```python
import torch

def _softmax(x, axis=-1):
    return torch.softmax(x, dim=axis)
def _gelu(x):
    return torch.nn.functional.gelu(x, approximate="tanh")
def _silu(x):
    return torch.nn.functional.silu(x)
def _sigmoid(x):
    return torch.sigmoid(x)
def _layernorm(x, axis=-1, eps=1e-5):
    m = x.mean(dim=axis, keepdim=True)
    v = x.var(dim=axis, keepdim=True, unbiased=False)
    return (x - m) / torch.sqrt(v + eps)
def _scatter_add(tgt, idx, src, axis=0):
    return tgt.clone().index_add_(axis, idx, src)
def _segment_sum(src, seg, n):
    out = torch.zeros((n,) + src.shape[1:], dtype=src.dtype)
    return out.index_add_(0, seg, src)
def _pad(x, pw):
    flat = tuple(v for pair in reversed(pw) for v in pair)
    return torch.nn.functional.pad(x, flat)

kernel_name = 'parallel_sum__grouped_kv_mqa__glu_gated_glu__prompt'

def setup_inputs():

    _w = (lambda a: (lambda t: t.to(torch.bfloat16) if t.is_floating_point() else t)(torch.as_tensor(a)))
    def _A_setup():
        B, S, D, H = 1, 2048, 448, 16
        Dh = D // H
        return {
            "x": _w((lambda *s: torch.randn(*s, dtype=torch.bfloat16) * 0.05)(B, S, D)),
            "wq": _w((lambda *s: torch.randn(*s, dtype=torch.bfloat16) * 0.2)(D, H * Dh)),
            "wk": _w((lambda *s: torch.randn(*s, dtype=torch.bfloat16) * 0.2)(D, Dh)),
            "wv": _w((lambda *s: torch.randn(*s, dtype=torch.bfloat16) * 0.1)(D, Dh)),
            "wo": _w((lambda *s: torch.randn(*s, dtype=torch.bfloat16) * 0.1)(H * Dh, D)),
        }
    _A_in = _A_setup()

    def _B_setup():
        B, S, D, F = 1, 2048, 448, 1792
        return {
            "x": _w((lambda *s: torch.randn(*s, dtype=torch.bfloat16) * 0.05)(B, S, D)),
            "w_gate": _w((lambda *s: torch.randn(*s, dtype=torch.bfloat16) * 0.2)(D, F)),
            "w_up": _w((lambda *s: torch.randn(*s, dtype=torch.bfloat16) * 0.1)(D, F)),
            "w_down": _w((lambda *s: torch.randn(*s, dtype=torch.bfloat16) * 0.1)(F, D)),
        }
    _B_in = _B_setup()

    return {
        "A_x": _A_in["x"],
        "A_wq": _A_in["wq"],
        "A_wk": _A_in["wk"],
        "A_wv": _A_in["wv"],
        "A_wo": _A_in["wo"],
        "B_x": _B_in["x"],
        "B_w_gate": _B_in["w_gate"],
        "B_w_up": _B_in["w_up"],
        "B_w_down": _B_in["w_down"],
    }

def reference(A_x, A_wq, A_wk, A_wv, A_wo, B_x, B_w_gate, B_w_up, B_w_down):
    def _A_ref(x, wq, wk, wv, wo):
        B, S, D = x.shape
        H = 16
        Dh = D // H
        q = (lambda x, *d: x.permute(*d))((x @ wq).reshape(B, S, H, Dh), 0, 2, 1, 3)
        k = x @ wk
        v = x @ wv
        scores = torch.einsum("bhqd,bkd->bhqk", q, k) * (Dh ** -0.5)
        p = _softmax(scores, axis=-1)
        o = torch.einsum("bhqk,bkd->bhqd", p, v)
        return (lambda x, *d: x.permute(*d))(o, 0, 2, 1, 3).reshape(B, S, H * Dh) @ wo

    def _B_ref(x, w_gate, w_up, w_down):
        g = torch.einsum("bsd,df->bsf", x, w_gate)
        u = torch.einsum("bsd,df->bsf", x, w_up)
        h = _sigmoid(g) * u
        return torch.einsum("bsf,fd->bsd", h, w_down)

    x = A_x
    xn = _layernorm(x, axis=-1)
    return x + _A_ref(xn, A_wq, A_wk, A_wv, A_wo) + _B_ref(xn, B_w_gate, B_w_up, B_w_down)
```

```asm
; @launch grid=(256,1,1) block=(512,1,1) lds=163840
.amdgcn_target "amdgcn-amd-amdhsa--gfx950"
.text
.p2align 8
.globl parallel_sum__grouped_kv_mqa__glu_gated_glu__prompt_kernel
.type parallel_sum__grouped_kv_mqa__glu_gated_glu__prompt_kernel,@function
parallel_sum__grouped_kv_mqa__glu_gated_glu__prompt_kernel:
    s_cmp_ge_u32 s2, 256
    s_cbranch_scc1 F_END
    s_load_dwordx16 s[8:23], s[0:1], 0
    s_load_dwordx8 s[24:31], s[0:1], 64
    s_cmp_lt_u32 s2, 192
    s_cbranch_scc1 F_NOPF
    s_getpc_b64 s[6:7]
F_PC:
    v_lshlrev_b32 v1, 7, v0
    v_min_u32 v1, F_CODE_END-F_PC-4, v1
    global_load_dword v255, v1, s[6:7]
F_NOPF:
    v_lshrrev_b32 v1, 6, v0
    v_and_b32 v0, 63, v0
    s_and_b32 s3, s2, 7
    s_lshr_b32 s4, s2, 3
    v_readfirstlane_b32 s62, v1
    s_and_b32 s60, s3, 3
    s_lshl_b32 s60, s60, 2
    s_and_b32 s5, s4, 3
    s_add_u32 s60, s60, s5
    s_lshr_b32 s61, s3, 2
    s_lshl_b32 s61, s61, 3
    s_lshr_b32 s6, s4, 2
    s_add_u32 s61, s61, s6
    s_lshl_b32 s5, s5, 1
    s_add_u32 s63, s5, s6
    s_cmp_ge_u32 s63, 7
    s_cselect_b32 s6, 7, 0
    s_sub_u32 s63, s63, s6
    v_lshrrev_b32 v2, 3, v0
    v_and_b32 v3, 7, v0
    s_waitcnt lgkmcnt(0)
    s_mov_b32 s52, s30
    s_mov_b32 s53, s31
    s_mov_b32 s54, 33554432
    s_mov_b32 s55, 0x20000
    s_mov_b32 s80, s28
    s_mov_b32 s81, s29
    s_mov_b32 s82, 256
    s_mov_b32 s83, 0x20000
    s_cmp_lt_u32 s62, 4
    s_cbranch_scc1 F_COMPUTE
    s_mov_b32 s44, s12
    s_mov_b32 s45, s13
    s_mov_b32 s46, 25088
    s_mov_b32 s47, 0x20000
    s_mov_b32 s48, s14
    s_mov_b32 s49, s15
    s_mov_b32 s50, 25088
    s_mov_b32 s51, 0x20000
    s_mov_b32 s32, s20
    s_mov_b32 s33, s21
    s_mov_b32 s34, 1605632
    s_mov_b32 s35, 0x20000
    s_mov_b32 s56, s22
    s_mov_b32 s57, s23
    s_mov_b32 s58, 1605632
    s_mov_b32 s59, 0x20000
    s_sub_u32 s62, s62, 4
    s_cmp_ge_u32 s61, 4
    s_cselect_b32 s36, s20, s10
    s_cselect_b32 s37, s21, s11
    s_cselect_b32 s40, s22, s10
    s_cselect_b32 s41, s23, s11
    s_mov_b32 s38, 401408
    s_mov_b32 s64, 896
    s_cselect_b32 s38, 1605632, s38
    s_cselect_b32 s64, 3584, s64
    s_cselect_b32 s5, 0, 128
    s_mov_b32 s39, 0x20000
    s_mov_b32 s42, s38
    s_mov_b32 s43, 0x20000
    s_sub_u32 s6, s61, 4
    s_cmp_ge_u32 s61, 4
    s_cselect_b32 s6, s6, s61
    s_lshl_b32 s65, s6, 8
    s_add_u32 s7, s65, 128
    s_lshl_b32 s6, s61, 7
    s_add_u32 s6, s6, 3072
    s_cmp_ge_u32 s61, 4
    s_cselect_b32 s67, s7, s6
    s_mul_i32 s7, s62, s64
    s_lshl_b32 s7, s7, 4
    s_add_u32 s65, s65, s7
    s_add_u32 s66, s65, s5
    s_mul_i32 s7, s62, 57344
    s_add_u32 s67, s67, s7
    s_lshl_b32 s69, s64, 3
    s_lshl_b32 s70, s64, 6
    s_lshl_b32 s73, s62, 11
    s_mul_i32 s74, s62, 896
    s_mov_b32 s71, s63
    s_mov_b32 s72, s63
    v_lshrrev_b32 v4, 1, v3
    v_and_b32 v5, 2, v2
    v_xor_b32 v4, v4, v5
    v_xor_b32 v5, 1, v4
    v_and_b32 v6, 1, v3
    v_mul_lo_u32 v7, v2, s64
    v_lshl_add_u32 v7, v6, 4, v7
    v_lshl_add_u32 v10, v4, 5, v7
    v_lshl_add_u32 v11, v5, 5, v7
    v_mul_u32_u24 v7, 3584, v2
    v_lshl_add_u32 v7, v6, 4, v7
    v_lshl_add_u32 v8, v4, 5, v7
    v_lshl_add_u32 v9, v5, 5, v7
    v_mul_u32_u24 v7, 56, v2
    v_and_b32 v6, 3, v3
    v_lshl_add_u32 v12, v6, 4, v7
    v_cmp_gt_u32 s[76:77], 2, v4
    v_cmp_le_u32 s[78:79], 2, v4
    s_mul_i32 s7, s71, s70
    s_add_u32 s5, s65, s7
    s_add_u32 s6, s66, s7
    s_cmp_eq_u32 s61, 3
    s_cbranch_scc1 K1_VS1
    s_add_u32 m0, s73, 114688
    s_add_u32 s7, s5, s69
    buffer_load_dwordx4 v10, s[36:39], s5 offen lds
    s_add_u32 m0, s73, 115712
    s_add_u32 s3, s6, s69
    buffer_load_dwordx4 v10, s[36:39], s7 offen lds
    s_add_u32 m0, s73, 122880
    s_nop 0
    buffer_load_dwordx4 v11, s[40:43], s6 offen lds
    s_add_u32 m0, s73, 123904
    s_nop 0
    buffer_load_dwordx4 v11, s[40:43], s3 offen lds
    s_branch K1_VE1
K1_VS1:
    s_mul_i32 s7, s71, 3584
    s_add_u32 s7, s7, s74
    s_add_u32 m0, s73, 114688
    s_add_u32 s3, s5, s69
    buffer_load_dwordx4 v10, s[36:39], s5 offen lds
    s_add_u32 m0, s73, 115712
    s_add_u32 s4, s7, 448
    buffer_load_dwordx4 v10, s[36:39], s3 offen lds
    s_add_u32 m0, s73, 122880
    s_mov_b64 exec, s[76:77]
    buffer_load_dwordx4 v12, s[44:47], s7 offen lds
    s_mov_b64 exec, s[78:79]
    buffer_load_dwordx4 v12, s[48:51], s7 offen lds
    s_add_u32 m0, s73, 123904
    s_mov_b64 exec, s[76:77]
    buffer_load_dwordx4 v12, s[44:47], s4 offen lds
    s_mov_b64 exec, s[78:79]
    buffer_load_dwordx4 v12, s[48:51], s4 offen lds
    s_mov_b64 exec, -1
K1_VE1:
    s_add_u32 s71, s71, 1
    s_cmp_eq_u32 s71, 7
    s_cselect_b32 s71, 0, s71
    s_lshl_b32 s3, s2, 2
    s_xor_b32 s3, s3, 3
    s_mov_b32 s4, 21004288
    s_cmp_lg_u32 s3, s62
    s_cbranch_scc1 F_NN
    buffer_load_dword v20, off, s[52:55], s4 sc1
    s_waitcnt vmcnt(0)
    v_add_u32 v20, 1, v20
    v_or_b32 v20, 0x80000000, v20
    s_mov_b64 exec, 1
    buffer_store_dword v20, off, s[80:83], 0 sc1
    buffer_store_dword v20, off, s[52:55], s4 sc1
    s_mov_b64 exec, -1
    s_branch F_NN2
F_NN:
    s_waitcnt vmcnt(0)
F_NN2:
    s_mul_i32 s7, s71, s70
    s_add_u32 s5, s65, s7
    s_add_u32 s6, s66, s7
    s_cmp_eq_u32 s61, 3
    s_cbranch_scc1 K1_VS2
    s_add_u32 m0, s73, 131072
    s_add_u32 s7, s5, s69
    buffer_load_dwordx4 v10, s[36:39], s5 offen lds
    s_add_u32 m0, s73, 132096
    s_add_u32 s3, s6, s69
    buffer_load_dwordx4 v10, s[36:39], s7 offen lds
    s_add_u32 m0, s73, 139264
    s_nop 0
    buffer_load_dwordx4 v11, s[40:43], s6 offen lds
    s_add_u32 m0, s73, 140288
    s_nop 0
    buffer_load_dwordx4 v11, s[40:43], s3 offen lds
    s_branch K1_VE2
K1_VS2:
    s_mul_i32 s7, s71, 3584
    s_add_u32 s7, s7, s74
    s_add_u32 m0, s73, 131072
    s_add_u32 s3, s5, s69
    buffer_load_dwordx4 v10, s[36:39], s5 offen lds
    s_add_u32 m0, s73, 132096
    s_add_u32 s4, s7, 448
    buffer_load_dwordx4 v10, s[36:39], s3 offen lds
    s_add_u32 m0, s73, 139264
    s_mov_b64 exec, s[76:77]
    buffer_load_dwordx4 v12, s[44:47], s7 offen lds
    s_mov_b64 exec, s[78:79]
    buffer_load_dwordx4 v12, s[48:51], s7 offen lds
    s_add_u32 m0, s73, 140288
    s_mov_b64 exec, s[76:77]
    buffer_load_dwordx4 v12, s[44:47], s4 offen lds
    s_mov_b64 exec, s[78:79]
    buffer_load_dwordx4 v12, s[48:51], s4 offen lds
    s_mov_b64 exec, -1
K1_VE2:
    s_add_u32 s71, s71, 1
    s_cmp_eq_u32 s71, 7
    s_cselect_b32 s71, 0, s71
    s_mul_i32 s7, s71, s70
    s_add_u32 s5, s65, s7
    s_add_u32 s6, s66, s7
    s_cmp_eq_u32 s61, 3
    s_cbranch_scc1 K1_VS3
    s_add_u32 m0, s73, 147456
    s_add_u32 s7, s5, s69
    buffer_load_dwordx4 v10, s[36:39], s5 offen lds
    s_add_u32 m0, s73, 148480
    s_add_u32 s3, s6, s69
    buffer_load_dwordx4 v10, s[36:39], s7 offen lds
    s_add_u32 m0, s73, 155648
    s_nop 0
    buffer_load_dwordx4 v11, s[40:43], s6 offen lds
    s_add_u32 m0, s73, 156672
    s_nop 0
    buffer_load_dwordx4 v11, s[40:43], s3 offen lds
    s_branch K1_VE3
K1_VS3:
    s_mul_i32 s7, s71, 3584
    s_add_u32 s7, s7, s74
    s_add_u32 m0, s73, 147456
    s_add_u32 s3, s5, s69
    buffer_load_dwordx4 v10, s[36:39], s5 offen lds
    s_add_u32 m0, s73, 148480
    s_add_u32 s4, s7, 448
    buffer_load_dwordx4 v10, s[36:39], s3 offen lds
    s_add_u32 m0, s73, 155648
    s_mov_b64 exec, s[76:77]
    buffer_load_dwordx4 v12, s[44:47], s7 offen lds
    s_mov_b64 exec, s[78:79]
    buffer_load_dwordx4 v12, s[48:51], s7 offen lds
    s_add_u32 m0, s73, 156672
    s_mov_b64 exec, s[76:77]
    buffer_load_dwordx4 v12, s[44:47], s4 offen lds
    s_mov_b64 exec, s[78:79]
    buffer_load_dwordx4 v12, s[48:51], s4 offen lds
    s_mov_b64 exec, -1
K1_VE3:
    s_add_u32 s71, s71, 1
    s_cmp_eq_u32 s71, 7
    s_cselect_b32 s71, 0, s71
    s_barrier
    s_mul_i32 s7, s71, s70
    s_add_u32 s5, s65, s7
    s_add_u32 s6, s66, s7
    s_cmp_eq_u32 s61, 3
    s_cbranch_scc1 K1_VS4
    s_add_u32 m0, s73, 0
    s_add_u32 s7, s5, s69
    buffer_load_dwordx4 v10, s[36:39], s5 offen lds
    s_add_u32 m0, s73, 1024
    s_add_u32 s3, s6, s69
    buffer_load_dwordx4 v10, s[36:39], s7 offen lds
    s_add_u32 m0, s73, 8192
    s_nop 0
    buffer_load_dwordx4 v11, s[40:43], s6 offen lds
    s_add_u32 m0, s73, 9216
    s_nop 0
    buffer_load_dwordx4 v11, s[40:43], s3 offen lds
    s_branch K1_VE4
K1_VS4:
    s_mul_i32 s7, s71, 3584
    s_add_u32 s7, s7, s74
    s_add_u32 m0, s73, 0
    s_add_u32 s3, s5, s69
    buffer_load_dwordx4 v10, s[36:39], s5 offen lds
    s_add_u32 m0, s73, 1024
    s_add_u32 s4, s7, 448
    buffer_load_dwordx4 v10, s[36:39], s3 offen lds
    s_add_u32 m0, s73, 8192
    s_mov_b64 exec, s[76:77]
    buffer_load_dwordx4 v12, s[44:47], s7 offen lds
    s_mov_b64 exec, s[78:79]
    buffer_load_dwordx4 v12, s[48:51], s7 offen lds
    s_add_u32 m0, s73, 9216
    s_mov_b64 exec, s[76:77]
    buffer_load_dwordx4 v12, s[44:47], s4 offen lds
    s_mov_b64 exec, s[78:79]
    buffer_load_dwordx4 v12, s[48:51], s4 offen lds
    s_mov_b64 exec, -1
K1_VE4:
    s_add_u32 s71, s71, 1
    s_cmp_eq_u32 s71, 7
    s_cselect_b32 s71, 0, s71
    s_cmp_eq_u32 s61, 3
    s_cbranch_scc1 W31
    s_waitcnt vmcnt(4)
W31:
    s_waitcnt vmcnt(6)
    s_barrier
    s_mul_i32 s7, s71, s70
    s_add_u32 s5, s65, s7
    s_add_u32 s6, s66, s7
    s_cmp_eq_u32 s61, 3
    s_cbranch_scc1 K1_VS5
    s_add_u32 m0, s73, 16384
    s_add_u32 s7, s5, s69
    buffer_load_dwordx4 v10, s[36:39], s5 offen lds
    s_add_u32 m0, s73, 17408
    s_add_u32 s3, s6, s69
    buffer_load_dwordx4 v10, s[36:39], s7 offen lds
    s_add_u32 m0, s73, 24576
    s_nop 0
    buffer_load_dwordx4 v11, s[40:43], s6 offen lds
    s_add_u32 m0, s73, 25600
    s_nop 0
    buffer_load_dwordx4 v11, s[40:43], s3 offen lds
    s_branch K1_VE5
K1_VS5:
    s_mul_i32 s7, s71, 3584
    s_add_u32 s7, s7, s74
    s_add_u32 m0, s73, 16384
    s_add_u32 s3, s5, s69
    buffer_load_dwordx4 v10, s[36:39], s5 offen lds
    s_add_u32 m0, s73, 17408
    s_add_u32 s4, s7, 448
    buffer_load_dwordx4 v10, s[36:39], s3 offen lds
    s_add_u32 m0, s73, 24576
    s_mov_b64 exec, s[76:77]
    buffer_load_dwordx4 v12, s[44:47], s7 offen lds
    s_mov_b64 exec, s[78:79]
    buffer_load_dwordx4 v12, s[48:51], s7 offen lds
    s_add_u32 m0, s73, 25600
    s_mov_b64 exec, s[76:77]
    buffer_load_dwordx4 v12, s[44:47], s4 offen lds
    s_mov_b64 exec, s[78:79]
    buffer_load_dwordx4 v12, s[48:51], s4 offen lds
    s_mov_b64 exec, -1
K1_VE5:
    s_add_u32 s71, s71, 1
    s_cmp_eq_u32 s71, 7
    s_cselect_b32 s71, 0, s71
    s_mul_i32 s7, s71, s70
    s_add_u32 s5, s65, s7
    s_add_u32 s6, s66, s7
    s_cmp_eq_u32 s61, 3
    s_cbranch_scc1 K1_VS6
    s_add_u32 m0, s73, 32768
    s_add_u32 s7, s5, s69
    buffer_load_dwordx4 v10, s[36:39], s5 offen lds
    s_add_u32 m0, s73, 33792
    s_add_u32 s3, s6, s69
    buffer_load_dwordx4 v10, s[36:39], s7 offen lds
    s_add_u32 m0, s73, 40960
    s_nop 0
    buffer_load_dwordx4 v11, s[40:43], s6 offen lds
    s_add_u32 m0, s73, 41984
    s_nop 0
    buffer_load_dwordx4 v11, s[40:43], s3 offen lds
    s_branch K1_VE6
K1_VS6:
    s_mul_i32 s7, s71, 3584
    s_add_u32 s7, s7, s74
    s_add_u32 m0, s73, 32768
    s_add_u32 s3, s5, s69
    buffer_load_dwordx4 v10, s[36:39], s5 offen lds
    s_add_u32 m0, s73, 33792
    s_add_u32 s4, s7, 448
    buffer_load_dwordx4 v10, s[36:39], s3 offen lds
    s_add_u32 m0, s73, 40960
    s_mov_b64 exec, s[76:77]
    buffer_load_dwordx4 v12, s[44:47], s7 offen lds
    s_mov_b64 exec, s[78:79]
    buffer_load_dwordx4 v12, s[48:51], s7 offen lds
    s_add_u32 m0, s73, 41984
    s_mov_b64 exec, s[76:77]
    buffer_load_dwordx4 v12, s[44:47], s4 offen lds
    s_mov_b64 exec, s[78:79]
    buffer_load_dwordx4 v12, s[48:51], s4 offen lds
    s_mov_b64 exec, -1
K1_VE6:
    s_add_u32 s71, s71, 1
    s_cmp_eq_u32 s71, 7
    s_cselect_b32 s71, 0, s71
    s_mul_i32 s7, s71, s70
    s_add_u32 s5, s65, s7
    s_add_u32 s6, s66, s7
    s_cmp_eq_u32 s61, 3
    s_cbranch_scc1 K1_VS7
    s_add_u32 m0, s73, 49152
    s_add_u32 s7, s5, s69
    buffer_load_dwordx4 v10, s[36:39], s5 offen lds
    s_add_u32 m0, s73, 50176
    s_add_u32 s3, s6, s69
    buffer_load_dwordx4 v10, s[36:39], s7 offen lds
    s_add_u32 m0, s73, 57344
    s_nop 0
    buffer_load_dwordx4 v11, s[40:43], s6 offen lds
    s_add_u32 m0, s73, 58368
    s_nop 0
    buffer_load_dwordx4 v11, s[40:43], s3 offen lds
    s_branch K1_VE7
K1_VS7:
    s_mul_i32 s7, s71, 3584
    s_add_u32 s7, s7, s74
    s_add_u32 m0, s73, 49152
    s_add_u32 s3, s5, s69
    buffer_load_dwordx4 v10, s[36:39], s5 offen lds
    s_add_u32 m0, s73, 50176
    s_add_u32 s4, s7, 448
    buffer_load_dwordx4 v10, s[36:39], s3 offen lds
    s_add_u32 m0, s73, 57344
    s_mov_b64 exec, s[76:77]
    buffer_load_dwordx4 v12, s[44:47], s7 offen lds
    s_mov_b64 exec, s[78:79]
    buffer_load_dwordx4 v12, s[48:51], s7 offen lds
    s_add_u32 m0, s73, 58368
    s_mov_b64 exec, s[76:77]
    buffer_load_dwordx4 v12, s[44:47], s4 offen lds
    s_mov_b64 exec, s[78:79]
    buffer_load_dwordx4 v12, s[48:51], s4 offen lds
    s_mov_b64 exec, -1
K1_VE7:
    s_add_u32 s71, s71, 1
    s_cmp_eq_u32 s71, 7
    s_cselect_b32 s71, 0, s71
    s_mul_i32 s5, s72, 229376
    s_add_u32 s5, s5, s67
    s_add_u32 m0, s73, 65536
    s_add_u32 s7, s5, 28672
    buffer_load_dwordx4 v8, s[32:35], s5 offen lds
    s_add_u32 m0, s73, 66560
    s_nop 0
    buffer_load_dwordx4 v8, s[32:35], s7 offen lds
    s_add_u32 m0, s73, 73728
    s_nop 0
    buffer_load_dwordx4 v9, s[56:59], s5 offen lds
    s_add_u32 m0, s73, 74752
    s_nop 0
    buffer_load_dwordx4 v9, s[56:59], s7 offen lds
    s_add_u32 s72, s72, 1
    s_cmp_eq_u32 s72, 7
    s_cselect_b32 s72, 0, s72
    s_cmp_eq_u32 s61, 3
    s_cbranch_scc1 W32
    s_waitcnt vmcnt(12)
W32:
    s_waitcnt vmcnt(16)
    s_barrier
    s_mul_i32 s5, s72, 229376
    s_add_u32 s5, s5, s67
    s_add_u32 m0, s73, 81920
    s_add_u32 s7, s5, 28672
    buffer_load_dwordx4 v8, s[32:35], s5 offen lds
    s_add_u32 m0, s73, 82944
    s_nop 0
    buffer_load_dwordx4 v8, s[32:35], s7 offen lds
    s_add_u32 m0, s73, 90112
    s_nop 0
    buffer_load_dwordx4 v9, s[56:59], s5 offen lds
    s_add_u32 m0, s73, 91136
    s_nop 0
    buffer_load_dwordx4 v9, s[56:59], s7 offen lds
    s_add_u32 s72, s72, 1
    s_cmp_eq_u32 s72, 7
    s_cselect_b32 s72, 0, s72
    s_mul_i32 s5, s72, 229376
    s_add_u32 s5, s5, s67
    s_add_u32 m0, s73, 98304
    s_add_u32 s7, s5, 28672
    buffer_load_dwordx4 v8, s[32:35], s5 offen lds
    s_add_u32 m0, s73, 99328
    s_nop 0
    buffer_load_dwordx4 v8, s[32:35], s7 offen lds
    s_add_u32 m0, s73, 106496
    s_nop 0
    buffer_load_dwordx4 v9, s[56:59], s5 offen lds
    s_add_u32 m0, s73, 107520
    s_nop 0
    buffer_load_dwordx4 v9, s[56:59], s7 offen lds
    s_add_u32 s72, s72, 1
    s_cmp_eq_u32 s72, 7
    s_cselect_b32 s72, 0, s72
    s_mul_i32 s5, s72, 229376
    s_add_u32 s5, s5, s67
    s_add_u32 m0, s73, 114688
    s_add_u32 s7, s5, 28672
    buffer_load_dwordx4 v8, s[32:35], s5 offen lds
    s_add_u32 m0, s73, 115712
    s_nop 0
    buffer_load_dwordx4 v8, s[32:35], s7 offen lds
    s_add_u32 m0, s73, 122880
    s_nop 0
    buffer_load_dwordx4 v9, s[56:59], s5 offen lds
    s_add_u32 m0, s73, 123904
    s_nop 0
    buffer_load_dwordx4 v9, s[56:59], s7 offen lds
    s_add_u32 s72, s72, 1
    s_cmp_eq_u32 s72, 7
    s_cselect_b32 s72, 0, s72
    s_mul_i32 s5, s72, 229376
    s_add_u32 s5, s5, s67
    s_add_u32 m0, s73, 131072
    s_add_u32 s7, s5, 28672
    buffer_load_dwordx4 v8, s[32:35], s5 offen lds
    s_add_u32 m0, s73, 132096
    s_nop 0
    buffer_load_dwordx4 v8, s[32:35], s7 offen lds
    s_add_u32 m0, s73, 139264
    s_nop 0
    buffer_load_dwordx4 v9, s[56:59], s5 offen lds
    s_add_u32 m0, s73, 140288
    s_nop 0
    buffer_load_dwordx4 v9, s[56:59], s7 offen lds
    s_add_u32 s72, s72, 1
    s_cmp_eq_u32 s72, 7
    s_cselect_b32 s72, 0, s72
    s_waitcnt vmcnt(20)
    s_barrier
    buffer_load_dword v14, off, s[80:83], 0 sc1
    s_mul_i32 s5, s72, 229376
    s_add_u32 s5, s5, s67
    s_add_u32 m0, s73, 147456
    s_add_u32 s7, s5, 28672
    buffer_load_dwordx4 v8, s[32:35], s5 offen lds
    s_add_u32 m0, s73, 148480
    s_nop 0
    buffer_load_dwordx4 v8, s[32:35], s7 offen lds
    s_add_u32 m0, s73, 155648
    s_nop 0
    buffer_load_dwordx4 v9, s[56:59], s5 offen lds
    s_add_u32 m0, s73, 156672
    s_nop 0
    buffer_load_dwordx4 v9, s[56:59], s7 offen lds
    s_add_u32 s72, s72, 1
    s_cmp_eq_u32 s72, 7
    s_cselect_b32 s72, 0, s72
    s_mul_i32 s5, s72, 229376
    s_add_u32 s5, s5, s67
    s_add_u32 m0, s73, 0
    s_add_u32 s7, s5, 28672
    buffer_load_dwordx4 v8, s[32:35], s5 offen lds
    s_add_u32 m0, s73, 1024
    s_nop 0
    buffer_load_dwordx4 v8, s[32:35], s7 offen lds
    s_add_u32 m0, s73, 8192
    s_nop 0
    buffer_load_dwordx4 v9, s[56:59], s5 offen lds
    s_add_u32 m0, s73, 9216
    s_nop 0
    buffer_load_dwordx4 v9, s[56:59], s7 offen lds
    s_add_u32 s72, s72, 1
    s_cmp_eq_u32 s72, 7
    s_cselect_b32 s72, 0, s72
    v_lshlrev_b32 v0, 4, v0
    s_mov_b32 s40, s24
    s_mov_b32 s41, s25
    s_mov_b32 s42, 1605632
    s_mov_b32 s43, 0x20000
    s_and_b32 s4, s61, 7
    s_cmp_lt_u32 s61, 8
    s_cselect_b32 s5, 3, 7
    s_cmp_gt_u32 s4, s5
    s_subb_u32 s70, s4, 0
    s_cmp_eq_u32 s4, s5
    s_and_b32 s5, s60, 3
    s_mul_i32 s5, s5, 7
    s_lshl_b32 s6, s70, 2
    s_add_u32 s5, s5, s6
    s_cmp_ge_u32 s5, 28
    s_cselect_b32 s6, 28, 0
    s_sub_u32 s63, s5, s6
    s_add_u32 s5, s63, 0
    s_cmp_ge_u32 s5, 28
    s_cselect_b32 s6, 28, 0
    s_sub_u32 s5, s5, s6
    s_mul_i32 s73, s5, 14336
    s_mul_i32 s74, s62, 12288
    s_add_u32 s74, s74, 16384
    s_lshl_b32 s5, s70, 7
    s_mul_i32 s6, s62, 401408
    s_add_u32 s5, s5, s6
    v_lshrrev_b32 v7, 7, v0
    v_mul_u32_u24 v7, 896, v7
    v_and_b32 v13, 0x70, v0
    v_add_u32 v7, v7, v13
    v_add_u32 v12, s5, v7
    v_add_u32 v13, 7168, v12
    v_lshrrev_b32 v0, 4, v0
    s_waitcnt vmcnt(0)
    s_barrier
    s_and_b32 s5, s61, 7
    s_cmp_lt_u32 s61, 8
    s_cselect_b32 s6, 3, 7
    s_cmp_gt_u32 s5, s6
    s_subb_u32 s4, s5, 0
    s_cmp_eq_u32 s5, s6
    s_cbranch_scc1 F_NR
    s_cmp_ge_u32 s61, 3
    s_cbranch_scc1 F_NB
    s_barrier
F_NB:
    s_add_u32 m0, s74, 0
    s_add_u32 s72, s73, 14336
    buffer_load_dwordx4 v12, s[40:43], s73 offen lds
    s_add_u32 m0, s74, 1024
    s_cmp_eq_u32 s72, 401408
    buffer_load_dwordx4 v13, s[40:43], s73 offen lds
    s_cselect_b32 s73, 0, s72
    s_add_u32 m0, s74, 2048
    s_add_u32 s72, s73, 14336
    buffer_load_dwordx4 v12, s[40:43], s73 offen lds
    s_add_u32 m0, s74, 3072
    s_cmp_eq_u32 s72, 401408
    buffer_load_dwordx4 v13, s[40:43], s73 offen lds
    s_cselect_b32 s73, 0, s72
    s_add_u32 m0, s74, 4096
    s_add_u32 s72, s73, 14336
    buffer_load_dwordx4 v12, s[40:43], s73 offen lds
    s_add_u32 m0, s74, 5120
    s_cmp_eq_u32 s72, 401408
    buffer_load_dwordx4 v13, s[40:43], s73 offen lds
    s_cselect_b32 s73, 0, s72
    s_add_u32 m0, s74, 6144
    s_add_u32 s72, s73, 14336
    buffer_load_dwordx4 v12, s[40:43], s73 offen lds
    s_add_u32 m0, s74, 7168
    s_cmp_eq_u32 s72, 401408
    buffer_load_dwordx4 v13, s[40:43], s73 offen lds
    s_cselect_b32 s73, 0, s72
    s_add_u32 m0, s74, 8192
    s_add_u32 s72, s73, 14336
    buffer_load_dwordx4 v12, s[40:43], s73 offen lds
    s_add_u32 m0, s74, 9216
    s_cmp_eq_u32 s72, 401408
    buffer_load_dwordx4 v13, s[40:43], s73 offen lds
    s_cselect_b32 s73, 0, s72
    s_add_u32 m0, s74, 10240
    s_add_u32 s72, s73, 14336
    buffer_load_dwordx4 v12, s[40:43], s73 offen lds
    s_add_u32 m0, s74, 11264
    s_cmp_eq_u32 s72, 401408
    buffer_load_dwordx4 v13, s[40:43], s73 offen lds
    s_cselect_b32 s73, 0, s72
F_NR:
    v_readfirstlane_b32 s4, v14
    s_nop 0
    s_cmp_lg_u32 s4, 0
    s_cbranch_scc1 NC3E
    s_mov_b32 s5, 400000
NC3:
    buffer_load_dword v14, off, s[80:83], 0 sc1
    s_waitcnt vmcnt(0)
    v_readfirstlane_b32 s4, v14
    s_nop 0
    s_cmp_lg_u32 s4, 0
    s_cbranch_scc1 NC3E
    s_sub_u32 s5, s5, 1
    s_cmp_lg_u32 s5, 0
    s_cbranch_scc1 NC3
NC3E:
    v_lshlrev_b32 v1, 4, v0
    v_cmp_lt_u32 s[30:31], 31, v0
    s_mul_i32 s5, s61, 7
    v_lshrrev_b32 v2, 5, v0
    v_add_u32 v2, s5, v2
    v_and_b32 v3, 31, v0
    v_lshlrev_b32 v3, 4, v3
    s_mov_b32 s24, 0
    s_mov_b32 s19, 0x20000000
    s_cmp_eq_u32 s61, 3
    s_mov_b32 s18, 65536
    s_cselect_b32 s18, 16384, s18
    s_lshl_b32 s22, s62, 16
    s_add_u32 s22, s22, 2097152
    s_lshr_b32 s23, s2, 3
    s_and_b32 s23, s23, 15
    s_lshl_b32 s23, s23, 12
    s_lshl_b32 s7, s60, 2
    s_and_b32 s5, s61, 3
    s_add_u32 s7, s7, s5
    s_lshl_b32 s7, s7, 12
    s_add_u32 s7, s7, 2097152
    v_add_u32 v4, 0, v2
    v_lshrrev_b32 v5, 2, v4
    v_lshl_add_u32 v8, v5, 10, v3
    v_and_b32 v5, 1, v4
    v_lshl_add_u32 v8, v5, 9, v8
    v_and_b32 v5, 2, v4
    v_lshl_add_u32 v8, v5, 2, v8
    v_add_u32 v4, 2, v2
    v_lshrrev_b32 v5, 2, v4
    v_lshl_add_u32 v9, v5, 10, v3
    v_and_b32 v5, 1, v4
    v_lshl_add_u32 v9, v5, 9, v9
    v_and_b32 v5, 2, v4
    v_lshl_add_u32 v9, v5, 2, v9
    s_setprio 3
    s_mov_b32 s27, 0
    s_mul_i32 s5, s61, 28
    v_bfe_u32 v4, v0, 2, 2
    v_mul_u32_u24 v4, 27, v4
    v_add_u32 v4, s5, v4
    v_lshrrev_b32 v4, 7, v4
    v_bfe_u32 v5, v0, 3, 1
    v_mul_u32_u24 v5, 3, v5
    v_or_b32 v4, v4, v5
    v_and_b32 v4, 3, v4
    v_and_b32 v5, 3, v0
    v_lshlrev_b32 v5, 7, v5
    v_lshl_add_u32 v4, v4, 9, v5
    v_bfe_u32 v12, v0, 2, 2
    v_lshl_add_u32 v12, v12, 11, v5
    s_lshl_b32 s29, s60, 11
    s_add_u32 s29, s29, 20971520
    s_lshl_b32 s28, s62, 13
    s_add_u32 s28, s28, 20973056
    s_sub_u32 s5, s29, s28
    v_add_u32 v4, s5, v4
    v_cmp_lt_u32 vcc, 15, v0
    v_add_u32 v12, s28, v12
    v_add_u32 v4, s28, v4
    s_mov_b32 s28, 0
    v_cndmask_b32 v12, v12, v4, vcc
    v_mov_b32 v48, 0
    v_mov_b32 v49, 0
    v_mov_b32 v50, 0
    v_mov_b32 v51, 0
    v_mov_b32 v52, 0
    v_mov_b32 v53, 0
    v_mov_b32 v54, 0
    v_mov_b32 v55, 0
    v_mov_b32 v56, 0
    v_mov_b32 v57, 0
    v_mov_b32 v58, 0
    v_mov_b32 v59, 0
    v_mov_b32 v60, 0
    v_mov_b32 v61, 0
    v_mov_b32 v62, 0
    v_mov_b32 v63, 0
    v_mov_b32 v64, 0
    v_mov_b32 v65, 0
    v_mov_b32 v66, 0
    v_mov_b32 v67, 0
    v_mov_b32 v68, 0
    v_mov_b32 v69, 0
    v_mov_b32 v70, 0
    v_mov_b32 v71, 0
    v_mov_b32 v72, 0
    v_mov_b32 v73, 0
    v_mov_b32 v74, 0
    v_mov_b32 v75, 0
    v_mov_b32 v76, 0
    v_mov_b32 v77, 0
    v_mov_b32 v78, 0
    v_mov_b32 v79, 0
    v_mov_b32 v80, 0
    v_mov_b32 v81, 0
    v_mov_b32 v82, 0
    v_mov_b32 v83, 0
    v_mov_b32 v84, 0
    v_mov_b32 v85, 0
    v_mov_b32 v86, 0
    v_mov_b32 v87, 0
    v_mov_b32 v88, 0
    v_mov_b32 v89, 0
    v_mov_b32 v90, 0
    v_mov_b32 v91, 0
    v_mov_b32 v92, 0
    v_mov_b32 v93, 0
    v_mov_b32 v94, 0
    v_mov_b32 v95, 0
    v_mov_b32 v96, 0
    v_mov_b32 v97, 0
    v_mov_b32 v98, 0
    v_mov_b32 v99, 0
    v_mov_b32 v100, 0
    v_mov_b32 v101, 0
    v_mov_b32 v102, 0
    v_mov_b32 v103, 0
    v_mov_b32 v104, 0
    v_mov_b32 v105, 0
    v_mov_b32 v106, 0
    v_mov_b32 v107, 0
    v_mov_b32 v108, 0
    v_mov_b32 v109, 0
    v_mov_b32 v110, 0
    v_mov_b32 v111, 0
    v_mov_b32 v216, 0
    v_mov_b32 v217, 0
    v_mov_b32 v218, 0
    v_mov_b32 v219, 0
    v_mov_b32 v220, 0
    v_mov_b32 v221, 0
    v_mov_b32 v222, 0
    v_mov_b32 v223, 0
    s_add_u32 s5, s18, 10240
    v_and_b32 v13, 3, v0
    v_mul_u32_u24 v13, 12288, v13
    v_add_u32 v13, s5, v13
    s_add_u32 s6, s62, 0
    s_and_b32 s6, s6, 3
    s_mul_i32 s6, s6, 12288
    s_add_u32 s6, s6, s5
    v_add_u32 v248, s6, v1
    s_add_u32 s6, s62, 1
    s_and_b32 s6, s6, 3
    s_mul_i32 s6, s6, 12288
    s_add_u32 s6, s6, s5
    v_add_u32 v249, s6, v1
    s_add_u32 s6, s62, 2
    s_and_b32 s6, s6, 3
    s_mul_i32 s6, s6, 12288
    s_add_u32 s6, s6, s5
    v_add_u32 v250, s6, v1
    s_add_u32 s6, s62, 3
    s_and_b32 s6, s6, 3
    s_mul_i32 s6, s6, 12288
    s_add_u32 s6, s6, s5
    v_add_u32 v251, s6, v1
    s_waitcnt vmcnt(0)
    s_barrier
    s_mov_b32 s4, 400000
    s_bfm_b64 exec, 28, 0
    s_branch K2_P1F
K2_P1:
    s_sleep 4
K2_P1F:
    buffer_load_dword v6, v12, s[52:55], s28 offen sc1
    s_waitcnt vmcnt(0)
    v_cmp_ne_u32 vcc, v6, v14
    s_sub_u32 s4, s4, 1
    s_mov_b32 s20, vcc_lo
    s_cmp_lt_u32 s20, 0x10000
    s_cbranch_scc1 K2_P1E
    s_cmp_lg_u32 s4, 0
    s_cbranch_scc1 K2_P1
K2_P1E:
    s_cmp_eq_u32 s20, 0
    s_cbranch_scc1 K2_NK
    s_bfm_b64 exec, 16, 0
    buffer_load_dword v6, v12, s[52:55], s28 offen sc1
K2_NK:
    s_mov_b64 exec, -1
    s_add_u32 s6, s62, 0
    s_and_b32 s6, s6, 3
    s_lshl_b32 s26, s60, 2
    s_add_u32 s6, s6, s26
    s_mul_i32 s6, s6, 28672
    buffer_load_dwordx2 v[16:17], v8, s[52:55], s6 offen offset:0 sc1
    buffer_load_dwordx2 v[18:19], v9, s[52:55], s6 offen offset:0 sc1
    buffer_load_dwordx2 v[20:21], v8, s[52:55], s6 offen offset:1024 sc1
    buffer_load_dwordx2 v[22:23], v9, s[52:55], s6 offen offset:1024 sc1
    buffer_load_dwordx4 v[224:227], v1, s[52:55], s7 offen sc1
    buffer_load_dwordx4 v[228:231], v1, s[52:55], s7 offen offset:1024 sc1
    s_cmp_eq_u32 s20, 0
    s_cbranch_scc1 K2_GO
    s_waitcnt vmcnt(6)
    v_cmp_ne_u32 vcc, v6, v14
    s_nop 0
    s_and_b32 s20, vcc_lo, 0xffff
    s_cbranch_scc0 K2_GO
    s_mov_b32 s4, 400000
    s_branch PL4F
PL4:
    s_sleep 4
PL4F:
    s_bfm_b64 exec, 16, 0
    buffer_load_dword v6, v12, s[52:55], s28 offen sc1
    s_waitcnt vmcnt(0)
PL4C:
    v_xor_b32 v6, v6, v14
    v_cmp_ne_u32 vcc, 0, v6
    s_sub_u32 s4, s4, 1
    s_cmp_eq_u64 vcc, 0
    s_cbranch_scc1 PL4E
    s_cmp_lg_u32 s4, 0
    s_cbranch_scc1 PL4
PL4E:
    s_mov_b64 exec, -1
K2_GO:
    s_mov_b32 s20, s23
    s_add_u32 s21, s20, s22
    buffer_load_dwordx4 v[160:163], v1, s[52:55], s21 offen offset:0 sc1
    buffer_load_dwordx4 v[164:167], v1, s[52:55], s21 offen offset:1024 sc1
    buffer_load_dwordx4 v[168:171], v1, s[52:55], s21 offen offset:2048 sc1
    buffer_load_dwordx4 v[172:175], v1, s[52:55], s21 offen offset:3072 sc1
    s_add_u32 s20, s20, 4096
    s_and_b32 s20, s20, 0xffff
    s_add_u32 s21, s20, s22
    buffer_load_dwordx4 v[176:179], v1, s[52:55], s21 offen offset:0 sc1
    buffer_load_dwordx4 v[180:183], v1, s[52:55], s21 offen offset:1024 sc1
    buffer_load_dwordx4 v[184:187], v1, s[52:55], s21 offen offset:2048 sc1
    buffer_load_dwordx4 v[188:191], v1, s[52:55], s21 offen offset:3072 sc1
    s_waitcnt vmcnt(10)
    ds_write_b128 v248, v[16:19]
    ds_write_b128 v248, v[20:23] offset:1024
    s_mov_b64 exec, 1
    ds_write_b32 v248, v14 offset:2044
    s_mov_b64 exec, -1
    s_mov_b32 s4, 1600000
K2_XQ:
    ds_read_b32 v6, v13 offset:2044
    s_sub_u32 s4, s4, 1
    s_waitcnt lgkmcnt(0)
    v_cmp_ne_u32 vcc, v6, v14
    s_cmp_eq_u32 s4, 0
    s_cbranch_scc1 K2_XE
    s_cmp_lg_u64 vcc, 0
    s_cbranch_scc1 K2_XQ
K2_XE:
    ds_read_b128 v[24:27], v249 offset:0
    ds_read_b128 v[28:31], v249 offset:1024
    ds_read_b128 v[32:35], v250 offset:0
    ds_read_b128 v[36:39], v250 offset:1024
    ds_read_b128 v[40:43], v251 offset:0
    ds_read_b128 v[44:47], v251 offset:1024
    s_waitcnt vmcnt(8) lgkmcnt(0)
    v_cndmask_b32 v22, v22, 0, s[30:31]
    v_cndmask_b32 v23, v23, 0, s[30:31]
    v_cndmask_b32 v30, v30, 0, s[30:31]
    v_cndmask_b32 v31, v31, 0, s[30:31]
    v_cndmask_b32 v38, v38, 0, s[30:31]
    v_cndmask_b32 v39, v39, 0, s[30:31]
    v_cndmask_b32 v46, v46, 0, s[30:31]
    v_cndmask_b32 v47, v47, 0, s[30:31]
    v_mfma_f32_32x32x16_bf16 v[112:127], v[224:227], v[16:19], 0
    v_mfma_f32_32x32x16_bf16 v[128:143], v[224:227], v[24:27], 0
    v_mfma_f32_32x32x16_bf16 v[144:159], v[224:227], v[32:35], 0
    v_mfma_f32_32x32x16_bf16 v[232:247], v[224:227], v[40:43], 0
    v_mfma_f32_32x32x16_bf16 v[112:127], v[228:231], v[20:23], v[112:127]
    v_mfma_f32_32x32x16_bf16 v[128:143], v[228:231], v[28:31], v[128:143]
    v_mfma_f32_32x32x16_bf16 v[144:159], v[228:231], v[36:39], v[144:159]
    v_mfma_f32_32x32x16_bf16 v[232:247], v[228:231], v[44:47], v[232:247]
    s_add_u32 s20, s20, 4096
    s_and_b32 s20, s20, 0xffff
    s_add_u32 s21, s20, s22
    buffer_load_dwordx4 v[192:195], v1, s[52:55], s21 offen offset:0 sc1
    buffer_load_dwordx4 v[196:199], v1, s[52:55], s21 offen offset:1024 sc1
    buffer_load_dwordx4 v[200:203], v1, s[52:55], s21 offen offset:2048 sc1
    buffer_load_dwordx4 v[204:207], v1, s[52:55], s21 offen offset:3072 sc1
    s_add_u32 s20, s20, 4096
    s_and_b32 s20, s20, 0xffff
    s_add_u32 s21, s20, s22
    buffer_load_dwordx4 v[208:211], v1, s[52:55], s21 offen offset:0 sc1
    buffer_load_dwordx4 v[212:215], v1, s[52:55], s21 offen offset:1024 sc1
    v_max3_f32 v4, v112, v113, v114
    v_max3_f32 v4, v4, v115, v116
    v_max3_f32 v4, v4, v117, v118
    v_max3_f32 v4, v4, v119, v120
    v_max3_f32 v4, v4, v121, v122
    v_max3_f32 v4, v4, v123, v124
    v_max3_f32 v4, v4, v125, v126
    v_max_f32 v4, v4, v127
    v_max3_f32 v5, v128, v129, v130
    v_max3_f32 v5, v5, v131, v132
    v_max3_f32 v5, v5, v133, v134
    v_max3_f32 v5, v5, v135, v136
    v_max3_f32 v5, v5, v137, v138
    v_max3_f32 v5, v5, v139, v140
    v_max3_f32 v5, v5, v141, v142
    v_max_f32 v5, v5, v143
    v_max3_f32 v6, v144, v145, v146
    v_max3_f32 v6, v6, v147, v148
    v_max3_f32 v6, v6, v149, v150
    v_max3_f32 v6, v6, v151, v152
    v_max3_f32 v6, v6, v153, v154
    v_max3_f32 v6, v6, v155, v156
    v_max3_f32 v6, v6, v157, v158
    v_max_f32 v6, v6, v159
    v_max3_f32 v7, v232, v233, v234
    v_max3_f32 v7, v7, v235, v236
    v_max3_f32 v7, v7, v237, v238
    v_max3_f32 v7, v7, v239, v240
    v_max3_f32 v7, v7, v241, v242
    v_max3_f32 v7, v7, v243, v244
    v_max3_f32 v7, v7, v245, v246
    v_max_f32 v7, v7, v247
    v_mov_b32 v8, v4
    v_mov_b32 v9, v5
    v_mov_b32 v10, v6
    v_mov_b32 v11, v7
    v_permlane32_swap_b32 v4, v8
    v_permlane32_swap_b32 v5, v9
    v_permlane32_swap_b32 v6, v10
    v_permlane32_swap_b32 v7, v11
    v_max_f32 v4, v4, v8
    v_max_f32 v5, v5, v9
    v_max_f32 v6, v6, v10
    v_max_f32 v7, v7, v11
    v_add_f32 v4, 0x42200000, v4
    v_add_f32 v5, 0x42200000, v5
    v_add_f32 v6, 0x42200000, v6
    v_add_f32 v7, 0x42200000, v7
    v_cvt_pk_bf16_f32 v8, -v4, 0
    v_cvt_pk_bf16_f32 v9, -v5, 0
    v_cvt_pk_bf16_f32 v10, -v6, 0
    v_cvt_pk_bf16_f32 v11, -v7, 0
    v_cndmask_b32 v22, v22, v8, s[30:31]
    v_cndmask_b32 v30, v30, v9, s[30:31]
    v_cndmask_b32 v38, v38, v10, s[30:31]
    v_cndmask_b32 v46, v46, v11, s[30:31]
K2_SETM:
    v_mov_b32 v152, 0
    v_mov_b32 v153, 0
    v_mov_b32 v154, 0
    v_mov_b32 v155, 0
    v_mov_b32 v156, 0
    v_mov_b32 v157, 0
    v_mov_b32 v158, 0
    v_mov_b32 v159, 0
    s_waitcnt vmcnt(12)
    v_mfma_f32_32x32x16_bf16 v[112:127], v[160:163], v[16:19], 0
    v_mfma_f32_32x32x16_bf16 v[112:127], v[164:167], v[20:23], v[112:127]
    s_mov_b32 s25, 4
    s_nop 10
.p2align 6
K2_LOOP:
    v_mfma_f32_32x32x16_bf16 v[128:143], v[160:163], v[24:27], 0
    v_exp_f32 v112, v112
    v_exp_f32 v113, v113
    v_exp_f32 v114, v114
    v_exp_f32 v115, v115
    v_mfma_f32_32x32x16_bf16 v[128:143], v[164:167], v[28:31], v[128:143]
    v_exp_f32 v116, v116
    v_exp_f32 v117, v117
    v_exp_f32 v118, v118
    v_exp_f32 v119, v119
    v_cvt_pk_bf16_f32 v144, v112, v113
    v_cvt_pk_bf16_f32 v145, v114, v115
    v_mfma_f32_32x32x16_bf16 v[96:111], v[216:219], v[152:155], v[96:111]
    v_exp_f32 v120, v120
    v_exp_f32 v121, v121
    v_exp_f32 v122, v122
    v_exp_f32 v123, v123
    v_cvt_pk_bf16_f32 v146, v116, v117
    v_cvt_pk_bf16_f32 v147, v118, v119
    v_mfma_f32_32x32x16_bf16 v[96:111], v[220:223], v[156:159], v[96:111]
    buffer_load_dwordx4 v[216:219], v1, s[52:55], s21 offen offset:2048 sc1
    buffer_load_dwordx4 v[220:223], v1, s[52:55], s21 offen offset:3072 sc1
    v_exp_f32 v124, v124
    v_exp_f32 v125, v125
    v_exp_f32 v126, v126
    v_exp_f32 v127, v127
    v_cvt_pk_bf16_f32 v148, v120, v121
    v_cvt_pk_bf16_f32 v149, v122, v123
    v_cvt_pk_bf16_f32 v150, v124, v125
    v_cvt_pk_bf16_f32 v151, v126, v127
    v_mfma_f32_32x32x16_bf16 v[112:127], v[160:163], v[32:35], 0
    v_exp_f32 v128, v128
    v_exp_f32 v129, v129
    v_exp_f32 v130, v130
    v_exp_f32 v131, v131
    v_mfma_f32_32x32x16_bf16 v[112:127], v[164:167], v[36:39], v[112:127]
    v_exp_f32 v132, v132
    v_exp_f32 v133, v133
    v_exp_f32 v134, v134
    v_exp_f32 v135, v135
    v_cvt_pk_bf16_f32 v152, v128, v129
    v_cvt_pk_bf16_f32 v153, v130, v131
    s_waitcnt vmcnt(12)
    v_mfma_f32_32x32x16_bf16 v[48:63], v[168:171], v[144:147], v[48:63]
    v_exp_f32 v136, v136
    v_exp_f32 v137, v137
    v_exp_f32 v138, v138
    v_exp_f32 v139, v139
    v_cvt_pk_bf16_f32 v154, v132, v133
    v_cvt_pk_bf16_f32 v155, v134, v135
    v_mfma_f32_32x32x16_bf16 v[48:63], v[172:175], v[148:151], v[48:63]
    v_exp_f32 v140, v140
    v_exp_f32 v141, v141
    v_exp_f32 v142, v142
    v_exp_f32 v143, v143
    v_cvt_pk_bf16_f32 v156, v136, v137
    v_cvt_pk_bf16_f32 v157, v138, v139
    v_cvt_pk_bf16_f32 v158, v140, v141
    v_cvt_pk_bf16_f32 v159, v142, v143
    v_mfma_f32_32x32x16_bf16 v[128:143], v[160:163], v[40:43], 0
    s_add_u32 s20, s20, 4096
    s_and_b32 s20, s20, 0xffff
    s_add_u32 s21, s20, s22
    v_exp_f32 v112, v112
    v_exp_f32 v113, v113
    v_exp_f32 v114, v114
    v_exp_f32 v115, v115
    v_mfma_f32_32x32x16_bf16 v[128:143], v[164:167], v[44:47], v[128:143]
    buffer_load_dwordx4 v[160:163], v1, s[52:55], s21 offen offset:0 sc1
    buffer_load_dwordx4 v[164:167], v1, s[52:55], s21 offen offset:1024 sc1
    v_exp_f32 v116, v116
    v_exp_f32 v117, v117
    v_exp_f32 v118, v118
    v_exp_f32 v119, v119
    v_cvt_pk_bf16_f32 v144, v112, v113
    v_cvt_pk_bf16_f32 v145, v114, v115
    v_mfma_f32_32x32x16_bf16 v[64:79], v[168:171], v[152:155], v[64:79]
    v_exp_f32 v120, v120
    v_exp_f32 v121, v121
    v_exp_f32 v122, v122
    v_exp_f32 v123, v123
    v_cvt_pk_bf16_f32 v146, v116, v117
    v_cvt_pk_bf16_f32 v147, v118, v119
    v_mfma_f32_32x32x16_bf16 v[64:79], v[172:175], v[156:159], v[64:79]
    v_exp_f32 v124, v124
    v_exp_f32 v125, v125
    v_exp_f32 v126, v126
    v_exp_f32 v127, v127
    v_cvt_pk_bf16_f32 v148, v120, v121
    v_cvt_pk_bf16_f32 v149, v122, v123
    v_cvt_pk_bf16_f32 v150, v124, v125
    v_cvt_pk_bf16_f32 v151, v126, v127
    s_waitcnt vmcnt(12)
    v_mfma_f32_32x32x16_bf16 v[112:127], v[176:179], v[16:19], 0
    v_exp_f32 v128, v128
    v_exp_f32 v129, v129
    v_exp_f32 v130, v130
    v_exp_f32 v131, v131
    v_mfma_f32_32x32x16_bf16 v[112:127], v[180:183], v[20:23], v[112:127]
    v_exp_f32 v132, v132
    v_exp_f32 v133, v133
    v_exp_f32 v134, v134
    v_exp_f32 v135, v135
    v_cvt_pk_bf16_f32 v152, v128, v129
    v_cvt_pk_bf16_f32 v153, v130, v131
    v_mfma_f32_32x32x16_bf16 v[80:95], v[168:171], v[144:147], v[80:95]
    v_exp_f32 v136, v136
    v_exp_f32 v137, v137
    v_exp_f32 v138, v138
    v_exp_f32 v139, v139
    v_cvt_pk_bf16_f32 v154, v132, v133
    v_cvt_pk_bf16_f32 v155, v134, v135
    v_mfma_f32_32x32x16_bf16 v[80:95], v[172:175], v[148:151], v[80:95]
    v_exp_f32 v140, v140
    v_exp_f32 v141, v141
    v_exp_f32 v142, v142
    v_exp_f32 v143, v143
    v_cvt_pk_bf16_f32 v156, v136, v137
    v_cvt_pk_bf16_f32 v157, v138, v139
    v_cvt_pk_bf16_f32 v158, v140, v141
    v_cvt_pk_bf16_f32 v159, v142, v143
    v_mfma_f32_32x32x16_bf16 v[128:143], v[176:179], v[24:27], 0
    v_exp_f32 v112, v112
    v_exp_f32 v113, v113
    v_exp_f32 v114, v114
    v_exp_f32 v115, v115
    v_mfma_f32_32x32x16_bf16 v[128:143], v[180:183], v[28:31], v[128:143]
    v_exp_f32 v116, v116
    v_exp_f32 v117, v117
    v_exp_f32 v118, v118
    v_exp_f32 v119, v119
    v_cvt_pk_bf16_f32 v144, v112, v113
    v_cvt_pk_bf16_f32 v145, v114, v115
    v_mfma_f32_32x32x16_bf16 v[96:111], v[168:171], v[152:155], v[96:111]
    v_exp_f32 v120, v120
    v_exp_f32 v121, v121
    v_exp_f32 v122, v122
    v_exp_f32 v123, v123
    v_cvt_pk_bf16_f32 v146, v116, v117
    v_cvt_pk_bf16_f32 v147, v118, v119
    v_mfma_f32_32x32x16_bf16 v[96:111], v[172:175], v[156:159], v[96:111]
    buffer_load_dwordx4 v[168:171], v1, s[52:55], s21 offen offset:2048 sc1
    buffer_load_dwordx4 v[172:175], v1, s[52:55], s21 offen offset:3072 sc1
    v_exp_f32 v124, v124
    v_exp_f32 v125, v125
    v_exp_f32 v126, v126
    v_exp_f32 v127, v127
    v_cvt_pk_bf16_f32 v148, v120, v121
    v_cvt_pk_bf16_f32 v149, v122, v123
    v_cvt_pk_bf16_f32 v150, v124, v125
    v_cvt_pk_bf16_f32 v151, v126, v127
    v_mfma_f32_32x32x16_bf16 v[112:127], v[176:179], v[32:35], 0
    v_exp_f32 v128, v128
    v_exp_f32 v129, v129
    v_exp_f32 v130, v130
    v_exp_f32 v131, v131
    v_mfma_f32_32x32x16_bf16 v[112:127], v[180:183], v[36:39], v[112:127]
    v_exp_f32 v132, v132
    v_exp_f32 v133, v133
    v_exp_f32 v134, v134
    v_exp_f32 v135, v135
    v_cvt_pk_bf16_f32 v152, v128, v129
    v_cvt_pk_bf16_f32 v153, v130, v131
    s_waitcnt vmcnt(12)
    v_mfma_f32_32x32x16_bf16 v[48:63], v[184:187], v[144:147], v[48:63]
    v_exp_f32 v136, v136
    v_exp_f32 v137, v137
    v_exp_f32 v138, v138
    v_exp_f32 v139, v139
    v_cvt_pk_bf16_f32 v154, v132, v133
    v_cvt_pk_bf16_f32 v155, v134, v135
    v_mfma_f32_32x32x16_bf16 v[48:63], v[188:191], v[148:151], v[48:63]
    v_exp_f32 v140, v140
    v_exp_f32 v141, v141
    v_exp_f32 v142, v142
    v_exp_f32 v143, v143
    v_cvt_pk_bf16_f32 v156, v136, v137
    v_cvt_pk_bf16_f32 v157, v138, v139
    v_cvt_pk_bf16_f32 v158, v140, v141
    v_cvt_pk_bf16_f32 v159, v142, v143
    v_mfma_f32_32x32x16_bf16 v[128:143], v[176:179], v[40:43], 0
    s_add_u32 s20, s20, 4096
    s_and_b32 s20, s20, 0xffff
    s_add_u32 s21, s20, s22
    v_exp_f32 v112, v112
    v_exp_f32 v113, v113
    v_exp_f32 v114, v114
    v_exp_f32 v115, v115
    v_mfma_f32_32x32x16_bf16 v[128:143], v[180:183], v[44:47], v[128:143]
    buffer_load_dwordx4 v[176:179], v1, s[52:55], s21 offen offset:0 sc1
    buffer_load_dwordx4 v[180:183], v1, s[52:55], s21 offen offset:1024 sc1
    v_exp_f32 v116, v116
    v_exp_f32 v117, v117
    v_exp_f32 v118, v118
    v_exp_f32 v119, v119
    v_cvt_pk_bf16_f32 v144, v112, v113
    v_cvt_pk_bf16_f32 v145, v114, v115
    v_mfma_f32_32x32x16_bf16 v[64:79], v[184:187], v[152:155], v[64:79]
    v_exp_f32 v120, v120
    v_exp_f32 v121, v121
    v_exp_f32 v122, v122
    v_exp_f32 v123, v123
    v_cvt_pk_bf16_f32 v146, v116, v117
    v_cvt_pk_bf16_f32 v147, v118, v119
    v_mfma_f32_32x32x16_bf16 v[64:79], v[188:191], v[156:159], v[64:79]
    v_exp_f32 v124, v124
    v_exp_f32 v125, v125
    v_exp_f32 v126, v126
    v_exp_f32 v127, v127
    v_cvt_pk_bf16_f32 v148, v120, v121
    v_cvt_pk_bf16_f32 v149, v122, v123
    v_cvt_pk_bf16_f32 v150, v124, v125
    v_cvt_pk_bf16_f32 v151, v126, v127
    s_waitcnt vmcnt(12)
    v_mfma_f32_32x32x16_bf16 v[112:127], v[192:195], v[16:19], 0
    v_exp_f32 v128, v128
    v_exp_f32 v129, v129
    v_exp_f32 v130, v130
    v_exp_f32 v131, v131
    v_mfma_f32_32x32x16_bf16 v[112:127], v[196:199], v[20:23], v[112:127]
    v_exp_f32 v132, v132
    v_exp_f32 v133, v133
    v_exp_f32 v134, v134
    v_exp_f32 v135, v135
    v_cvt_pk_bf16_f32 v152, v128, v129
    v_cvt_pk_bf16_f32 v153, v130, v131
    v_mfma_f32_32x32x16_bf16 v[80:95], v[184:187], v[144:147], v[80:95]
    v_exp_f32 v136, v136
    v_exp_f32 v137, v137
    v_exp_f32 v138, v138
    v_exp_f32 v139, v139
    v_cvt_pk_bf16_f32 v154, v132, v133
    v_cvt_pk_bf16_f32 v155, v134, v135
    v_mfma_f32_32x32x16_bf16 v[80:95], v[188:191], v[148:151], v[80:95]
    v_exp_f32 v140, v140
    v_exp_f32 v141, v141
    v_exp_f32 v142, v142
    v_exp_f32 v143, v143
    v_cvt_pk_bf16_f32 v156, v136, v137
    v_cvt_pk_bf16_f32 v157, v138, v139
    v_cvt_pk_bf16_f32 v158, v140, v141
    v_cvt_pk_bf16_f32 v159, v142, v143
    v_mfma_f32_32x32x16_bf16 v[128:143], v[192:195], v[24:27], 0
    v_exp_f32 v112, v112
    v_exp_f32 v113, v113
    v_exp_f32 v114, v114
    v_exp_f32 v115, v115
    v_mfma_f32_32x32x16_bf16 v[128:143], v[196:199], v[28:31], v[128:143]
    v_exp_f32 v116, v116
    v_exp_f32 v117, v117
    v_exp_f32 v118, v118
    v_exp_f32 v119, v119
    v_cvt_pk_bf16_f32 v144, v112, v113
    v_cvt_pk_bf16_f32 v145, v114, v115
    v_mfma_f32_32x32x16_bf16 v[96:111], v[184:187], v[152:155], v[96:111]
    v_exp_f32 v120, v120
    v_exp_f32 v121, v121
    v_exp_f32 v122, v122
    v_exp_f32 v123, v123
    v_cvt_pk_bf16_f32 v146, v116, v117
    v_cvt_pk_bf16_f32 v147, v118, v119
    v_mfma_f32_32x32x16_bf16 v[96:111], v[188:191], v[156:159], v[96:111]
    buffer_load_dwordx4 v[184:187], v1, s[52:55], s21 offen offset:2048 sc1
    buffer_load_dwordx4 v[188:191], v1, s[52:55], s21 offen offset:3072 sc1
    v_exp_f32 v124, v124
    v_exp_f32 v125, v125
    v_exp_f32 v126, v126
    v_exp_f32 v127, v127
    v_cvt_pk_bf16_f32 v148, v120, v121
    v_cvt_pk_bf16_f32 v149, v122, v123
    v_cvt_pk_bf16_f32 v150, v124, v125
    v_cvt_pk_bf16_f32 v151, v126, v127
    v_mfma_f32_32x32x16_bf16 v[112:127], v[192:195], v[32:35], 0
    v_exp_f32 v128, v128
    v_exp_f32 v129, v129
    v_exp_f32 v130, v130
    v_exp_f32 v131, v131
    v_mfma_f32_32x32x16_bf16 v[112:127], v[196:199], v[36:39], v[112:127]
    v_exp_f32 v132, v132
    v_exp_f32 v133, v133
    v_exp_f32 v134, v134
    v_exp_f32 v135, v135
    v_cvt_pk_bf16_f32 v152, v128, v129
    v_cvt_pk_bf16_f32 v153, v130, v131
    s_waitcnt vmcnt(12)
    v_mfma_f32_32x32x16_bf16 v[48:63], v[200:203], v[144:147], v[48:63]
    v_exp_f32 v136, v136
    v_exp_f32 v137, v137
    v_exp_f32 v138, v138
    v_exp_f32 v139, v139
    v_cvt_pk_bf16_f32 v154, v132, v133
    v_cvt_pk_bf16_f32 v155, v134, v135
    v_mfma_f32_32x32x16_bf16 v[48:63], v[204:207], v[148:151], v[48:63]
    v_exp_f32 v140, v140
    v_exp_f32 v141, v141
    v_exp_f32 v142, v142
    v_exp_f32 v143, v143
    v_cvt_pk_bf16_f32 v156, v136, v137
    v_cvt_pk_bf16_f32 v157, v138, v139
    v_cvt_pk_bf16_f32 v158, v140, v141
    v_cvt_pk_bf16_f32 v159, v142, v143
    v_mfma_f32_32x32x16_bf16 v[128:143], v[192:195], v[40:43], 0
    s_add_u32 s20, s20, 4096
    s_and_b32 s20, s20, 0xffff
    s_add_u32 s21, s20, s22
    v_exp_f32 v112, v112
    v_exp_f32 v113, v113
    v_exp_f32 v114, v114
    v_exp_f32 v115, v115
    v_mfma_f32_32x32x16_bf16 v[128:143], v[196:199], v[44:47], v[128:143]
    buffer_load_dwordx4 v[192:195], v1, s[52:55], s21 offen offset:0 sc1
    buffer_load_dwordx4 v[196:199], v1, s[52:55], s21 offen offset:1024 sc1
    v_exp_f32 v116, v116
    v_exp_f32 v117, v117
    v_exp_f32 v118, v118
    v_exp_f32 v119, v119
    v_cvt_pk_bf16_f32 v144, v112, v113
    v_cvt_pk_bf16_f32 v145, v114, v115
    v_mfma_f32_32x32x16_bf16 v[64:79], v[200:203], v[152:155], v[64:79]
    v_exp_f32 v120, v120
    v_exp_f32 v121, v121
    v_exp_f32 v122, v122
    v_exp_f32 v123, v123
    v_cvt_pk_bf16_f32 v146, v116, v117
    v_cvt_pk_bf16_f32 v147, v118, v119
    v_mfma_f32_32x32x16_bf16 v[64:79], v[204:207], v[156:159], v[64:79]
    v_exp_f32 v124, v124
    v_exp_f32 v125, v125
    v_exp_f32 v126, v126
    v_exp_f32 v127, v127
    v_cvt_pk_bf16_f32 v148, v120, v121
    v_cvt_pk_bf16_f32 v149, v122, v123
    v_cvt_pk_bf16_f32 v150, v124, v125
    v_cvt_pk_bf16_f32 v151, v126, v127
    s_waitcnt vmcnt(12)
    v_mfma_f32_32x32x16_bf16 v[112:127], v[208:211], v[16:19], 0
    v_exp_f32 v128, v128
    v_exp_f32 v129, v129
    v_exp_f32 v130, v130
    v_exp_f32 v131, v131
    v_mfma_f32_32x32x16_bf16 v[112:127], v[212:215], v[20:23], v[112:127]
    v_exp_f32 v132, v132
    v_exp_f32 v133, v133
    v_exp_f32 v134, v134
    v_exp_f32 v135, v135
    v_cvt_pk_bf16_f32 v152, v128, v129
    v_cvt_pk_bf16_f32 v153, v130, v131
    v_mfma_f32_32x32x16_bf16 v[80:95], v[200:203], v[144:147], v[80:95]
    v_exp_f32 v136, v136
    v_exp_f32 v137, v137
    v_exp_f32 v138, v138
    v_exp_f32 v139, v139
    v_cvt_pk_bf16_f32 v154, v132, v133
    v_cvt_pk_bf16_f32 v155, v134, v135
    v_mfma_f32_32x32x16_bf16 v[80:95], v[204:207], v[148:151], v[80:95]
    v_exp_f32 v140, v140
    v_exp_f32 v141, v141
    v_exp_f32 v142, v142
    v_exp_f32 v143, v143
    v_cvt_pk_bf16_f32 v156, v136, v137
    v_cvt_pk_bf16_f32 v157, v138, v139
    v_cvt_pk_bf16_f32 v158, v140, v141
    v_cvt_pk_bf16_f32 v159, v142, v143
    v_mfma_f32_32x32x16_bf16 v[128:143], v[208:211], v[24:27], 0
    v_exp_f32 v112, v112
    v_exp_f32 v113, v113
    v_exp_f32 v114, v114
    v_exp_f32 v115, v115
    v_mfma_f32_32x32x16_bf16 v[128:143], v[212:215], v[28:31], v[128:143]
    v_exp_f32 v116, v116
    v_exp_f32 v117, v117
    v_exp_f32 v118, v118
    v_exp_f32 v119, v119
    v_cvt_pk_bf16_f32 v144, v112, v113
    v_cvt_pk_bf16_f32 v145, v114, v115
    v_mfma_f32_32x32x16_bf16 v[96:111], v[200:203], v[152:155], v[96:111]
    v_exp_f32 v120, v120
    v_exp_f32 v121, v121
    v_exp_f32 v122, v122
    v_exp_f32 v123, v123
    v_cvt_pk_bf16_f32 v146, v116, v117
    v_cvt_pk_bf16_f32 v147, v118, v119
    v_mfma_f32_32x32x16_bf16 v[96:111], v[204:207], v[156:159], v[96:111]
    buffer_load_dwordx4 v[200:203], v1, s[52:55], s21 offen offset:2048 sc1
    buffer_load_dwordx4 v[204:207], v1, s[52:55], s21 offen offset:3072 sc1
    v_exp_f32 v124, v124
    v_exp_f32 v125, v125
    v_exp_f32 v126, v126
    v_exp_f32 v127, v127
    v_cvt_pk_bf16_f32 v148, v120, v121
    v_cvt_pk_bf16_f32 v149, v122, v123
    v_cvt_pk_bf16_f32 v150, v124, v125
    v_cvt_pk_bf16_f32 v151, v126, v127
    v_mfma_f32_32x32x16_bf16 v[112:127], v[208:211], v[32:35], 0
    v_exp_f32 v128, v128
    v_exp_f32 v129, v129
    v_exp_f32 v130, v130
    v_exp_f32 v131, v131
    v_mfma_f32_32x32x16_bf16 v[112:127], v[212:215], v[36:39], v[112:127]
    v_exp_f32 v132, v132
    v_exp_f32 v133, v133
    v_exp_f32 v134, v134
    v_exp_f32 v135, v135
    v_cvt_pk_bf16_f32 v152, v128, v129
    v_cvt_pk_bf16_f32 v153, v130, v131
    s_waitcnt vmcnt(12)
    v_mfma_f32_32x32x16_bf16 v[48:63], v[216:219], v[144:147], v[48:63]
    v_exp_f32 v136, v136
    v_exp_f32 v137, v137
    v_exp_f32 v138, v138
    v_exp_f32 v139, v139
    v_cvt_pk_bf16_f32 v154, v132, v133
    v_cvt_pk_bf16_f32 v155, v134, v135
    v_mfma_f32_32x32x16_bf16 v[48:63], v[220:223], v[148:151], v[48:63]
    v_exp_f32 v140, v140
    v_exp_f32 v141, v141
    v_exp_f32 v142, v142
    v_exp_f32 v143, v143
    v_cvt_pk_bf16_f32 v156, v136, v137
    v_cvt_pk_bf16_f32 v157, v138, v139
    v_cvt_pk_bf16_f32 v158, v140, v141
    v_cvt_pk_bf16_f32 v159, v142, v143
    v_mfma_f32_32x32x16_bf16 v[128:143], v[208:211], v[40:43], 0
    s_add_u32 s20, s20, 4096
    s_and_b32 s20, s20, 0xffff
    s_add_u32 s21, s20, s22
    v_exp_f32 v112, v112
    v_exp_f32 v113, v113
    v_exp_f32 v114, v114
    v_exp_f32 v115, v115
    v_mfma_f32_32x32x16_bf16 v[128:143], v[212:215], v[44:47], v[128:143]
    buffer_load_dwordx4 v[208:211], v1, s[52:55], s21 offen offset:0 sc1
    buffer_load_dwordx4 v[212:215], v1, s[52:55], s21 offen offset:1024 sc1
    v_exp_f32 v116, v116
    v_exp_f32 v117, v117
    v_exp_f32 v118, v118
    v_exp_f32 v119, v119
    v_cvt_pk_bf16_f32 v144, v112, v113
    v_cvt_pk_bf16_f32 v145, v114, v115
    v_mfma_f32_32x32x16_bf16 v[64:79], v[216:219], v[152:155], v[64:79]
    v_exp_f32 v120, v120
    v_exp_f32 v121, v121
    v_exp_f32 v122, v122
    v_exp_f32 v123, v123
    v_cvt_pk_bf16_f32 v146, v116, v117
    v_cvt_pk_bf16_f32 v147, v118, v119
    v_mfma_f32_32x32x16_bf16 v[64:79], v[220:223], v[156:159], v[64:79]
    v_exp_f32 v124, v124
    v_exp_f32 v125, v125
    v_exp_f32 v126, v126
    v_exp_f32 v127, v127
    v_cvt_pk_bf16_f32 v148, v120, v121
    v_cvt_pk_bf16_f32 v149, v122, v123
    v_cvt_pk_bf16_f32 v150, v124, v125
    v_cvt_pk_bf16_f32 v151, v126, v127
    s_waitcnt vmcnt(12)
    v_mfma_f32_32x32x16_bf16 v[112:127], v[160:163], v[16:19], 0
    v_exp_f32 v128, v128
    v_exp_f32 v129, v129
    v_exp_f32 v130, v130
    v_exp_f32 v131, v131
    v_mfma_f32_32x32x16_bf16 v[112:127], v[164:167], v[20:23], v[112:127]
    v_exp_f32 v132, v132
    v_exp_f32 v133, v133
    v_exp_f32 v134, v134
    v_exp_f32 v135, v135
    v_cvt_pk_bf16_f32 v152, v128, v129
    v_cvt_pk_bf16_f32 v153, v130, v131
    v_mfma_f32_32x32x16_bf16 v[80:95], v[216:219], v[144:147], v[80:95]
    v_exp_f32 v136, v136
    v_exp_f32 v137, v137
    v_exp_f32 v138, v138
    v_exp_f32 v139, v139
    v_cvt_pk_bf16_f32 v154, v132, v133
    v_cvt_pk_bf16_f32 v155, v134, v135
    v_mfma_f32_32x32x16_bf16 v[80:95], v[220:223], v[148:151], v[80:95]
    v_exp_f32 v140, v140
    v_exp_f32 v141, v141
    v_exp_f32 v142, v142
    v_exp_f32 v143, v143
    v_cvt_pk_bf16_f32 v156, v136, v137
    v_cvt_pk_bf16_f32 v157, v138, v139
    s_sub_u32 s25, s25, 1
    s_cmp_lg_u32 s25, 0
    v_cvt_pk_bf16_f32 v158, v140, v141
    v_cvt_pk_bf16_f32 v159, v142, v143
    s_cbranch_scc1 K2_LOOP
    s_setprio 3
    v_mfma_f32_32x32x16_bf16 v[96:111], v[216:219], v[152:155], v[96:111]
    v_mfma_f32_32x32x16_bf16 v[96:111], v[220:223], v[156:159], v[96:111]
    v_and_b32 v8, 0x1fff, v14
    v_lshl_or_b32 v8, v8, 16, s19
    v_or_b32 v8, s24, v8
    v_add_u32 v2, s18, v1
    s_add_u32 s6, s62, 1
    s_and_b32 s6, s6, 3
    s_mul_i32 s6, s6, 12288
    v_add_u32 v3, s6, v2
    ds_write_b128 v3, v[64:67] offset:0
    ds_write_b128 v3, v[68:71] offset:1024
    ds_write_b128 v3, v[72:75] offset:2048
    ds_write_b128 v3, v[76:79] offset:3072
    s_mov_b64 exec, 1
    ds_write_b32 v3, v8 offset:4092
    s_mov_b64 exec, -1
    s_add_u32 s6, s62, 2
    s_and_b32 s6, s6, 3
    s_mul_i32 s6, s6, 12288
    v_add_u32 v3, s6, v2
    ds_write_b128 v3, v[80:83] offset:4096
    ds_write_b128 v3, v[84:87] offset:5120
    ds_write_b128 v3, v[88:91] offset:6144
    ds_write_b128 v3, v[92:95] offset:7168
    s_mov_b64 exec, 1
    ds_write_b32 v3, v8 offset:8188
    s_mov_b64 exec, -1
    s_add_u32 s6, s62, 3
    s_and_b32 s6, s6, 3
    s_mul_i32 s6, s6, 12288
    v_add_u32 v3, s6, v2
    ds_write_b128 v3, v[96:99] offset:8192
    ds_write_b128 v3, v[100:103] offset:9216
    ds_write_b128 v3, v[104:107] offset:10240
    ds_write_b128 v3, v[108:111] offset:11264
    s_mov_b64 exec, 1
    ds_write_b32 v3, v8 offset:12284
    s_mov_b64 exec, -1
    s_mul_i32 s6, s62, 12288
    v_add_u32 v3, s6, v2
    s_add_u32 s6, s6, s18
    v_min_u32 v9, 2, v0
    v_lshl_add_u32 v9, v9, 12, s6
    s_mov_b32 s4, 1600000
K2_RQ:
    ds_read_b32 v6, v9 offset:4092
    s_sub_u32 s4, s4, 1
    s_waitcnt lgkmcnt(0)
    v_cmp_ne_u32 vcc, v6, v8
    s_cmp_eq_u32 s4, 0
    s_cbranch_scc1 K2_RE
    s_cmp_lg_u64 vcc, 0
    s_cbranch_scc1 K2_RQ
K2_RE:
    ds_read_b128 v[64:67], v3 offset:0
    ds_read_b128 v[68:71], v3 offset:1024
    ds_read_b128 v[72:75], v3 offset:2048
    ds_read_b128 v[76:79], v3 offset:3072
    ds_read_b128 v[80:83], v3 offset:4096
    ds_read_b128 v[84:87], v3 offset:5120
    ds_read_b128 v[88:91], v3 offset:6144
    ds_read_b128 v[92:95], v3 offset:7168
    ds_read_b128 v[96:99], v3 offset:8192
    ds_read_b128 v[100:103], v3 offset:9216
    ds_read_b128 v[104:107], v3 offset:10240
    ds_read_b128 v[108:111], v3 offset:11264
    s_lshl_b32 s6, s60, 2
    s_add_u32 s6, s6, s62
    s_mul_i32 s6, s6, 144
    s_lshl_b32 s7, s61, 1
    s_add_u32 s6, s6, s7
    s_lshl_b32 s6, s6, 10
    s_add_u32 s6, s6, 4308992
    s_waitcnt lgkmcnt(8)
    v_add_f32 v48, v48, v64
    v_add_f32 v49, v49, v65
    v_add_f32 v50, v50, v66
    v_add_f32 v51, v51, v67
    v_add_f32 v52, v52, v68
    v_add_f32 v53, v53, v69
    v_add_f32 v54, v54, v70
    v_add_f32 v55, v55, v71
    v_add_f32 v56, v56, v72
    v_add_f32 v57, v57, v73
    v_add_f32 v58, v58, v74
    v_add_f32 v59, v59, v75
    v_add_f32 v60, v60, v76
    v_add_f32 v61, v61, v77
    v_add_f32 v62, v62, v78
    v_add_f32 v63, v63, v79
    s_waitcnt lgkmcnt(4)
    v_add_f32 v48, v48, v80
    v_add_f32 v49, v49, v81
    v_add_f32 v50, v50, v82
    v_add_f32 v51, v51, v83
    v_add_f32 v52, v52, v84
    v_add_f32 v53, v53, v85
    v_add_f32 v54, v54, v86
    v_add_f32 v55, v55, v87
    v_add_f32 v56, v56, v88
    v_add_f32 v57, v57, v89
    v_add_f32 v58, v58, v90
    v_add_f32 v59, v59, v91
    v_add_f32 v60, v60, v92
    v_add_f32 v61, v61, v93
    v_add_f32 v62, v62, v94
    v_add_f32 v63, v63, v95
    s_waitcnt lgkmcnt(0)
    v_add_f32 v48, v48, v96
    v_add_f32 v49, v49, v97
    v_add_f32 v50, v50, v98
    v_add_f32 v51, v51, v99
    v_add_f32 v52, v52, v100
    v_add_f32 v53, v53, v101
    v_add_f32 v54, v54, v102
    v_add_f32 v55, v55, v103
    v_add_f32 v56, v56, v104
    v_add_f32 v57, v57, v105
    v_add_f32 v58, v58, v106
    v_add_f32 v59, v59, v107
    v_add_f32 v60, v60, v108
    v_add_f32 v61, v61, v109
    v_add_f32 v62, v62, v110
    v_add_f32 v63, v63, v111
    v_mov_b32 v4, v60
    v_mov_b32 v5, v60
    v_mul_f32 v6, 0, v48
    s_nop 0
    v_permlane32_swap_b32 v4, v5
    v_rcp_f32 v5, v5
    v_fmac_f32 v6, 0, v49
    v_fmac_f32 v6, 0, v50
    v_fmac_f32 v6, 0, v51
    v_fmac_f32 v6, 0, v52
    v_fmac_f32 v6, 0, v53
    v_fmac_f32 v6, 0, v54
    v_fmac_f32 v6, 0, v55
    v_fmac_f32 v6, 0, v56
    v_fmac_f32 v6, 0, v57
    v_fmac_f32 v6, 0, v58
    v_fmac_f32 v6, 0, v59
    v_fmac_f32 v6, 0, v60
    v_fmac_f32 v6, 0, v61
    v_fmac_f32 v6, 0, v62
    v_fmac_f32 v6, 0, v63
    v_mul_f32 v4, 0x5f800000, v5
    v_fmac_f32 v6, 0, v4
    v_cndmask_b32 v60, v60, v55, s[30:31]
    v_and_b32 v7, 0x1fff, v14
    v_permlane32_swap_b32 v62, v63
    v_permlane32_swap_b32 v61, v55
    v_lshl_or_b32 v7, v7, 16, s19
    v_mul_f32 v48, v5, v48
    v_mul_f32 v49, v5, v49
    v_mul_f32 v50, v5, v50
    v_mul_f32 v51, v5, v51
    v_mul_f32 v52, v5, v52
    v_mul_f32 v53, v5, v53
    v_mul_f32 v54, v5, v54
    v_mul_f32 v56, v5, v56
    v_mul_f32 v57, v5, v57
    v_mul_f32 v58, v5, v58
    v_mul_f32 v59, v5, v59
    v_mul_f32 v60, v5, v60
    v_mul_f32 v61, v5, v61
    v_mul_f32 v62, v5, v62
    v_cvt_pk_bf16_f32 v48, v48, v49
    v_cvt_pk_bf16_f32 v49, v50, v51
    v_cvt_pk_bf16_f32 v50, v52, v53
    v_cvt_pk_bf16_f32 v51, v54, v7
    v_cvt_pk_bf16_f32 v52, v56, v57
    v_cvt_pk_bf16_f32 v53, v58, v59
    v_cvt_pk_bf16_f32 v54, v60, v61
    v_cvt_pk_bf16_f32 v55, v62, v7
    v_cmp_u_f32 vcc, v6, v6
    s_nop 0
    s_cmp_lg_u64 vcc, 0
    s_cselect_b32 s5, 1, 0
    s_andn2_b32 s5, s5, s24
    s_mul_i32 s4, s62, 12288
    s_add_u32 s4, s4, s18
    v_mov_b32 v3, s4
    v_mov_b32 v4, s5
    ds_write_b32 v3, v4
    s_or_b32 s4, s5, s27
    s_cmp_lg_u32 s4, 0
    s_cbranch_scc1 K2_OK
    buffer_store_dwordx4 v[48:51], v1, s[52:55], s6 offen sc1
    buffer_store_dwordx4 v[52:55], v1, s[52:55], s6 offen offset:1024 sc1
    s_mov_b32 s27, 1
K2_OK:
    s_waitcnt lgkmcnt(0)
    s_barrier
    v_and_b32 v3, 3, v0
    v_mul_u32_u24 v3, 12288, v3
    v_add_u32 v3, s18, v3
    ds_read_b32 v4, v3
    s_waitcnt lgkmcnt(0)
    v_cmp_ne_u32 vcc, 0, v4
    s_nop 0
    s_cmp_eq_u64 vcc, 0
    s_cbranch_scc1 K2_END
    s_mov_b32 s24, 1
    s_mov_b32 s25, 16
    s_mov_b32 s21, s22
    s_waitcnt vmcnt(0)
    v_cndmask_b32 v22, v22, 0, s[30:31]
    v_cndmask_b32 v23, v23, 0, s[30:31]
    v_mov_b32 v4, 0xff800000
    v_cndmask_b32 v30, v30, 0, s[30:31]
    v_cndmask_b32 v31, v31, 0, s[30:31]
    v_mov_b32 v5, 0xff800000
    v_cndmask_b32 v38, v38, 0, s[30:31]
    v_cndmask_b32 v39, v39, 0, s[30:31]
    v_mov_b32 v6, 0xff800000
    v_cndmask_b32 v46, v46, 0, s[30:31]
    v_cndmask_b32 v47, v47, 0, s[30:31]
    v_mov_b32 v7, 0xff800000
    s_nop 4
K2_MAXLOOP:
    buffer_load_dwordx4 v[160:163], v1, s[52:55], s21 offen offset:0 sc1
    buffer_load_dwordx4 v[164:167], v1, s[52:55], s21 offen offset:1024 sc1
    s_add_u32 s21, s21, 4096
    s_waitcnt vmcnt(0)
    v_mfma_f32_32x32x16_bf16 v[48:63], v[160:163], v[16:19], 0
    v_mfma_f32_32x32x16_bf16 v[48:63], v[164:167], v[20:23], v[48:63]
    v_mfma_f32_32x32x16_bf16 v[64:79], v[160:163], v[24:27], 0
    v_mfma_f32_32x32x16_bf16 v[64:79], v[164:167], v[28:31], v[64:79]
    v_mfma_f32_32x32x16_bf16 v[80:95], v[160:163], v[32:35], 0
    v_mfma_f32_32x32x16_bf16 v[80:95], v[164:167], v[36:39], v[80:95]
    v_mfma_f32_32x32x16_bf16 v[96:111], v[160:163], v[40:43], 0
    v_mfma_f32_32x32x16_bf16 v[96:111], v[164:167], v[44:47], v[96:111]
    s_nop 5
    v_max3_f32 v4, v4, v48, v49
    v_max3_f32 v4, v4, v50, v51
    v_max3_f32 v4, v4, v52, v53
    v_max3_f32 v4, v4, v54, v55
    v_max3_f32 v4, v4, v56, v57
    v_max3_f32 v4, v4, v58, v59
    v_max3_f32 v4, v4, v60, v61
    v_max3_f32 v4, v4, v62, v63
    v_max3_f32 v5, v5, v64, v65
    v_max3_f32 v5, v5, v66, v67
    v_max3_f32 v5, v5, v68, v69
    v_max3_f32 v5, v5, v70, v71
    v_max3_f32 v5, v5, v72, v73
    v_max3_f32 v5, v5, v74, v75
    v_max3_f32 v5, v5, v76, v77
    v_max3_f32 v5, v5, v78, v79
    v_max3_f32 v6, v6, v80, v81
    v_max3_f32 v6, v6, v82, v83
    v_max3_f32 v6, v6, v84, v85
    v_max3_f32 v6, v6, v86, v87
    v_max3_f32 v6, v6, v88, v89
    v_max3_f32 v6, v6, v90, v91
    v_max3_f32 v6, v6, v92, v93
    v_max3_f32 v6, v6, v94, v95
    v_max3_f32 v7, v7, v96, v97
    v_max3_f32 v7, v7, v98, v99
    v_max3_f32 v7, v7, v100, v101
    v_max3_f32 v7, v7, v102, v103
    v_max3_f32 v7, v7, v104, v105
    v_max3_f32 v7, v7, v106, v107
    v_max3_f32 v7, v7, v108, v109
    v_max3_f32 v7, v7, v110, v111
    s_sub_u32 s25, s25, 1
    s_cmp_lg_u32 s25, 0
    s_nop 2
    s_cbranch_scc1 K2_MAXLOOP
    v_mov_b32 v8, v4
    v_mov_b32 v9, v5
    v_mov_b32 v10, v6
    v_mov_b32 v11, v7
    v_permlane32_swap_b32 v4, v8
    v_permlane32_swap_b32 v5, v9
    v_permlane32_swap_b32 v6, v10
    v_permlane32_swap_b32 v7, v11
    v_max_f32 v4, v4, v8
    v_max_f32 v5, v5, v9
    v_max_f32 v6, v6, v10
    v_max_f32 v7, v7, v11
    v_lshlrev_b32 v12, 2, v0
    s_add_u32 s6, s62, 0
    s_and_b32 s6, s6, 3
    s_lshl_b32 s6, s6, 10
    s_add_u32 s6, s6, 256
    v_add_u32 v8, s6, v12
    s_lshl_b32 s7, s62, 8
    v_add_u32 v13, s7, v8
    ds_write_b32 v13, v4
    s_add_u32 s6, s62, 1
    s_and_b32 s6, s6, 3
    s_lshl_b32 s6, s6, 10
    s_add_u32 s6, s6, 256
    v_add_u32 v9, s6, v12
    s_lshl_b32 s7, s62, 8
    v_add_u32 v13, s7, v9
    ds_write_b32 v13, v5
    s_add_u32 s6, s62, 2
    s_and_b32 s6, s6, 3
    s_lshl_b32 s6, s6, 10
    s_add_u32 s6, s6, 256
    v_add_u32 v10, s6, v12
    s_lshl_b32 s7, s62, 8
    v_add_u32 v13, s7, v10
    ds_write_b32 v13, v6
    s_add_u32 s6, s62, 3
    s_and_b32 s6, s6, 3
    s_lshl_b32 s6, s6, 10
    s_add_u32 s6, s6, 256
    v_add_u32 v11, s6, v12
    s_lshl_b32 s7, s62, 8
    v_add_u32 v13, s7, v11
    ds_write_b32 v13, v7
    s_waitcnt lgkmcnt(0)
    s_barrier
    ds_read_b32 v48, v8 offset:0
    ds_read_b32 v49, v8 offset:256
    ds_read_b32 v50, v8 offset:512
    ds_read_b32 v51, v8 offset:768
    ds_read_b32 v52, v9 offset:0
    ds_read_b32 v53, v9 offset:256
    ds_read_b32 v54, v9 offset:512
    ds_read_b32 v55, v9 offset:768
    ds_read_b32 v56, v10 offset:0
    ds_read_b32 v57, v10 offset:256
    ds_read_b32 v58, v10 offset:512
    ds_read_b32 v59, v10 offset:768
    ds_read_b32 v60, v11 offset:0
    ds_read_b32 v61, v11 offset:256
    ds_read_b32 v62, v11 offset:512
    ds_read_b32 v63, v11 offset:768
    s_waitcnt lgkmcnt(0)
    v_max3_f32 v4, v48, v49, v50
    v_max_f32 v4, v4, v51
    v_max3_f32 v5, v52, v53, v54
    v_max_f32 v5, v5, v55
    v_max3_f32 v6, v56, v57, v58
    v_max_f32 v6, v6, v59
    v_max3_f32 v7, v60, v61, v62
    v_max_f32 v7, v7, v63
    s_mov_b32 s20, s23
    s_add_u32 s21, s20, s22
    buffer_load_dwordx4 v[160:163], v1, s[52:55], s21 offen offset:0 sc1
    buffer_load_dwordx4 v[164:167], v1, s[52:55], s21 offen offset:1024 sc1
    buffer_load_dwordx4 v[168:171], v1, s[52:55], s21 offen offset:2048 sc1
    buffer_load_dwordx4 v[172:175], v1, s[52:55], s21 offen offset:3072 sc1
    s_add_u32 s20, s20, 4096
    s_and_b32 s20, s20, 0xffff
    s_add_u32 s21, s20, s22
    buffer_load_dwordx4 v[176:179], v1, s[52:55], s21 offen offset:0 sc1
    buffer_load_dwordx4 v[180:183], v1, s[52:55], s21 offen offset:1024 sc1
    buffer_load_dwordx4 v[184:187], v1, s[52:55], s21 offen offset:2048 sc1
    buffer_load_dwordx4 v[188:191], v1, s[52:55], s21 offen offset:3072 sc1
    s_add_u32 s20, s20, 4096
    s_and_b32 s20, s20, 0xffff
    s_add_u32 s21, s20, s22
    buffer_load_dwordx4 v[192:195], v1, s[52:55], s21 offen offset:0 sc1
    buffer_load_dwordx4 v[196:199], v1, s[52:55], s21 offen offset:1024 sc1
    buffer_load_dwordx4 v[200:203], v1, s[52:55], s21 offen offset:2048 sc1
    buffer_load_dwordx4 v[204:207], v1, s[52:55], s21 offen offset:3072 sc1
    s_add_u32 s20, s20, 4096
    s_and_b32 s20, s20, 0xffff
    s_add_u32 s21, s20, s22
    buffer_load_dwordx4 v[208:211], v1, s[52:55], s21 offen offset:0 sc1
    buffer_load_dwordx4 v[212:215], v1, s[52:55], s21 offen offset:1024 sc1
    v_mov_b32 v48, 0
    v_mov_b32 v49, 0
    v_mov_b32 v50, 0
    v_mov_b32 v51, 0
    v_mov_b32 v52, 0
    v_mov_b32 v53, 0
    v_mov_b32 v54, 0
    v_mov_b32 v55, 0
    v_mov_b32 v56, 0
    v_mov_b32 v57, 0
    v_mov_b32 v58, 0
    v_mov_b32 v59, 0
    v_mov_b32 v60, 0
    v_mov_b32 v61, 0
    v_mov_b32 v62, 0
    v_mov_b32 v63, 0
    v_mov_b32 v64, 0
    v_mov_b32 v65, 0
    v_mov_b32 v66, 0
    v_mov_b32 v67, 0
    v_mov_b32 v68, 0
    v_mov_b32 v69, 0
    v_mov_b32 v70, 0
    v_mov_b32 v71, 0
    v_mov_b32 v72, 0
    v_mov_b32 v73, 0
    v_mov_b32 v74, 0
    v_mov_b32 v75, 0
    v_mov_b32 v76, 0
    v_mov_b32 v77, 0
    v_mov_b32 v78, 0
    v_mov_b32 v79, 0
    v_mov_b32 v80, 0
    v_mov_b32 v81, 0
    v_mov_b32 v82, 0
    v_mov_b32 v83, 0
    v_mov_b32 v84, 0
    v_mov_b32 v85, 0
    v_mov_b32 v86, 0
    v_mov_b32 v87, 0
    v_mov_b32 v88, 0
    v_mov_b32 v89, 0
    v_mov_b32 v90, 0
    v_mov_b32 v91, 0
    v_mov_b32 v92, 0
    v_mov_b32 v93, 0
    v_mov_b32 v94, 0
    v_mov_b32 v95, 0
    v_mov_b32 v96, 0
    v_mov_b32 v97, 0
    v_mov_b32 v98, 0
    v_mov_b32 v99, 0
    v_mov_b32 v100, 0
    v_mov_b32 v101, 0
    v_mov_b32 v102, 0
    v_mov_b32 v103, 0
    v_mov_b32 v104, 0
    v_mov_b32 v105, 0
    v_mov_b32 v106, 0
    v_mov_b32 v107, 0
    v_mov_b32 v108, 0
    v_mov_b32 v109, 0
    v_mov_b32 v110, 0
    v_mov_b32 v111, 0
    v_mov_b32 v216, 0
    v_mov_b32 v217, 0
    v_mov_b32 v218, 0
    v_mov_b32 v219, 0
    v_mov_b32 v220, 0
    v_mov_b32 v221, 0
    v_mov_b32 v222, 0
    v_mov_b32 v223, 0
    v_cvt_pk_bf16_f32 v8, -v4, -v4
    v_lshlrev_b32 v8, 16, v8
    v_sub_f32 v9, -v4, v8
    v_cvt_pk_bf16_f32 v10, v9, v9
    v_lshlrev_b32 v10, 16, v10
    v_sub_f32 v10, v9, v10
    v_cvt_pk_bf16_f32 v8, -v4, v9
    v_cvt_pk_bf16_f32 v10, v10, 0
    v_cndmask_b32 v22, v22, v8, s[30:31]
    v_cndmask_b32 v23, v23, v10, s[30:31]
    v_cvt_pk_bf16_f32 v8, -v5, -v5
    v_lshlrev_b32 v8, 16, v8
    v_sub_f32 v9, -v5, v8
    v_cvt_pk_bf16_f32 v10, v9, v9
    v_lshlrev_b32 v10, 16, v10
    v_sub_f32 v10, v9, v10
    v_cvt_pk_bf16_f32 v8, -v5, v9
    v_cvt_pk_bf16_f32 v10, v10, 0
    v_cndmask_b32 v30, v30, v8, s[30:31]
    v_cndmask_b32 v31, v31, v10, s[30:31]
    v_cvt_pk_bf16_f32 v8, -v6, -v6
    v_lshlrev_b32 v8, 16, v8
    v_sub_f32 v9, -v6, v8
    v_cvt_pk_bf16_f32 v10, v9, v9
    v_lshlrev_b32 v10, 16, v10
    v_sub_f32 v10, v9, v10
    v_cvt_pk_bf16_f32 v8, -v6, v9
    v_cvt_pk_bf16_f32 v10, v10, 0
    v_cndmask_b32 v38, v38, v8, s[30:31]
    v_cndmask_b32 v39, v39, v10, s[30:31]
    v_cvt_pk_bf16_f32 v8, -v7, -v7
    v_lshlrev_b32 v8, 16, v8
    v_sub_f32 v9, -v7, v8
    v_cvt_pk_bf16_f32 v10, v9, v9
    v_lshlrev_b32 v10, 16, v10
    v_sub_f32 v10, v9, v10
    v_cvt_pk_bf16_f32 v8, -v7, v9
    v_cvt_pk_bf16_f32 v10, v10, 0
    v_cndmask_b32 v46, v46, v8, s[30:31]
    v_cndmask_b32 v47, v47, v10, s[30:31]
    s_nop 4
    s_branch K2_SETM
K2_END:
    s_endpgm
F_COMPUTE:
    s_mov_b32 s32, s8
    s_mov_b32 s33, s9
    s_mov_b32 s34, 1835008
    s_mov_b32 s35, 0x20000
    s_setprio 3
    v_lshrrev_b32 v4, 4, v0
    v_xor_b32 v4, v4, v3
    v_mul_u32_u24 v5, 896, v2
    v_lshl_add_u32 v12, v4, 4, v5
    v_xor_b32 v4, 4, v4
    v_lshl_add_u32 v13, v4, 4, v5
    s_lshl_b32 s64, s60, 2
    s_add_u32 s64, s64, s62
    s_mul_i32 s72, s64, 28672
    s_lshl_b32 s73, s63, 7
    s_mul_i32 s74, s62, 28672
    s_add_u32 s6, s72, s73
    s_add_u32 m0, s74, 0
    s_add_u32 s5, s6, 0
    buffer_load_dwordx4 v12, s[32:35], s5 offen lds
    s_add_u32 m0, s74, 1024
    s_add_u32 s5, s6, 7168
    buffer_load_dwordx4 v13, s[32:35], s5 offen lds
    s_add_u32 m0, s74, 2048
    s_add_u32 s5, s6, 14336
    buffer_load_dwordx4 v12, s[32:35], s5 offen lds
    s_add_u32 m0, s74, 3072
    s_add_u32 s5, s6, 21504
    buffer_load_dwordx4 v13, s[32:35], s5 offen lds
    s_add_u32 s73, s73, 128
    s_cmp_eq_u32 s73, 896
    s_cselect_b32 s73, 0, s73
    s_add_u32 s6, s72, s73
    s_add_u32 m0, s74, 4096
    s_add_u32 s5, s6, 0
    buffer_load_dwordx4 v12, s[32:35], s5 offen lds
    s_add_u32 m0, s74, 5120
    s_add_u32 s5, s6, 7168
    buffer_load_dwordx4 v13, s[32:35], s5 offen lds
    s_add_u32 m0, s74, 6144
    s_add_u32 s5, s6, 14336
    buffer_load_dwordx4 v12, s[32:35], s5 offen lds
    s_add_u32 m0, s74, 7168
    s_add_u32 s5, s6, 21504
    buffer_load_dwordx4 v13, s[32:35], s5 offen lds
    s_add_u32 s73, s73, 128
    s_cmp_eq_u32 s73, 896
    s_cselect_b32 s73, 0, s73
    s_add_u32 s6, s72, s73
    s_add_u32 m0, s74, 8192
    s_add_u32 s5, s6, 0
    buffer_load_dwordx4 v12, s[32:35], s5 offen lds
    s_add_u32 m0, s74, 9216
    s_add_u32 s5, s6, 7168
    buffer_load_dwordx4 v13, s[32:35], s5 offen lds
    s_add_u32 m0, s74, 10240
    s_add_u32 s5, s6, 14336
    buffer_load_dwordx4 v12, s[32:35], s5 offen lds
    s_add_u32 m0, s74, 11264
    s_add_u32 s5, s6, 21504
    buffer_load_dwordx4 v13, s[32:35], s5 offen lds
    s_add_u32 s73, s73, 128
    s_cmp_eq_u32 s73, 896
    s_cselect_b32 s73, 0, s73
    s_add_u32 s6, s72, s73
    s_add_u32 m0, s74, 12288
    s_add_u32 s5, s6, 0
    buffer_load_dwordx4 v12, s[32:35], s5 offen lds
    s_add_u32 m0, s74, 13312
    s_add_u32 s5, s6, 7168
    buffer_load_dwordx4 v13, s[32:35], s5 offen lds
    s_add_u32 m0, s74, 14336
    s_add_u32 s5, s6, 14336
    buffer_load_dwordx4 v12, s[32:35], s5 offen lds
    s_add_u32 m0, s74, 15360
    s_add_u32 s5, s6, 21504
    buffer_load_dwordx4 v13, s[32:35], s5 offen lds
    s_add_u32 s73, s73, 128
    s_cmp_eq_u32 s73, 896
    s_cselect_b32 s73, 0, s73
    v_bfe_u32 v5, v0, 4, 1
    v_lshlrev_b32 v1, 13, v5
    v_bfe_u32 v6, v0, 2, 2
    v_lshl_add_u32 v1, v6, 7, v1
    v_and_b32 v6, 2, v6
    v_xor_b32 v5, v5, v6
    v_lshl_add_u32 v1, v5, 5, v1
    v_lshrrev_b32 v5, 5, v0
    v_lshl_add_u32 v1, v5, 10, v1
    v_and_b32 v5, 3, v0
    v_lshl_add_u32 v1, v5, 3, v1
    v_xor_b32 v2, 32, v1
    v_xor_b32 v3, 64, v1
    v_xor_b32 v4, 0x60, v1
    v_mov_b32 v200, v1
    s_cmp_lg_u32 s61, 3
    s_cbranch_scc1 K1_NJ3
    v_and_b32 v1, 0x1fff, v1
    v_xor_b32 v2, 64, v1
    v_add_u32 v3, 0x2000, v1
    v_add_u32 v4, 0x2000, v2
K1_NJ3:
    v_and_b32 v5, 31, v0
    v_bfe_u32 v6, v5, 1, 3
    v_lshrrev_b32 v7, 5, v0
    v_xor_b32 v6, v6, v7
    v_lshlrev_b32 v8, 7, v5
    v_lshl_add_u32 v8, v6, 4, v8
    v_add_u32 v8, s74, v8
    v_xor_b32 v9, 32, v8
    v_xor_b32 v10, 64, v8
    v_xor_b32 v11, 0x60, v8
    v_mov_b32 v5, 0
    v_mov_b32 v6, 0
    v_mov_b32 v7, 0
    v_mov_b32 v14, 0
    v_lshlrev_b32 v15, 3, v0
    v_lshlrev_b32 v0, 4, v0
    s_mov_b32 s77, 0x3f803f80
    s_mov_b32 s78, 0xffff0000
    s_mov_b32 s75, 0xbfb8aa3b
    s_mov_b32 s76, 0x3e8b97f6
    s_mul_i32 s65, s64, 147456
    s_add_u32 s65, s65, 4194304
    s_add_u32 s5, s61, 24
    s_lshl_b32 s6, s61, 1
    s_sub_u32 s6, s6, 7
    s_cmp_lt_u32 s61, 4
    s_cselect_b32 s5, s5, s6
    s_lshl_b32 s5, s5, 12
    s_add_u32 s66, s65, s5
    s_sub_u32 s65, s66, 4096
    s_mul_i32 s67, s64, 28672
    s_lshl_b32 s5, s61, 13
    s_add_u32 s67, s67, s5
    s_add_u32 s68, s67, 4096
    s_lshl_b32 s71, s64, 12
    s_add_u32 s71, s71, 2097152
    s_waitcnt vmcnt(12)
    ds_read_b128 v[16:19], v8 offset:0
    ds_read_b128 v[20:23], v9 offset:0
    ds_read_b128 v[24:27], v10 offset:0
    ds_read_b128 v[28:31], v11 offset:0
    s_add_u32 s6, s72, s73
    s_add_u32 m0, s74, 16384
    s_add_u32 s5, s6, 0
    buffer_load_dwordx4 v12, s[32:35], s5 offen lds
    s_add_u32 m0, s74, 17408
    s_add_u32 s5, s6, 7168
    buffer_load_dwordx4 v13, s[32:35], s5 offen lds
    s_add_u32 m0, s74, 18432
    s_add_u32 s5, s6, 14336
    buffer_load_dwordx4 v12, s[32:35], s5 offen lds
    s_add_u32 m0, s74, 19456
    s_add_u32 s5, s6, 21504
    buffer_load_dwordx4 v13, s[32:35], s5 offen lds
    s_add_u32 s73, s73, 128
    s_cmp_eq_u32 s73, 896
    s_cselect_b32 s73, 0, s73
    s_waitcnt lgkmcnt(3)
    v_dot2_f32_bf16 v7, v16, s77, v7
    v_dot2_f32_bf16 v14, v16, v16, v14
    v_dot2_f32_bf16 v5, v17, s77, v5
    v_dot2_f32_bf16 v6, v17, v17, v6
    v_dot2_f32_bf16 v7, v18, s77, v7
    v_dot2_f32_bf16 v14, v18, v18, v14
    v_dot2_f32_bf16 v5, v19, s77, v5
    v_dot2_f32_bf16 v6, v19, v19, v6
    s_waitcnt lgkmcnt(2)
    v_dot2_f32_bf16 v7, v20, s77, v7
    v_dot2_f32_bf16 v14, v20, v20, v14
    v_dot2_f32_bf16 v5, v21, s77, v5
    v_dot2_f32_bf16 v6, v21, v21, v6
    v_dot2_f32_bf16 v7, v22, s77, v7
    v_dot2_f32_bf16 v14, v22, v22, v14
    v_dot2_f32_bf16 v5, v23, s77, v5
    v_dot2_f32_bf16 v6, v23, v23, v6
    s_waitcnt lgkmcnt(1)
    v_dot2_f32_bf16 v7, v24, s77, v7
    v_dot2_f32_bf16 v14, v24, v24, v14
    v_dot2_f32_bf16 v5, v25, s77, v5
    v_dot2_f32_bf16 v6, v25, v25, v6
    v_dot2_f32_bf16 v7, v26, s77, v7
    v_dot2_f32_bf16 v14, v26, v26, v14
    v_dot2_f32_bf16 v5, v27, s77, v5
    v_dot2_f32_bf16 v6, v27, v27, v6
    s_waitcnt lgkmcnt(0)
    v_dot2_f32_bf16 v7, v28, s77, v7
    v_dot2_f32_bf16 v14, v28, v28, v14
    v_dot2_f32_bf16 v5, v29, s77, v5
    v_dot2_f32_bf16 v6, v29, v29, v6
    v_dot2_f32_bf16 v7, v30, s77, v7
    v_dot2_f32_bf16 v14, v30, v30, v14
    v_dot2_f32_bf16 v5, v31, s77, v5
    v_dot2_f32_bf16 v6, v31, v31, v6
    s_waitcnt vmcnt(12)
    ds_read_b128 v[32:35], v8 offset:4096
    ds_read_b128 v[36:39], v9 offset:4096
    ds_read_b128 v[40:43], v10 offset:4096
    ds_read_b128 v[44:47], v11 offset:4096
    s_add_u32 s6, s72, s73
    s_add_u32 m0, s74, 20480
    s_add_u32 s5, s6, 0
    buffer_load_dwordx4 v12, s[32:35], s5 offen lds
    s_add_u32 m0, s74, 21504
    s_add_u32 s5, s6, 7168
    buffer_load_dwordx4 v13, s[32:35], s5 offen lds
    s_add_u32 m0, s74, 22528
    s_add_u32 s5, s6, 14336
    buffer_load_dwordx4 v12, s[32:35], s5 offen lds
    s_add_u32 m0, s74, 23552
    s_add_u32 s5, s6, 21504
    buffer_load_dwordx4 v13, s[32:35], s5 offen lds
    s_add_u32 s73, s73, 128
    s_cmp_eq_u32 s73, 896
    s_cselect_b32 s73, 0, s73
    s_waitcnt lgkmcnt(3)
    v_dot2_f32_bf16 v7, v32, s77, v7
    v_dot2_f32_bf16 v14, v32, v32, v14
    v_dot2_f32_bf16 v5, v33, s77, v5
    v_dot2_f32_bf16 v6, v33, v33, v6
    v_dot2_f32_bf16 v7, v34, s77, v7
    v_dot2_f32_bf16 v14, v34, v34, v14
    v_dot2_f32_bf16 v5, v35, s77, v5
    v_dot2_f32_bf16 v6, v35, v35, v6
    s_waitcnt lgkmcnt(2)
    v_dot2_f32_bf16 v7, v36, s77, v7
    v_dot2_f32_bf16 v14, v36, v36, v14
    v_dot2_f32_bf16 v5, v37, s77, v5
    v_dot2_f32_bf16 v6, v37, v37, v6
    v_dot2_f32_bf16 v7, v38, s77, v7
    v_dot2_f32_bf16 v14, v38, v38, v14
    v_dot2_f32_bf16 v5, v39, s77, v5
    v_dot2_f32_bf16 v6, v39, v39, v6
    s_waitcnt lgkmcnt(1)
    v_dot2_f32_bf16 v7, v40, s77, v7
    v_dot2_f32_bf16 v14, v40, v40, v14
    v_dot2_f32_bf16 v5, v41, s77, v5
    v_dot2_f32_bf16 v6, v41, v41, v6
    v_dot2_f32_bf16 v7, v42, s77, v7
    v_dot2_f32_bf16 v14, v42, v42, v14
    v_dot2_f32_bf16 v5, v43, s77, v5
    v_dot2_f32_bf16 v6, v43, v43, v6
    s_waitcnt lgkmcnt(0)
    v_dot2_f32_bf16 v7, v44, s77, v7
    v_dot2_f32_bf16 v14, v44, v44, v14
    v_dot2_f32_bf16 v5, v45, s77, v5
    v_dot2_f32_bf16 v6, v45, v45, v6
    v_dot2_f32_bf16 v7, v46, s77, v7
    v_dot2_f32_bf16 v14, v46, v46, v14
    v_dot2_f32_bf16 v5, v47, s77, v5
    v_dot2_f32_bf16 v6, v47, v47, v6
    s_waitcnt vmcnt(12)
    ds_read_b128 v[48:51], v8 offset:8192
    ds_read_b128 v[52:55], v9 offset:8192
    ds_read_b128 v[56:59], v10 offset:8192
    ds_read_b128 v[60:63], v11 offset:8192
    s_add_u32 s6, s72, s73
    s_add_u32 m0, s74, 24576
    s_add_u32 s5, s6, 0
    buffer_load_dwordx4 v12, s[32:35], s5 offen lds
    s_add_u32 m0, s74, 25600
    s_add_u32 s5, s6, 7168
    buffer_load_dwordx4 v13, s[32:35], s5 offen lds
    s_add_u32 m0, s74, 26624
    s_add_u32 s5, s6, 14336
    buffer_load_dwordx4 v12, s[32:35], s5 offen lds
    s_add_u32 m0, s74, 27648
    s_add_u32 s5, s6, 21504
    buffer_load_dwordx4 v13, s[32:35], s5 offen lds
    s_add_u32 s73, s73, 128
    s_cmp_eq_u32 s73, 896
    s_cselect_b32 s73, 0, s73
    s_waitcnt lgkmcnt(3)
    v_dot2_f32_bf16 v7, v48, s77, v7
    v_dot2_f32_bf16 v14, v48, v48, v14
    v_dot2_f32_bf16 v5, v49, s77, v5
    v_dot2_f32_bf16 v6, v49, v49, v6
    v_dot2_f32_bf16 v7, v50, s77, v7
    v_dot2_f32_bf16 v14, v50, v50, v14
    v_dot2_f32_bf16 v5, v51, s77, v5
    v_dot2_f32_bf16 v6, v51, v51, v6
    s_waitcnt lgkmcnt(2)
    v_dot2_f32_bf16 v7, v52, s77, v7
    v_dot2_f32_bf16 v14, v52, v52, v14
    v_dot2_f32_bf16 v5, v53, s77, v5
    v_dot2_f32_bf16 v6, v53, v53, v6
    v_dot2_f32_bf16 v7, v54, s77, v7
    v_dot2_f32_bf16 v14, v54, v54, v14
    v_dot2_f32_bf16 v5, v55, s77, v5
    v_dot2_f32_bf16 v6, v55, v55, v6
    s_waitcnt lgkmcnt(1)
    v_dot2_f32_bf16 v7, v56, s77, v7
    v_dot2_f32_bf16 v14, v56, v56, v14
    v_dot2_f32_bf16 v5, v57, s77, v5
    v_dot2_f32_bf16 v6, v57, v57, v6
    v_dot2_f32_bf16 v7, v58, s77, v7
    v_dot2_f32_bf16 v14, v58, v58, v14
    v_dot2_f32_bf16 v5, v59, s77, v5
    v_dot2_f32_bf16 v6, v59, v59, v6
    s_waitcnt lgkmcnt(0)
    v_dot2_f32_bf16 v7, v60, s77, v7
    v_dot2_f32_bf16 v14, v60, v60, v14
    v_dot2_f32_bf16 v5, v61, s77, v5
    v_dot2_f32_bf16 v6, v61, v61, v6
    v_dot2_f32_bf16 v7, v62, s77, v7
    v_dot2_f32_bf16 v14, v62, v62, v14
    v_dot2_f32_bf16 v5, v63, s77, v5
    v_dot2_f32_bf16 v6, v63, v63, v6
    s_waitcnt vmcnt(12)
    ds_read_b128 v[64:67], v8 offset:12288
    ds_read_b128 v[68:71], v9 offset:12288
    ds_read_b128 v[72:75], v10 offset:12288
    ds_read_b128 v[76:79], v11 offset:12288
    s_waitcnt lgkmcnt(3)
    v_dot2_f32_bf16 v7, v64, s77, v7
    v_dot2_f32_bf16 v14, v64, v64, v14
    v_dot2_f32_bf16 v5, v65, s77, v5
    v_dot2_f32_bf16 v6, v65, v65, v6
    v_dot2_f32_bf16 v7, v66, s77, v7
    v_dot2_f32_bf16 v14, v66, v66, v14
    v_dot2_f32_bf16 v5, v67, s77, v5
    v_dot2_f32_bf16 v6, v67, v67, v6
    s_waitcnt lgkmcnt(2)
    v_dot2_f32_bf16 v7, v68, s77, v7
    v_dot2_f32_bf16 v14, v68, v68, v14
    v_dot2_f32_bf16 v5, v69, s77, v5
    v_dot2_f32_bf16 v6, v69, v69, v6
    v_dot2_f32_bf16 v7, v70, s77, v7
    v_dot2_f32_bf16 v14, v70, v70, v14
    v_dot2_f32_bf16 v5, v71, s77, v5
    v_dot2_f32_bf16 v6, v71, v71, v6
    s_waitcnt lgkmcnt(1)
    v_dot2_f32_bf16 v7, v72, s77, v7
    v_dot2_f32_bf16 v14, v72, v72, v14
    v_dot2_f32_bf16 v5, v73, s77, v5
    v_dot2_f32_bf16 v6, v73, v73, v6
    v_dot2_f32_bf16 v7, v74, s77, v7
    v_dot2_f32_bf16 v14, v74, v74, v14
    v_dot2_f32_bf16 v5, v75, s77, v5
    v_dot2_f32_bf16 v6, v75, v75, v6
    s_waitcnt lgkmcnt(0)
    v_dot2_f32_bf16 v7, v76, s77, v7
    v_dot2_f32_bf16 v14, v76, v76, v14
    v_dot2_f32_bf16 v5, v77, s77, v5
    v_dot2_f32_bf16 v6, v77, v77, v6
    v_dot2_f32_bf16 v7, v78, s77, v7
    v_dot2_f32_bf16 v14, v78, v78, v14
    v_dot2_f32_bf16 v5, v79, s77, v5
    v_dot2_f32_bf16 v6, v79, v79, v6
    s_waitcnt vmcnt(8)
    ds_read_b128 v[80:83], v8 offset:16384
    ds_read_b128 v[84:87], v9 offset:16384
    ds_read_b128 v[88:91], v10 offset:16384
    ds_read_b128 v[92:95], v11 offset:16384
    s_waitcnt lgkmcnt(3)
    v_dot2_f32_bf16 v7, v80, s77, v7
    v_dot2_f32_bf16 v14, v80, v80, v14
    v_dot2_f32_bf16 v5, v81, s77, v5
    v_dot2_f32_bf16 v6, v81, v81, v6
    v_dot2_f32_bf16 v7, v82, s77, v7
    v_dot2_f32_bf16 v14, v82, v82, v14
    v_dot2_f32_bf16 v5, v83, s77, v5
    v_dot2_f32_bf16 v6, v83, v83, v6
    s_waitcnt lgkmcnt(2)
    v_dot2_f32_bf16 v7, v84, s77, v7
    v_dot2_f32_bf16 v14, v84, v84, v14
    v_dot2_f32_bf16 v5, v85, s77, v5
    v_dot2_f32_bf16 v6, v85, v85, v6
    v_dot2_f32_bf16 v7, v86, s77, v7
    v_dot2_f32_bf16 v14, v86, v86, v14
    v_dot2_f32_bf16 v5, v87, s77, v5
    v_dot2_f32_bf16 v6, v87, v87, v6
    s_waitcnt lgkmcnt(1)
    v_dot2_f32_bf16 v7, v88, s77, v7
    v_dot2_f32_bf16 v14, v88, v88, v14
    v_dot2_f32_bf16 v5, v89, s77, v5
    v_dot2_f32_bf16 v6, v89, v89, v6
    v_dot2_f32_bf16 v7, v90, s77, v7
    v_dot2_f32_bf16 v14, v90, v90, v14
    v_dot2_f32_bf16 v5, v91, s77, v5
    v_dot2_f32_bf16 v6, v91, v91, v6
    s_waitcnt lgkmcnt(0)
    v_dot2_f32_bf16 v7, v92, s77, v7
    v_dot2_f32_bf16 v14, v92, v92, v14
    v_dot2_f32_bf16 v5, v93, s77, v5
    v_dot2_f32_bf16 v6, v93, v93, v6
    v_dot2_f32_bf16 v7, v94, s77, v7
    v_dot2_f32_bf16 v14, v94, v94, v14
    v_dot2_f32_bf16 v5, v95, s77, v5
    v_dot2_f32_bf16 v6, v95, v95, v6
    s_waitcnt vmcnt(4)
    ds_read_b128 v[96:99], v8 offset:20480
    ds_read_b128 v[100:103], v9 offset:20480
    ds_read_b128 v[104:107], v10 offset:20480
    ds_read_b128 v[108:111], v11 offset:20480
    s_waitcnt lgkmcnt(3)
    v_dot2_f32_bf16 v7, v96, s77, v7
    v_dot2_f32_bf16 v14, v96, v96, v14
    v_dot2_f32_bf16 v5, v97, s77, v5
    v_dot2_f32_bf16 v6, v97, v97, v6
    v_dot2_f32_bf16 v7, v98, s77, v7
    v_dot2_f32_bf16 v14, v98, v98, v14
    v_dot2_f32_bf16 v5, v99, s77, v5
    v_dot2_f32_bf16 v6, v99, v99, v6
    s_waitcnt lgkmcnt(2)
    v_dot2_f32_bf16 v7, v100, s77, v7
    v_dot2_f32_bf16 v14, v100, v100, v14
    v_dot2_f32_bf16 v5, v101, s77, v5
    v_dot2_f32_bf16 v6, v101, v101, v6
    v_dot2_f32_bf16 v7, v102, s77, v7
    v_dot2_f32_bf16 v14, v102, v102, v14
    v_dot2_f32_bf16 v5, v103, s77, v5
    v_dot2_f32_bf16 v6, v103, v103, v6
    s_waitcnt lgkmcnt(1)
    v_dot2_f32_bf16 v7, v104, s77, v7
    v_dot2_f32_bf16 v14, v104, v104, v14
    v_dot2_f32_bf16 v5, v105, s77, v5
    v_dot2_f32_bf16 v6, v105, v105, v6
    v_dot2_f32_bf16 v7, v106, s77, v7
    v_dot2_f32_bf16 v14, v106, v106, v14
    v_dot2_f32_bf16 v5, v107, s77, v5
    v_dot2_f32_bf16 v6, v107, v107, v6
    s_waitcnt lgkmcnt(0)
    v_dot2_f32_bf16 v7, v108, s77, v7
    v_dot2_f32_bf16 v14, v108, v108, v14
    v_dot2_f32_bf16 v5, v109, s77, v5
    v_dot2_f32_bf16 v6, v109, v109, v6
    v_dot2_f32_bf16 v7, v110, s77, v7
    v_dot2_f32_bf16 v14, v110, v110, v14
    v_dot2_f32_bf16 v5, v111, s77, v5
    v_dot2_f32_bf16 v6, v111, v111, v6
    s_waitcnt vmcnt(0)
    ds_read_b128 v[112:115], v8 offset:24576
    ds_read_b128 v[116:119], v9 offset:24576
    ds_read_b128 v[120:123], v10 offset:24576
    ds_read_b128 v[124:127], v11 offset:24576
    s_waitcnt lgkmcnt(3)
    v_dot2_f32_bf16 v7, v112, s77, v7
    v_dot2_f32_bf16 v14, v112, v112, v14
    v_dot2_f32_bf16 v5, v113, s77, v5
    v_dot2_f32_bf16 v6, v113, v113, v6
    v_dot2_f32_bf16 v7, v114, s77, v7
    v_dot2_f32_bf16 v14, v114, v114, v14
    v_dot2_f32_bf16 v5, v115, s77, v5
    v_dot2_f32_bf16 v6, v115, v115, v6
    s_waitcnt lgkmcnt(2)
    v_dot2_f32_bf16 v7, v116, s77, v7
    v_dot2_f32_bf16 v14, v116, v116, v14
    v_dot2_f32_bf16 v5, v117, s77, v5
    v_dot2_f32_bf16 v6, v117, v117, v6
    v_dot2_f32_bf16 v7, v118, s77, v7
    v_dot2_f32_bf16 v14, v118, v118, v14
    v_dot2_f32_bf16 v5, v119, s77, v5
    v_dot2_f32_bf16 v6, v119, v119, v6
    s_waitcnt lgkmcnt(1)
    v_dot2_f32_bf16 v7, v120, s77, v7
    v_dot2_f32_bf16 v14, v120, v120, v14
    v_dot2_f32_bf16 v5, v121, s77, v5
    v_dot2_f32_bf16 v6, v121, v121, v6
    v_dot2_f32_bf16 v7, v122, s77, v7
    v_dot2_f32_bf16 v14, v122, v122, v14
    v_dot2_f32_bf16 v5, v123, s77, v5
    v_dot2_f32_bf16 v6, v123, v123, v6
    s_waitcnt lgkmcnt(0)
    v_dot2_f32_bf16 v7, v124, s77, v7
    v_dot2_f32_bf16 v14, v124, v124, v14
    v_dot2_f32_bf16 v5, v125, s77, v5
    v_dot2_f32_bf16 v6, v125, v125, v6
    v_dot2_f32_bf16 v7, v126, s77, v7
    v_dot2_f32_bf16 v14, v126, v126, v14
    v_dot2_f32_bf16 v5, v127, s77, v5
    v_dot2_f32_bf16 v6, v127, v127, v6
    s_barrier
    v_add_u32 v1, 98304, v1
    v_add_u32 v2, 98304, v2
    v_add_u32 v3, 98304, v3
    v_add_u32 v4, 98304, v4
    ds_read_b64_tr_b16 v[224:225], v1 offset:16384
    ds_read_b64_tr_b16 v[226:227], v1 offset:16896
    ds_read_b64_tr_b16 v[228:229], v2 offset:16384
    ds_read_b64_tr_b16 v[230:231], v2 offset:16896
    ds_read_b64_tr_b16 v[232:233], v3 offset:16384
    ds_read_b64_tr_b16 v[234:235], v3 offset:16896
    ds_read_b64_tr_b16 v[236:237], v4 offset:16384
    ds_read_b64_tr_b16 v[238:239], v4 offset:16896
    v_add_f32 v5, v5, v7
    v_add_f32 v6, v6, v14
    v_mov_b32 v8, v5
    v_mov_b32 v9, v6
    s_nop 0
    v_permlane32_swap_b32 v5, v8
    v_permlane32_swap_b32 v6, v9
    v_add_f32 v5, v5, v8
    v_add_f32 v6, v6, v9
    v_mul_f32 v5, 0x3b124925, v5
    v_mul_f32 v6, 0x3b124925, v6
    v_fma_f32 v6, -v5, v5, v6
    v_max_f32 v6, 0, v6
    v_cvt_pk_bf16_f32 v5, v5, v5
    v_cvt_pk_bf16_f32 v6, v6, v6
    v_lshlrev_b32 v5, 16, v5
    v_lshlrev_b32 v6, 16, v6
    v_add_f32 v6, 0x3727c5ac, v6
    v_cvt_pk_bf16_f32 v6, v6, v6
    v_lshlrev_b32 v6, 16, v6
    v_sqrt_f32 v6, v6
    s_nop 0
    v_cvt_pk_bf16_f32 v6, v6, v6
    v_lshlrev_b32 v6, 16, v6
    v_rcp_f32 v12, v6
    s_nop 0
    v_mul_f32 v13, -v5, v12
    v_lshlrev_b32 v192, 16, v16
    v_lshlrev_b32 v194, 16, v17
    v_lshlrev_b32 v196, 16, v18
    v_lshlrev_b32 v198, 16, v19
    v_and_b32 v193, s78, v16
    v_and_b32 v195, s78, v17
    v_and_b32 v197, s78, v18
    v_and_b32 v199, s78, v19
    v_fma_f32 v192, v192, v12, v13
    v_fma_f32 v194, v194, v12, v13
    v_fma_f32 v196, v196, v12, v13
    v_fma_f32 v198, v198, v12, v13
    v_fma_f32 v193, v193, v12, v13
    v_fma_f32 v195, v195, v12, v13
    v_fma_f32 v197, v197, v12, v13
    v_fma_f32 v199, v199, v12, v13
    v_cvt_pk_bf16_f32 v16, v192, v193
    v_cvt_pk_bf16_f32 v17, v194, v195
    v_cvt_pk_bf16_f32 v18, v196, v197
    v_cvt_pk_bf16_f32 v19, v198, v199
    s_waitcnt lgkmcnt(4)
    s_nop 0
    v_mfma_f32_32x32x16_bf16 v[128:143], v[224:227], v[16:19], 0
    ds_read_b64_tr_b16 v[240:241], v1 offset:18432
    ds_read_b64_tr_b16 v[242:243], v1 offset:18944
    v_lshlrev_b32 v192, 16, v20
    v_lshlrev_b32 v194, 16, v21
    v_and_b32 v193, s78, v20
    v_and_b32 v195, s78, v21
    v_fma_f32 v192, v192, v12, v13
    v_mfma_f32_32x32x16_bf16 v[144:159], v[228:231], v[16:19], 0
    ds_read_b64_tr_b16 v[244:245], v2 offset:18432
    ds_read_b64_tr_b16 v[246:247], v2 offset:18944
    v_fma_f32 v194, v194, v12, v13
    v_fma_f32 v193, v193, v12, v13
    v_fma_f32 v195, v195, v12, v13
    v_cvt_pk_bf16_f32 v20, v192, v193
    v_cvt_pk_bf16_f32 v21, v194, v195
    s_waitcnt lgkmcnt(4)
    v_mfma_f32_32x32x16_bf16 v[160:175], v[232:235], v[16:19], 0
    ds_read_b64_tr_b16 v[248:249], v3 offset:18432
    ds_read_b64_tr_b16 v[250:251], v3 offset:18944
    v_lshlrev_b32 v196, 16, v22
    v_lshlrev_b32 v198, 16, v23
    v_and_b32 v197, s78, v22
    v_and_b32 v199, s78, v23
    v_fma_f32 v196, v196, v12, v13
    v_mfma_f32_32x32x16_bf16 v[176:191], v[236:239], v[16:19], 0
    ds_read_b64_tr_b16 v[252:253], v4 offset:18432
    ds_read_b64_tr_b16 v[254:255], v4 offset:18944
    v_fma_f32 v198, v198, v12, v13
    v_fma_f32 v197, v197, v12, v13
    v_fma_f32 v199, v199, v12, v13
    v_cvt_pk_bf16_f32 v22, v196, v197
    v_cvt_pk_bf16_f32 v23, v198, v199
    s_waitcnt lgkmcnt(4)
    s_nop 0
    v_mfma_f32_32x32x16_bf16 v[128:143], v[240:243], v[20:23], v[128:143]
    ds_read_b64_tr_b16 v[224:225], v1 offset:20480
    ds_read_b64_tr_b16 v[226:227], v1 offset:20992
    v_lshlrev_b32 v192, 16, v24
    v_lshlrev_b32 v194, 16, v25
    v_and_b32 v193, s78, v24
    v_and_b32 v195, s78, v25
    v_fma_f32 v192, v192, v12, v13
    v_mfma_f32_32x32x16_bf16 v[144:159], v[244:247], v[20:23], v[144:159]
    ds_read_b64_tr_b16 v[228:229], v2 offset:20480
    ds_read_b64_tr_b16 v[230:231], v2 offset:20992
    v_fma_f32 v194, v194, v12, v13
    v_fma_f32 v193, v193, v12, v13
    v_fma_f32 v195, v195, v12, v13
    v_cvt_pk_bf16_f32 v24, v192, v193
    v_cvt_pk_bf16_f32 v25, v194, v195
    s_waitcnt lgkmcnt(4)
    v_mfma_f32_32x32x16_bf16 v[160:175], v[248:251], v[20:23], v[160:175]
    ds_read_b64_tr_b16 v[232:233], v3 offset:20480
    ds_read_b64_tr_b16 v[234:235], v3 offset:20992
    v_lshlrev_b32 v196, 16, v26
    v_lshlrev_b32 v198, 16, v27
    v_and_b32 v197, s78, v26
    v_and_b32 v199, s78, v27
    v_fma_f32 v196, v196, v12, v13
    v_mfma_f32_32x32x16_bf16 v[176:191], v[252:255], v[20:23], v[176:191]
    ds_read_b64_tr_b16 v[236:237], v4 offset:20480
    ds_read_b64_tr_b16 v[238:239], v4 offset:20992
    v_fma_f32 v198, v198, v12, v13
    v_fma_f32 v197, v197, v12, v13
    v_fma_f32 v199, v199, v12, v13
    v_cvt_pk_bf16_f32 v26, v196, v197
    v_cvt_pk_bf16_f32 v27, v198, v199
    s_waitcnt lgkmcnt(4)
    s_nop 0
    v_mfma_f32_32x32x16_bf16 v[128:143], v[224:227], v[24:27], v[128:143]
    ds_read_b64_tr_b16 v[240:241], v1 offset:22528
    ds_read_b64_tr_b16 v[242:243], v1 offset:23040
    v_lshlrev_b32 v192, 16, v28
    v_lshlrev_b32 v194, 16, v29
    v_and_b32 v193, s78, v28
    v_and_b32 v195, s78, v29
    v_fma_f32 v192, v192, v12, v13
    v_mfma_f32_32x32x16_bf16 v[144:159], v[228:231], v[24:27], v[144:159]
    ds_read_b64_tr_b16 v[244:245], v2 offset:22528
    ds_read_b64_tr_b16 v[246:247], v2 offset:23040
    v_fma_f32 v194, v194, v12, v13
    v_fma_f32 v193, v193, v12, v13
    v_fma_f32 v195, v195, v12, v13
    v_cvt_pk_bf16_f32 v28, v192, v193
    v_cvt_pk_bf16_f32 v29, v194, v195
    s_waitcnt lgkmcnt(4)
    v_mfma_f32_32x32x16_bf16 v[160:175], v[232:235], v[24:27], v[160:175]
    ds_read_b64_tr_b16 v[248:249], v3 offset:22528
    ds_read_b64_tr_b16 v[250:251], v3 offset:23040
    v_lshlrev_b32 v196, 16, v30
    v_lshlrev_b32 v198, 16, v31
    v_and_b32 v197, s78, v30
    v_and_b32 v199, s78, v31
    v_fma_f32 v196, v196, v12, v13
    v_mfma_f32_32x32x16_bf16 v[176:191], v[236:239], v[24:27], v[176:191]
    ds_read_b64_tr_b16 v[252:253], v4 offset:22528
    ds_read_b64_tr_b16 v[254:255], v4 offset:23040
    v_fma_f32 v198, v198, v12, v13
    v_fma_f32 v197, v197, v12, v13
    v_fma_f32 v199, v199, v12, v13
    v_cvt_pk_bf16_f32 v30, v196, v197
    v_cvt_pk_bf16_f32 v31, v198, v199
    s_waitcnt lgkmcnt(4)
    s_nop 0
    v_mfma_f32_32x32x16_bf16 v[128:143], v[240:243], v[28:31], v[128:143]
    v_lshlrev_b32 v192, 16, v32
    v_lshlrev_b32 v194, 16, v33
    v_and_b32 v193, s78, v32
    v_and_b32 v195, s78, v33
    v_fma_f32 v192, v192, v12, v13
    v_mfma_f32_32x32x16_bf16 v[144:159], v[244:247], v[28:31], v[144:159]
    v_fma_f32 v194, v194, v12, v13
    v_fma_f32 v193, v193, v12, v13
    v_fma_f32 v195, v195, v12, v13
    v_cvt_pk_bf16_f32 v32, v192, v193
    v_cvt_pk_bf16_f32 v33, v194, v195
    s_waitcnt lgkmcnt(0)
    v_mfma_f32_32x32x16_bf16 v[160:175], v[248:251], v[28:31], v[160:175]
    s_barrier
    ds_read_b64_tr_b16 v[224:225], v1 offset:32768
    ds_read_b64_tr_b16 v[226:227], v1 offset:33280
    ds_read_b64_tr_b16 v[228:229], v2 offset:32768
    ds_read_b64_tr_b16 v[230:231], v2 offset:33280
    v_lshlrev_b32 v196, 16, v34
    v_lshlrev_b32 v198, 16, v35
    v_and_b32 v197, s78, v34
    v_and_b32 v199, s78, v35
    v_fma_f32 v196, v196, v12, v13
    v_mfma_f32_32x32x16_bf16 v[176:191], v[252:255], v[28:31], v[176:191]
    ds_read_b64_tr_b16 v[232:233], v3 offset:32768
    ds_read_b64_tr_b16 v[234:235], v3 offset:33280
    ds_read_b64_tr_b16 v[236:237], v4 offset:32768
    ds_read_b64_tr_b16 v[238:239], v4 offset:33280
    v_fma_f32 v198, v198, v12, v13
    v_fma_f32 v197, v197, v12, v13
    v_fma_f32 v199, v199, v12, v13
    v_cvt_pk_bf16_f32 v34, v196, v197
    v_cvt_pk_bf16_f32 v35, v198, v199
    s_waitcnt lgkmcnt(4)
    s_nop 0
    v_mfma_f32_32x32x16_bf16 v[128:143], v[224:227], v[32:35], v[128:143]
    ds_read_b64_tr_b16 v[240:241], v1 offset:34816
    ds_read_b64_tr_b16 v[242:243], v1 offset:35328
    v_lshlrev_b32 v192, 16, v36
    v_lshlrev_b32 v194, 16, v37
    v_and_b32 v193, s78, v36
    v_and_b32 v195, s78, v37
    v_fma_f32 v192, v192, v12, v13
    v_mfma_f32_32x32x16_bf16 v[144:159], v[228:231], v[32:35], v[144:159]
    ds_read_b64_tr_b16 v[244:245], v2 offset:34816
    ds_read_b64_tr_b16 v[246:247], v2 offset:35328
    v_fma_f32 v194, v194, v12, v13
    v_fma_f32 v193, v193, v12, v13
    v_fma_f32 v195, v195, v12, v13
    v_cvt_pk_bf16_f32 v36, v192, v193
    v_cvt_pk_bf16_f32 v37, v194, v195
    s_waitcnt lgkmcnt(4)
    v_mfma_f32_32x32x16_bf16 v[160:175], v[232:235], v[32:35], v[160:175]
    ds_read_b64_tr_b16 v[248:249], v3 offset:34816
    ds_read_b64_tr_b16 v[250:251], v3 offset:35328
    v_lshlrev_b32 v196, 16, v38
    v_lshlrev_b32 v198, 16, v39
    v_and_b32 v197, s78, v38
    v_and_b32 v199, s78, v39
    v_fma_f32 v196, v196, v12, v13
    v_mfma_f32_32x32x16_bf16 v[176:191], v[236:239], v[32:35], v[176:191]
    ds_read_b64_tr_b16 v[252:253], v4 offset:34816
    ds_read_b64_tr_b16 v[254:255], v4 offset:35328
    v_fma_f32 v198, v198, v12, v13
    v_fma_f32 v197, v197, v12, v13
    v_fma_f32 v199, v199, v12, v13
    v_cvt_pk_bf16_f32 v38, v196, v197
    v_cvt_pk_bf16_f32 v39, v198, v199
    s_waitcnt lgkmcnt(4)
    s_nop 0
    v_mfma_f32_32x32x16_bf16 v[128:143], v[240:243], v[36:39], v[128:143]
    ds_read_b64_tr_b16 v[224:225], v1 offset:36864
    ds_read_b64_tr_b16 v[226:227], v1 offset:37376
    v_lshlrev_b32 v192, 16, v40
    v_lshlrev_b32 v194, 16, v41
    v_and_b32 v193, s78, v40
    v_and_b32 v195, s78, v41
    v_fma_f32 v192, v192, v12, v13
    v_mfma_f32_32x32x16_bf16 v[144:159], v[244:247], v[36:39], v[144:159]
    ds_read_b64_tr_b16 v[228:229], v2 offset:36864
    ds_read_b64_tr_b16 v[230:231], v2 offset:37376
    v_fma_f32 v194, v194, v12, v13
    v_fma_f32 v193, v193, v12, v13
    v_fma_f32 v195, v195, v12, v13
    v_cvt_pk_bf16_f32 v40, v192, v193
    v_cvt_pk_bf16_f32 v41, v194, v195
    s_waitcnt lgkmcnt(4)
    v_mfma_f32_32x32x16_bf16 v[160:175], v[248:251], v[36:39], v[160:175]
    ds_read_b64_tr_b16 v[232:233], v3 offset:36864
    ds_read_b64_tr_b16 v[234:235], v3 offset:37376
    v_lshlrev_b32 v196, 16, v42
    v_lshlrev_b32 v198, 16, v43
    v_and_b32 v197, s78, v42
    v_and_b32 v199, s78, v43
    v_fma_f32 v196, v196, v12, v13
    v_mfma_f32_32x32x16_bf16 v[176:191], v[252:255], v[36:39], v[176:191]
    ds_read_b64_tr_b16 v[236:237], v4 offset:36864
    ds_read_b64_tr_b16 v[238:239], v4 offset:37376
    v_fma_f32 v198, v198, v12, v13
    v_fma_f32 v197, v197, v12, v13
    v_fma_f32 v199, v199, v12, v13
    v_cvt_pk_bf16_f32 v42, v196, v197
    v_cvt_pk_bf16_f32 v43, v198, v199
    s_waitcnt lgkmcnt(4)
    s_nop 0
    v_mfma_f32_32x32x16_bf16 v[128:143], v[224:227], v[40:43], v[128:143]
    ds_read_b64_tr_b16 v[240:241], v1 offset:38912
    ds_read_b64_tr_b16 v[242:243], v1 offset:39424
    v_lshlrev_b32 v192, 16, v44
    v_lshlrev_b32 v194, 16, v45
    v_and_b32 v193, s78, v44
    v_and_b32 v195, s78, v45
    v_fma_f32 v192, v192, v12, v13
    v_mfma_f32_32x32x16_bf16 v[144:159], v[228:231], v[40:43], v[144:159]
    ds_read_b64_tr_b16 v[244:245], v2 offset:38912
    ds_read_b64_tr_b16 v[246:247], v2 offset:39424
    v_fma_f32 v194, v194, v12, v13
    v_fma_f32 v193, v193, v12, v13
    v_fma_f32 v195, v195, v12, v13
    v_cvt_pk_bf16_f32 v44, v192, v193
    v_cvt_pk_bf16_f32 v45, v194, v195
    s_waitcnt lgkmcnt(4)
    v_mfma_f32_32x32x16_bf16 v[160:175], v[232:235], v[40:43], v[160:175]
    ds_read_b64_tr_b16 v[248:249], v3 offset:38912
    ds_read_b64_tr_b16 v[250:251], v3 offset:39424
    v_lshlrev_b32 v196, 16, v46
    v_lshlrev_b32 v198, 16, v47
    v_and_b32 v197, s78, v46
    v_and_b32 v199, s78, v47
    v_fma_f32 v196, v196, v12, v13
    v_mfma_f32_32x32x16_bf16 v[176:191], v[236:239], v[40:43], v[176:191]
    ds_read_b64_tr_b16 v[252:253], v4 offset:38912
    ds_read_b64_tr_b16 v[254:255], v4 offset:39424
    v_fma_f32 v198, v198, v12, v13
    v_fma_f32 v197, v197, v12, v13
    v_fma_f32 v199, v199, v12, v13
    v_cvt_pk_bf16_f32 v46, v196, v197
    v_cvt_pk_bf16_f32 v47, v198, v199
    s_waitcnt lgkmcnt(4)
    s_nop 0
    v_mfma_f32_32x32x16_bf16 v[128:143], v[240:243], v[44:47], v[128:143]
    ds_read_b64_tr_b16 v[224:225], v1 offset:49152
    ds_read_b64_tr_b16 v[226:227], v1 offset:49664
    v_lshlrev_b32 v192, 16, v48
    v_lshlrev_b32 v194, 16, v49
    v_and_b32 v193, s78, v48
    v_and_b32 v195, s78, v49
    v_fma_f32 v192, v192, v12, v13
    v_mfma_f32_32x32x16_bf16 v[144:159], v[244:247], v[44:47], v[144:159]
    ds_read_b64_tr_b16 v[228:229], v2 offset:49152
    ds_read_b64_tr_b16 v[230:231], v2 offset:49664
    v_fma_f32 v194, v194, v12, v13
    v_fma_f32 v193, v193, v12, v13
    v_fma_f32 v195, v195, v12, v13
    v_cvt_pk_bf16_f32 v48, v192, v193
    v_cvt_pk_bf16_f32 v49, v194, v195
    s_waitcnt lgkmcnt(4)
    v_mfma_f32_32x32x16_bf16 v[160:175], v[248:251], v[44:47], v[160:175]
    ds_read_b64_tr_b16 v[232:233], v3 offset:49152
    ds_read_b64_tr_b16 v[234:235], v3 offset:49664
    v_lshlrev_b32 v196, 16, v50
    v_lshlrev_b32 v198, 16, v51
    v_and_b32 v197, s78, v50
    v_and_b32 v199, s78, v51
    v_fma_f32 v196, v196, v12, v13
    v_mfma_f32_32x32x16_bf16 v[176:191], v[252:255], v[44:47], v[176:191]
    ds_read_b64_tr_b16 v[236:237], v4 offset:49152
    ds_read_b64_tr_b16 v[238:239], v4 offset:49664
    v_fma_f32 v198, v198, v12, v13
    v_fma_f32 v197, v197, v12, v13
    v_fma_f32 v199, v199, v12, v13
    v_cvt_pk_bf16_f32 v50, v196, v197
    v_cvt_pk_bf16_f32 v51, v198, v199
    s_waitcnt lgkmcnt(4)
    s_nop 0
    v_mfma_f32_32x32x16_bf16 v[128:143], v[224:227], v[48:51], v[128:143]
    ds_read_b64_tr_b16 v[240:241], v1 offset:51200
    ds_read_b64_tr_b16 v[242:243], v1 offset:51712
    v_lshlrev_b32 v192, 16, v52
    v_lshlrev_b32 v194, 16, v53
    v_and_b32 v193, s78, v52
    v_and_b32 v195, s78, v53
    v_fma_f32 v192, v192, v12, v13
    v_mfma_f32_32x32x16_bf16 v[144:159], v[228:231], v[48:51], v[144:159]
    ds_read_b64_tr_b16 v[244:245], v2 offset:51200
    ds_read_b64_tr_b16 v[246:247], v2 offset:51712
    v_fma_f32 v194, v194, v12, v13
    v_fma_f32 v193, v193, v12, v13
    v_fma_f32 v195, v195, v12, v13
    v_cvt_pk_bf16_f32 v52, v192, v193
    v_cvt_pk_bf16_f32 v53, v194, v195
    s_waitcnt lgkmcnt(4)
    v_mfma_f32_32x32x16_bf16 v[160:175], v[232:235], v[48:51], v[160:175]
    ds_read_b64_tr_b16 v[248:249], v3 offset:51200
    ds_read_b64_tr_b16 v[250:251], v3 offset:51712
    v_lshlrev_b32 v196, 16, v54
    v_lshlrev_b32 v198, 16, v55
    v_and_b32 v197, s78, v54
    v_and_b32 v199, s78, v55
    v_fma_f32 v196, v196, v12, v13
    v_mfma_f32_32x32x16_bf16 v[176:191], v[236:239], v[48:51], v[176:191]
    ds_read_b64_tr_b16 v[252:253], v4 offset:51200
    ds_read_b64_tr_b16 v[254:255], v4 offset:51712
    v_fma_f32 v198, v198, v12, v13
    v_fma_f32 v197, v197, v12, v13
    v_fma_f32 v199, v199, v12, v13
    v_cvt_pk_bf16_f32 v54, v196, v197
    v_cvt_pk_bf16_f32 v55, v198, v199
    s_waitcnt lgkmcnt(4)
    s_nop 0
    v_mfma_f32_32x32x16_bf16 v[128:143], v[240:243], v[52:55], v[128:143]
    ds_read_b64_tr_b16 v[224:225], v1 offset:53248
    ds_read_b64_tr_b16 v[226:227], v1 offset:53760
    v_lshlrev_b32 v192, 16, v56
    v_lshlrev_b32 v194, 16, v57
    v_and_b32 v193, s78, v56
    v_and_b32 v195, s78, v57
    v_fma_f32 v192, v192, v12, v13
    v_mfma_f32_32x32x16_bf16 v[144:159], v[244:247], v[52:55], v[144:159]
    ds_read_b64_tr_b16 v[228:229], v2 offset:53248
    ds_read_b64_tr_b16 v[230:231], v2 offset:53760
    v_fma_f32 v194, v194, v12, v13
    v_fma_f32 v193, v193, v12, v13
    v_fma_f32 v195, v195, v12, v13
    v_cvt_pk_bf16_f32 v56, v192, v193
    v_cvt_pk_bf16_f32 v57, v194, v195
    s_waitcnt lgkmcnt(4)
    v_mfma_f32_32x32x16_bf16 v[160:175], v[248:251], v[52:55], v[160:175]
    ds_read_b64_tr_b16 v[232:233], v3 offset:53248
    ds_read_b64_tr_b16 v[234:235], v3 offset:53760
    v_lshlrev_b32 v196, 16, v58
    v_lshlrev_b32 v198, 16, v59
    v_and_b32 v197, s78, v58
    v_and_b32 v199, s78, v59
    v_fma_f32 v196, v196, v12, v13
    v_mfma_f32_32x32x16_bf16 v[176:191], v[252:255], v[52:55], v[176:191]
    ds_read_b64_tr_b16 v[236:237], v4 offset:53248
    ds_read_b64_tr_b16 v[238:239], v4 offset:53760
    v_fma_f32 v198, v198, v12, v13
    v_fma_f32 v197, v197, v12, v13
    v_fma_f32 v199, v199, v12, v13
    v_cvt_pk_bf16_f32 v58, v196, v197
    v_cvt_pk_bf16_f32 v59, v198, v199
    s_waitcnt lgkmcnt(4)
    s_nop 0
    v_mfma_f32_32x32x16_bf16 v[128:143], v[224:227], v[56:59], v[128:143]
    ds_read_b64_tr_b16 v[240:241], v1 offset:55296
    ds_read_b64_tr_b16 v[242:243], v1 offset:55808
    v_lshlrev_b32 v192, 16, v60
    v_lshlrev_b32 v194, 16, v61
    v_and_b32 v193, s78, v60
    v_and_b32 v195, s78, v61
    v_fma_f32 v192, v192, v12, v13
    v_mfma_f32_32x32x16_bf16 v[144:159], v[228:231], v[56:59], v[144:159]
    ds_read_b64_tr_b16 v[244:245], v2 offset:55296
    ds_read_b64_tr_b16 v[246:247], v2 offset:55808
    v_fma_f32 v194, v194, v12, v13
    v_fma_f32 v193, v193, v12, v13
    v_fma_f32 v195, v195, v12, v13
    v_cvt_pk_bf16_f32 v60, v192, v193
    v_cvt_pk_bf16_f32 v61, v194, v195
    s_waitcnt lgkmcnt(4)
    v_mfma_f32_32x32x16_bf16 v[160:175], v[232:235], v[56:59], v[160:175]
    ds_read_b64_tr_b16 v[248:249], v3 offset:55296
    ds_read_b64_tr_b16 v[250:251], v3 offset:55808
    v_lshlrev_b32 v196, 16, v62
    v_lshlrev_b32 v198, 16, v63
    v_and_b32 v197, s78, v62
    v_and_b32 v199, s78, v63
    v_fma_f32 v196, v196, v12, v13
    v_mfma_f32_32x32x16_bf16 v[176:191], v[236:239], v[56:59], v[176:191]
    ds_read_b64_tr_b16 v[252:253], v4 offset:55296
    ds_read_b64_tr_b16 v[254:255], v4 offset:55808
    v_fma_f32 v198, v198, v12, v13
    v_fma_f32 v197, v197, v12, v13
    v_fma_f32 v199, v199, v12, v13
    v_cvt_pk_bf16_f32 v62, v196, v197
    v_cvt_pk_bf16_f32 v63, v198, v199
    s_waitcnt lgkmcnt(4)
    s_nop 0
    v_mfma_f32_32x32x16_bf16 v[128:143], v[240:243], v[60:63], v[128:143]
    v_lshlrev_b32 v192, 16, v64
    v_lshlrev_b32 v194, 16, v65
    v_and_b32 v193, s78, v64
    v_and_b32 v195, s78, v65
    v_fma_f32 v192, v192, v12, v13
    v_mfma_f32_32x32x16_bf16 v[144:159], v[244:247], v[60:63], v[144:159]
    v_fma_f32 v194, v194, v12, v13
    v_fma_f32 v193, v193, v12, v13
    v_fma_f32 v195, v195, v12, v13
    v_cvt_pk_bf16_f32 v64, v192, v193
    v_cvt_pk_bf16_f32 v65, v194, v195
    s_waitcnt lgkmcnt(0)
    v_mfma_f32_32x32x16_bf16 v[160:175], v[248:251], v[60:63], v[160:175]
    s_barrier
    v_add_u32 v1, 4294868992, v1
    v_add_u32 v2, 4294868992, v2
    v_add_u32 v3, 4294868992, v3
    v_add_u32 v4, 4294868992, v4
    ds_read_b64_tr_b16 v[224:225], v1 offset:0
    ds_read_b64_tr_b16 v[226:227], v1 offset:512
    ds_read_b64_tr_b16 v[228:229], v2 offset:0
    ds_read_b64_tr_b16 v[230:231], v2 offset:512
    v_lshlrev_b32 v196, 16, v66
    v_lshlrev_b32 v198, 16, v67
    v_and_b32 v197, s78, v66
    v_and_b32 v199, s78, v67
    v_fma_f32 v196, v196, v12, v13
    v_mfma_f32_32x32x16_bf16 v[176:191], v[252:255], v[60:63], v[176:191]
    ds_read_b64_tr_b16 v[232:233], v3 offset:0
    ds_read_b64_tr_b16 v[234:235], v3 offset:512
    ds_read_b64_tr_b16 v[236:237], v4 offset:0
    ds_read_b64_tr_b16 v[238:239], v4 offset:512
    v_fma_f32 v198, v198, v12, v13
    v_fma_f32 v197, v197, v12, v13
    v_fma_f32 v199, v199, v12, v13
    v_cvt_pk_bf16_f32 v66, v196, v197
    v_cvt_pk_bf16_f32 v67, v198, v199
    s_waitcnt lgkmcnt(4)
    s_nop 0
    v_mfma_f32_32x32x16_bf16 v[128:143], v[224:227], v[64:67], v[128:143]
    ds_read_b64_tr_b16 v[240:241], v1 offset:2048
    ds_read_b64_tr_b16 v[242:243], v1 offset:2560
    v_lshlrev_b32 v192, 16, v68
    v_lshlrev_b32 v194, 16, v69
    v_and_b32 v193, s78, v68
    v_and_b32 v195, s78, v69
    v_fma_f32 v192, v192, v12, v13
    v_mfma_f32_32x32x16_bf16 v[144:159], v[228:231], v[64:67], v[144:159]
    ds_read_b64_tr_b16 v[244:245], v2 offset:2048
    ds_read_b64_tr_b16 v[246:247], v2 offset:2560
    v_fma_f32 v194, v194, v12, v13
    v_fma_f32 v193, v193, v12, v13
    v_fma_f32 v195, v195, v12, v13
    v_cvt_pk_bf16_f32 v68, v192, v193
    v_cvt_pk_bf16_f32 v69, v194, v195
    s_waitcnt lgkmcnt(4)
    v_mfma_f32_32x32x16_bf16 v[160:175], v[232:235], v[64:67], v[160:175]
    ds_read_b64_tr_b16 v[248:249], v3 offset:2048
    ds_read_b64_tr_b16 v[250:251], v3 offset:2560
    v_lshlrev_b32 v196, 16, v70
    v_lshlrev_b32 v198, 16, v71
    v_and_b32 v197, s78, v70
    v_and_b32 v199, s78, v71
    v_fma_f32 v196, v196, v12, v13
    v_mfma_f32_32x32x16_bf16 v[176:191], v[236:239], v[64:67], v[176:191]
    ds_read_b64_tr_b16 v[252:253], v4 offset:2048
    ds_read_b64_tr_b16 v[254:255], v4 offset:2560
    v_fma_f32 v198, v198, v12, v13
    v_fma_f32 v197, v197, v12, v13
    v_fma_f32 v199, v199, v12, v13
    v_cvt_pk_bf16_f32 v70, v196, v197
    v_cvt_pk_bf16_f32 v71, v198, v199
    s_waitcnt lgkmcnt(4)
    s_nop 0
    v_mfma_f32_32x32x16_bf16 v[128:143], v[240:243], v[68:71], v[128:143]
    ds_read_b64_tr_b16 v[224:225], v1 offset:4096
    ds_read_b64_tr_b16 v[226:227], v1 offset:4608
    v_lshlrev_b32 v192, 16, v72
    v_lshlrev_b32 v194, 16, v73
    v_and_b32 v193, s78, v72
    v_and_b32 v195, s78, v73
    v_fma_f32 v192, v192, v12, v13
    v_mfma_f32_32x32x16_bf16 v[144:159], v[244:247], v[68:71], v[144:159]
    ds_read_b64_tr_b16 v[228:229], v2 offset:4096
    ds_read_b64_tr_b16 v[230:231], v2 offset:4608
    v_fma_f32 v194, v194, v12, v13
    v_fma_f32 v193, v193, v12, v13
    v_fma_f32 v195, v195, v12, v13
    v_cvt_pk_bf16_f32 v72, v192, v193
    v_cvt_pk_bf16_f32 v73, v194, v195
    s_waitcnt lgkmcnt(4)
    v_mfma_f32_32x32x16_bf16 v[160:175], v[248:251], v[68:71], v[160:175]
    ds_read_b64_tr_b16 v[232:233], v3 offset:4096
    ds_read_b64_tr_b16 v[234:235], v3 offset:4608
    v_lshlrev_b32 v196, 16, v74
    v_lshlrev_b32 v198, 16, v75
    v_and_b32 v197, s78, v74
    v_and_b32 v199, s78, v75
    v_fma_f32 v196, v196, v12, v13
    v_mfma_f32_32x32x16_bf16 v[176:191], v[252:255], v[68:71], v[176:191]
    ds_read_b64_tr_b16 v[236:237], v4 offset:4096
    ds_read_b64_tr_b16 v[238:239], v4 offset:4608
    v_fma_f32 v198, v198, v12, v13
    v_fma_f32 v197, v197, v12, v13
    v_fma_f32 v199, v199, v12, v13
    v_cvt_pk_bf16_f32 v74, v196, v197
    v_cvt_pk_bf16_f32 v75, v198, v199
    s_waitcnt lgkmcnt(4)
    s_nop 0
    v_mfma_f32_32x32x16_bf16 v[128:143], v[224:227], v[72:75], v[128:143]
    ds_read_b64_tr_b16 v[240:241], v1 offset:6144
    ds_read_b64_tr_b16 v[242:243], v1 offset:6656
    v_lshlrev_b32 v192, 16, v76
    v_lshlrev_b32 v194, 16, v77
    v_and_b32 v193, s78, v76
    v_and_b32 v195, s78, v77
    v_fma_f32 v192, v192, v12, v13
    v_mfma_f32_32x32x16_bf16 v[144:159], v[228:231], v[72:75], v[144:159]
    ds_read_b64_tr_b16 v[244:245], v2 offset:6144
    ds_read_b64_tr_b16 v[246:247], v2 offset:6656
    v_fma_f32 v194, v194, v12, v13
    v_fma_f32 v193, v193, v12, v13
    v_fma_f32 v195, v195, v12, v13
    v_cvt_pk_bf16_f32 v76, v192, v193
    v_cvt_pk_bf16_f32 v77, v194, v195
    s_waitcnt lgkmcnt(4)
    v_mfma_f32_32x32x16_bf16 v[160:175], v[232:235], v[72:75], v[160:175]
    ds_read_b64_tr_b16 v[248:249], v3 offset:6144
    ds_read_b64_tr_b16 v[250:251], v3 offset:6656
    v_lshlrev_b32 v196, 16, v78
    v_lshlrev_b32 v198, 16, v79
    v_and_b32 v197, s78, v78
    v_and_b32 v199, s78, v79
    v_fma_f32 v196, v196, v12, v13
    v_mfma_f32_32x32x16_bf16 v[176:191], v[236:239], v[72:75], v[176:191]
    ds_read_b64_tr_b16 v[252:253], v4 offset:6144
    ds_read_b64_tr_b16 v[254:255], v4 offset:6656
    v_fma_f32 v198, v198, v12, v13
    v_fma_f32 v197, v197, v12, v13
    v_fma_f32 v199, v199, v12, v13
    v_cvt_pk_bf16_f32 v78, v196, v197
    v_cvt_pk_bf16_f32 v79, v198, v199
    s_waitcnt lgkmcnt(4)
    s_nop 0
    v_mfma_f32_32x32x16_bf16 v[128:143], v[240:243], v[76:79], v[128:143]
    ds_read_b64_tr_b16 v[224:225], v1 offset:16384
    ds_read_b64_tr_b16 v[226:227], v1 offset:16896
    v_lshlrev_b32 v192, 16, v80
    v_lshlrev_b32 v194, 16, v81
    v_and_b32 v193, s78, v80
    v_and_b32 v195, s78, v81
    v_fma_f32 v192, v192, v12, v13
    v_mfma_f32_32x32x16_bf16 v[144:159], v[244:247], v[76:79], v[144:159]
    ds_read_b64_tr_b16 v[228:229], v2 offset:16384
    ds_read_b64_tr_b16 v[230:231], v2 offset:16896
    v_fma_f32 v194, v194, v12, v13
    v_fma_f32 v193, v193, v12, v13
    v_fma_f32 v195, v195, v12, v13
    v_cvt_pk_bf16_f32 v80, v192, v193
    v_cvt_pk_bf16_f32 v81, v194, v195
    s_waitcnt lgkmcnt(4)
    v_mfma_f32_32x32x16_bf16 v[160:175], v[248:251], v[76:79], v[160:175]
    ds_read_b64_tr_b16 v[232:233], v3 offset:16384
    ds_read_b64_tr_b16 v[234:235], v3 offset:16896
    v_lshlrev_b32 v196, 16, v82
    v_lshlrev_b32 v198, 16, v83
    v_and_b32 v197, s78, v82
    v_and_b32 v199, s78, v83
    v_fma_f32 v196, v196, v12, v13
    v_mfma_f32_32x32x16_bf16 v[176:191], v[252:255], v[76:79], v[176:191]
    ds_read_b64_tr_b16 v[236:237], v4 offset:16384
    ds_read_b64_tr_b16 v[238:239], v4 offset:16896
    v_fma_f32 v198, v198, v12, v13
    v_fma_f32 v197, v197, v12, v13
    v_fma_f32 v199, v199, v12, v13
    v_cvt_pk_bf16_f32 v82, v196, v197
    v_cvt_pk_bf16_f32 v83, v198, v199
    s_waitcnt lgkmcnt(4)
    s_nop 0
    v_mfma_f32_32x32x16_bf16 v[128:143], v[224:227], v[80:83], v[128:143]
    ds_read_b64_tr_b16 v[240:241], v1 offset:18432
    ds_read_b64_tr_b16 v[242:243], v1 offset:18944
    v_lshlrev_b32 v192, 16, v84
    v_lshlrev_b32 v194, 16, v85
    v_and_b32 v193, s78, v84
    v_and_b32 v195, s78, v85
    v_fma_f32 v192, v192, v12, v13
    v_mfma_f32_32x32x16_bf16 v[144:159], v[228:231], v[80:83], v[144:159]
    ds_read_b64_tr_b16 v[244:245], v2 offset:18432
    ds_read_b64_tr_b16 v[246:247], v2 offset:18944
    v_fma_f32 v194, v194, v12, v13
    v_fma_f32 v193, v193, v12, v13
    v_fma_f32 v195, v195, v12, v13
    v_cvt_pk_bf16_f32 v84, v192, v193
    v_cvt_pk_bf16_f32 v85, v194, v195
    s_waitcnt lgkmcnt(4)
    v_mfma_f32_32x32x16_bf16 v[160:175], v[232:235], v[80:83], v[160:175]
    ds_read_b64_tr_b16 v[248:249], v3 offset:18432
    ds_read_b64_tr_b16 v[250:251], v3 offset:18944
    v_lshlrev_b32 v196, 16, v86
    v_lshlrev_b32 v198, 16, v87
    v_and_b32 v197, s78, v86
    v_and_b32 v199, s78, v87
    v_fma_f32 v196, v196, v12, v13
    v_mfma_f32_32x32x16_bf16 v[176:191], v[236:239], v[80:83], v[176:191]
    ds_read_b64_tr_b16 v[252:253], v4 offset:18432
    ds_read_b64_tr_b16 v[254:255], v4 offset:18944
    v_fma_f32 v198, v198, v12, v13
    v_fma_f32 v197, v197, v12, v13
    v_fma_f32 v199, v199, v12, v13
    v_cvt_pk_bf16_f32 v86, v196, v197
    v_cvt_pk_bf16_f32 v87, v198, v199
    s_waitcnt lgkmcnt(4)
    s_nop 0
    v_mfma_f32_32x32x16_bf16 v[128:143], v[240:243], v[84:87], v[128:143]
    ds_read_b64_tr_b16 v[224:225], v1 offset:20480
    ds_read_b64_tr_b16 v[226:227], v1 offset:20992
    v_lshlrev_b32 v192, 16, v88
    v_lshlrev_b32 v194, 16, v89
    v_and_b32 v193, s78, v88
    v_and_b32 v195, s78, v89
    v_fma_f32 v192, v192, v12, v13
    v_mfma_f32_32x32x16_bf16 v[144:159], v[244:247], v[84:87], v[144:159]
    ds_read_b64_tr_b16 v[228:229], v2 offset:20480
    ds_read_b64_tr_b16 v[230:231], v2 offset:20992
    v_fma_f32 v194, v194, v12, v13
    v_fma_f32 v193, v193, v12, v13
    v_fma_f32 v195, v195, v12, v13
    v_cvt_pk_bf16_f32 v88, v192, v193
    v_cvt_pk_bf16_f32 v89, v194, v195
    s_waitcnt lgkmcnt(4)
    v_mfma_f32_32x32x16_bf16 v[160:175], v[248:251], v[84:87], v[160:175]
    ds_read_b64_tr_b16 v[232:233], v3 offset:20480
    ds_read_b64_tr_b16 v[234:235], v3 offset:20992
    v_lshlrev_b32 v196, 16, v90
    v_lshlrev_b32 v198, 16, v91
    v_and_b32 v197, s78, v90
    v_and_b32 v199, s78, v91
    v_fma_f32 v196, v196, v12, v13
    v_mfma_f32_32x32x16_bf16 v[176:191], v[252:255], v[84:87], v[176:191]
    ds_read_b64_tr_b16 v[236:237], v4 offset:20480
    ds_read_b64_tr_b16 v[238:239], v4 offset:20992
    v_fma_f32 v198, v198, v12, v13
    v_fma_f32 v197, v197, v12, v13
    v_fma_f32 v199, v199, v12, v13
    v_cvt_pk_bf16_f32 v90, v196, v197
    v_cvt_pk_bf16_f32 v91, v198, v199
    s_waitcnt lgkmcnt(4)
    s_nop 0
    v_mfma_f32_32x32x16_bf16 v[128:143], v[224:227], v[88:91], v[128:143]
    ds_read_b64_tr_b16 v[240:241], v1 offset:22528
    ds_read_b64_tr_b16 v[242:243], v1 offset:23040
    v_lshlrev_b32 v192, 16, v92
    v_lshlrev_b32 v194, 16, v93
    v_and_b32 v193, s78, v92
    v_and_b32 v195, s78, v93
    v_fma_f32 v192, v192, v12, v13
    v_mfma_f32_32x32x16_bf16 v[144:159], v[228:231], v[88:91], v[144:159]
    ds_read_b64_tr_b16 v[244:245], v2 offset:22528
    ds_read_b64_tr_b16 v[246:247], v2 offset:23040
    v_fma_f32 v194, v194, v12, v13
    v_fma_f32 v193, v193, v12, v13
    v_fma_f32 v195, v195, v12, v13
    v_cvt_pk_bf16_f32 v92, v192, v193
    v_cvt_pk_bf16_f32 v93, v194, v195
    s_waitcnt lgkmcnt(4)
    v_mfma_f32_32x32x16_bf16 v[160:175], v[232:235], v[88:91], v[160:175]
    ds_read_b64_tr_b16 v[248:249], v3 offset:22528
    ds_read_b64_tr_b16 v[250:251], v3 offset:23040
    v_lshlrev_b32 v196, 16, v94
    v_lshlrev_b32 v198, 16, v95
    v_and_b32 v197, s78, v94
    v_and_b32 v199, s78, v95
    v_fma_f32 v196, v196, v12, v13
    v_mfma_f32_32x32x16_bf16 v[176:191], v[236:239], v[88:91], v[176:191]
    ds_read_b64_tr_b16 v[252:253], v4 offset:22528
    ds_read_b64_tr_b16 v[254:255], v4 offset:23040
    v_fma_f32 v198, v198, v12, v13
    v_fma_f32 v197, v197, v12, v13
    v_fma_f32 v199, v199, v12, v13
    v_cvt_pk_bf16_f32 v94, v196, v197
    v_cvt_pk_bf16_f32 v95, v198, v199
    s_waitcnt lgkmcnt(4)
    s_nop 0
    v_mfma_f32_32x32x16_bf16 v[128:143], v[240:243], v[92:95], v[128:143]
    v_lshlrev_b32 v192, 16, v96
    v_lshlrev_b32 v194, 16, v97
    v_and_b32 v193, s78, v96
    v_and_b32 v195, s78, v97
    v_fma_f32 v192, v192, v12, v13
    v_mfma_f32_32x32x16_bf16 v[144:159], v[244:247], v[92:95], v[144:159]
    v_fma_f32 v194, v194, v12, v13
    v_fma_f32 v193, v193, v12, v13
    v_fma_f32 v195, v195, v12, v13
    v_cvt_pk_bf16_f32 v96, v192, v193
    v_cvt_pk_bf16_f32 v97, v194, v195
    s_waitcnt lgkmcnt(0)
    v_mfma_f32_32x32x16_bf16 v[160:175], v[248:251], v[92:95], v[160:175]
    s_barrier
    ds_read_b64_tr_b16 v[224:225], v1 offset:32768
    ds_read_b64_tr_b16 v[226:227], v1 offset:33280
    ds_read_b64_tr_b16 v[228:229], v2 offset:32768
    ds_read_b64_tr_b16 v[230:231], v2 offset:33280
    v_lshlrev_b32 v196, 16, v98
    v_lshlrev_b32 v198, 16, v99
    v_and_b32 v197, s78, v98
    v_and_b32 v199, s78, v99
    v_fma_f32 v196, v196, v12, v13
    v_mfma_f32_32x32x16_bf16 v[176:191], v[252:255], v[92:95], v[176:191]
    ds_read_b64_tr_b16 v[232:233], v3 offset:32768
    ds_read_b64_tr_b16 v[234:235], v3 offset:33280
    ds_read_b64_tr_b16 v[236:237], v4 offset:32768
    ds_read_b64_tr_b16 v[238:239], v4 offset:33280
    v_fma_f32 v198, v198, v12, v13
    v_fma_f32 v197, v197, v12, v13
    v_fma_f32 v199, v199, v12, v13
    v_cvt_pk_bf16_f32 v98, v196, v197
    v_cvt_pk_bf16_f32 v99, v198, v199
    s_waitcnt lgkmcnt(4)
    s_nop 0
    v_mfma_f32_32x32x16_bf16 v[128:143], v[224:227], v[96:99], v[128:143]
    ds_read_b64_tr_b16 v[240:241], v1 offset:34816
    ds_read_b64_tr_b16 v[242:243], v1 offset:35328
    v_lshlrev_b32 v192, 16, v100
    v_lshlrev_b32 v194, 16, v101
    v_and_b32 v193, s78, v100
    v_and_b32 v195, s78, v101
    v_fma_f32 v192, v192, v12, v13
    v_mfma_f32_32x32x16_bf16 v[144:159], v[228:231], v[96:99], v[144:159]
    ds_read_b64_tr_b16 v[244:245], v2 offset:34816
    ds_read_b64_tr_b16 v[246:247], v2 offset:35328
    v_fma_f32 v194, v194, v12, v13
    v_fma_f32 v193, v193, v12, v13
    v_fma_f32 v195, v195, v12, v13
    v_cvt_pk_bf16_f32 v100, v192, v193
    v_cvt_pk_bf16_f32 v101, v194, v195
    s_waitcnt lgkmcnt(4)
    v_mfma_f32_32x32x16_bf16 v[160:175], v[232:235], v[96:99], v[160:175]
    ds_read_b64_tr_b16 v[248:249], v3 offset:34816
    ds_read_b64_tr_b16 v[250:251], v3 offset:35328
    v_lshlrev_b32 v196, 16, v102
    v_lshlrev_b32 v198, 16, v103
    v_and_b32 v197, s78, v102
    v_and_b32 v199, s78, v103
    v_fma_f32 v196, v196, v12, v13
    v_mfma_f32_32x32x16_bf16 v[176:191], v[236:239], v[96:99], v[176:191]
    ds_read_b64_tr_b16 v[252:253], v4 offset:34816
    ds_read_b64_tr_b16 v[254:255], v4 offset:35328
    v_fma_f32 v198, v198, v12, v13
    v_fma_f32 v197, v197, v12, v13
    v_fma_f32 v199, v199, v12, v13
    v_cvt_pk_bf16_f32 v102, v196, v197
    v_cvt_pk_bf16_f32 v103, v198, v199
    s_waitcnt lgkmcnt(4)
    s_nop 0
    v_mfma_f32_32x32x16_bf16 v[128:143], v[240:243], v[100:103], v[128:143]
    ds_read_b64_tr_b16 v[224:225], v1 offset:36864
    ds_read_b64_tr_b16 v[226:227], v1 offset:37376
    v_lshlrev_b32 v192, 16, v104
    v_lshlrev_b32 v194, 16, v105
    v_and_b32 v193, s78, v104
    v_and_b32 v195, s78, v105
    v_fma_f32 v192, v192, v12, v13
    v_mfma_f32_32x32x16_bf16 v[144:159], v[244:247], v[100:103], v[144:159]
    ds_read_b64_tr_b16 v[228:229], v2 offset:36864
    ds_read_b64_tr_b16 v[230:231], v2 offset:37376
    v_fma_f32 v194, v194, v12, v13
    v_fma_f32 v193, v193, v12, v13
    v_fma_f32 v195, v195, v12, v13
    v_cvt_pk_bf16_f32 v104, v192, v193
    v_cvt_pk_bf16_f32 v105, v194, v195
    s_waitcnt lgkmcnt(4)
    v_mfma_f32_32x32x16_bf16 v[160:175], v[248:251], v[100:103], v[160:175]
    ds_read_b64_tr_b16 v[232:233], v3 offset:36864
    ds_read_b64_tr_b16 v[234:235], v3 offset:37376
    v_lshlrev_b32 v196, 16, v106
    v_lshlrev_b32 v198, 16, v107
    v_and_b32 v197, s78, v106
    v_and_b32 v199, s78, v107
    v_fma_f32 v196, v196, v12, v13
    v_mfma_f32_32x32x16_bf16 v[176:191], v[252:255], v[100:103], v[176:191]
    ds_read_b64_tr_b16 v[236:237], v4 offset:36864
    ds_read_b64_tr_b16 v[238:239], v4 offset:37376
    v_fma_f32 v198, v198, v12, v13
    v_fma_f32 v197, v197, v12, v13
    v_fma_f32 v199, v199, v12, v13
    v_cvt_pk_bf16_f32 v106, v196, v197
    v_cvt_pk_bf16_f32 v107, v198, v199
    s_waitcnt lgkmcnt(4)
    s_nop 0
    v_mfma_f32_32x32x16_bf16 v[128:143], v[224:227], v[104:107], v[128:143]
    ds_read_b64_tr_b16 v[240:241], v1 offset:38912
    ds_read_b64_tr_b16 v[242:243], v1 offset:39424
    v_lshlrev_b32 v192, 16, v108
    v_lshlrev_b32 v194, 16, v109
    v_and_b32 v193, s78, v108
    v_and_b32 v195, s78, v109
    v_fma_f32 v192, v192, v12, v13
    v_mfma_f32_32x32x16_bf16 v[144:159], v[228:231], v[104:107], v[144:159]
    ds_read_b64_tr_b16 v[244:245], v2 offset:38912
    ds_read_b64_tr_b16 v[246:247], v2 offset:39424
    v_fma_f32 v194, v194, v12, v13
    v_fma_f32 v193, v193, v12, v13
    v_fma_f32 v195, v195, v12, v13
    v_cvt_pk_bf16_f32 v108, v192, v193
    v_cvt_pk_bf16_f32 v109, v194, v195
    s_waitcnt lgkmcnt(4)
    v_mfma_f32_32x32x16_bf16 v[160:175], v[232:235], v[104:107], v[160:175]
    ds_read_b64_tr_b16 v[248:249], v3 offset:38912
    ds_read_b64_tr_b16 v[250:251], v3 offset:39424
    v_lshlrev_b32 v196, 16, v110
    v_lshlrev_b32 v198, 16, v111
    v_and_b32 v197, s78, v110
    v_and_b32 v199, s78, v111
    v_fma_f32 v196, v196, v12, v13
    v_mfma_f32_32x32x16_bf16 v[176:191], v[236:239], v[104:107], v[176:191]
    ds_read_b64_tr_b16 v[252:253], v4 offset:38912
    ds_read_b64_tr_b16 v[254:255], v4 offset:39424
    v_fma_f32 v198, v198, v12, v13
    v_fma_f32 v197, v197, v12, v13
    v_fma_f32 v199, v199, v12, v13
    v_cvt_pk_bf16_f32 v110, v196, v197
    v_cvt_pk_bf16_f32 v111, v198, v199
    s_waitcnt lgkmcnt(4)
    s_nop 0
    v_mfma_f32_32x32x16_bf16 v[128:143], v[240:243], v[108:111], v[128:143]
    ds_read_b64_tr_b16 v[224:225], v1 offset:49152
    ds_read_b64_tr_b16 v[226:227], v1 offset:49664
    v_lshlrev_b32 v192, 16, v112
    v_lshlrev_b32 v194, 16, v113
    v_and_b32 v193, s78, v112
    v_and_b32 v195, s78, v113
    v_fma_f32 v192, v192, v12, v13
    v_mfma_f32_32x32x16_bf16 v[144:159], v[244:247], v[108:111], v[144:159]
    ds_read_b64_tr_b16 v[228:229], v2 offset:49152
    ds_read_b64_tr_b16 v[230:231], v2 offset:49664
    v_fma_f32 v194, v194, v12, v13
    v_fma_f32 v193, v193, v12, v13
    v_fma_f32 v195, v195, v12, v13
    v_cvt_pk_bf16_f32 v112, v192, v193
    v_cvt_pk_bf16_f32 v113, v194, v195
    s_waitcnt lgkmcnt(4)
    v_mfma_f32_32x32x16_bf16 v[160:175], v[248:251], v[108:111], v[160:175]
    ds_read_b64_tr_b16 v[232:233], v3 offset:49152
    ds_read_b64_tr_b16 v[234:235], v3 offset:49664
    v_lshlrev_b32 v196, 16, v114
    v_lshlrev_b32 v198, 16, v115
    v_and_b32 v197, s78, v114
    v_and_b32 v199, s78, v115
    v_fma_f32 v196, v196, v12, v13
    v_mfma_f32_32x32x16_bf16 v[176:191], v[252:255], v[108:111], v[176:191]
    ds_read_b64_tr_b16 v[236:237], v4 offset:49152
    ds_read_b64_tr_b16 v[238:239], v4 offset:49664
    v_fma_f32 v198, v198, v12, v13
    v_fma_f32 v197, v197, v12, v13
    v_fma_f32 v199, v199, v12, v13
    v_cvt_pk_bf16_f32 v114, v196, v197
    v_cvt_pk_bf16_f32 v115, v198, v199
    s_waitcnt lgkmcnt(4)
    s_nop 0
    v_mfma_f32_32x32x16_bf16 v[128:143], v[224:227], v[112:115], v[128:143]
    ds_read_b64_tr_b16 v[240:241], v1 offset:51200
    ds_read_b64_tr_b16 v[242:243], v1 offset:51712
    v_lshlrev_b32 v192, 16, v116
    v_lshlrev_b32 v194, 16, v117
    v_and_b32 v193, s78, v116
    v_and_b32 v195, s78, v117
    v_fma_f32 v192, v192, v12, v13
    v_mfma_f32_32x32x16_bf16 v[144:159], v[228:231], v[112:115], v[144:159]
    ds_read_b64_tr_b16 v[244:245], v2 offset:51200
    ds_read_b64_tr_b16 v[246:247], v2 offset:51712
    v_fma_f32 v194, v194, v12, v13
    v_fma_f32 v193, v193, v12, v13
    v_fma_f32 v195, v195, v12, v13
    v_cvt_pk_bf16_f32 v116, v192, v193
    v_cvt_pk_bf16_f32 v117, v194, v195
    s_waitcnt lgkmcnt(4)
    v_mfma_f32_32x32x16_bf16 v[160:175], v[232:235], v[112:115], v[160:175]
    ds_read_b64_tr_b16 v[248:249], v3 offset:51200
    ds_read_b64_tr_b16 v[250:251], v3 offset:51712
    v_lshlrev_b32 v196, 16, v118
    v_lshlrev_b32 v198, 16, v119
    v_and_b32 v197, s78, v118
    v_and_b32 v199, s78, v119
    v_fma_f32 v196, v196, v12, v13
    v_mfma_f32_32x32x16_bf16 v[176:191], v[236:239], v[112:115], v[176:191]
    ds_read_b64_tr_b16 v[252:253], v4 offset:51200
    ds_read_b64_tr_b16 v[254:255], v4 offset:51712
    v_fma_f32 v198, v198, v12, v13
    v_fma_f32 v197, v197, v12, v13
    v_fma_f32 v199, v199, v12, v13
    v_cvt_pk_bf16_f32 v118, v196, v197
    v_cvt_pk_bf16_f32 v119, v198, v199
    s_waitcnt lgkmcnt(4)
    s_nop 0
    v_mfma_f32_32x32x16_bf16 v[128:143], v[240:243], v[116:119], v[128:143]
    ds_read_b64_tr_b16 v[224:225], v1 offset:53248
    ds_read_b64_tr_b16 v[226:227], v1 offset:53760
    v_lshlrev_b32 v192, 16, v120
    v_lshlrev_b32 v194, 16, v121
    v_and_b32 v193, s78, v120
    v_and_b32 v195, s78, v121
    v_fma_f32 v192, v192, v12, v13
    v_mfma_f32_32x32x16_bf16 v[144:159], v[244:247], v[116:119], v[144:159]
    ds_read_b64_tr_b16 v[228:229], v2 offset:53248
    ds_read_b64_tr_b16 v[230:231], v2 offset:53760
    v_fma_f32 v194, v194, v12, v13
    v_fma_f32 v193, v193, v12, v13
    v_fma_f32 v195, v195, v12, v13
    v_cvt_pk_bf16_f32 v120, v192, v193
    v_cvt_pk_bf16_f32 v121, v194, v195
    s_waitcnt lgkmcnt(4)
    v_mfma_f32_32x32x16_bf16 v[160:175], v[248:251], v[116:119], v[160:175]
    ds_read_b64_tr_b16 v[232:233], v3 offset:53248
    ds_read_b64_tr_b16 v[234:235], v3 offset:53760
    v_lshlrev_b32 v196, 16, v122
    v_lshlrev_b32 v198, 16, v123
    v_and_b32 v197, s78, v122
    v_and_b32 v199, s78, v123
    v_fma_f32 v196, v196, v12, v13
    v_mfma_f32_32x32x16_bf16 v[176:191], v[252:255], v[116:119], v[176:191]
    ds_read_b64_tr_b16 v[236:237], v4 offset:53248
    ds_read_b64_tr_b16 v[238:239], v4 offset:53760
    v_fma_f32 v198, v198, v12, v13
    v_fma_f32 v197, v197, v12, v13
    v_fma_f32 v199, v199, v12, v13
    v_cvt_pk_bf16_f32 v122, v196, v197
    v_cvt_pk_bf16_f32 v123, v198, v199
    s_waitcnt lgkmcnt(4)
    s_nop 0
    v_mfma_f32_32x32x16_bf16 v[128:143], v[224:227], v[120:123], v[128:143]
    ds_read_b64_tr_b16 v[240:241], v1 offset:55296
    ds_read_b64_tr_b16 v[242:243], v1 offset:55808
    v_lshlrev_b32 v192, 16, v124
    v_lshlrev_b32 v194, 16, v125
    v_and_b32 v193, s78, v124
    v_and_b32 v195, s78, v125
    v_fma_f32 v192, v192, v12, v13
    v_mfma_f32_32x32x16_bf16 v[144:159], v[228:231], v[120:123], v[144:159]
    ds_read_b64_tr_b16 v[244:245], v2 offset:55296
    ds_read_b64_tr_b16 v[246:247], v2 offset:55808
    v_fma_f32 v194, v194, v12, v13
    v_fma_f32 v193, v193, v12, v13
    v_fma_f32 v195, v195, v12, v13
    v_cvt_pk_bf16_f32 v124, v192, v193
    v_cvt_pk_bf16_f32 v125, v194, v195
    s_waitcnt lgkmcnt(4)
    v_mfma_f32_32x32x16_bf16 v[160:175], v[232:235], v[120:123], v[160:175]
    ds_read_b64_tr_b16 v[248:249], v3 offset:55296
    ds_read_b64_tr_b16 v[250:251], v3 offset:55808
    v_lshlrev_b32 v196, 16, v126
    v_lshlrev_b32 v198, 16, v127
    v_and_b32 v197, s78, v126
    v_and_b32 v199, s78, v127
    v_fma_f32 v196, v196, v12, v13
    v_mfma_f32_32x32x16_bf16 v[176:191], v[236:239], v[120:123], v[176:191]
    ds_read_b64_tr_b16 v[252:253], v4 offset:55296
    ds_read_b64_tr_b16 v[254:255], v4 offset:55808
    v_fma_f32 v198, v198, v12, v13
    v_fma_f32 v197, v197, v12, v13
    v_fma_f32 v199, v199, v12, v13
    v_cvt_pk_bf16_f32 v126, v196, v197
    v_cvt_pk_bf16_f32 v127, v198, v199
    s_waitcnt lgkmcnt(4)
    s_nop 0
    v_mfma_f32_32x32x16_bf16 v[128:143], v[240:243], v[124:127], v[128:143]
    v_cmp_lt_u32 vcc, 511, v0
    v_mov_b32 v5, 0x3f803f80
    v_mov_b32 v6, 0x3f80
    s_lshl_b32 s5, s62, 11
    v_mfma_f32_32x32x16_bf16 v[144:159], v[244:247], v[124:127], v[144:159]
    s_add_u32 s5, s5, 49152
    v_bfe_u32 v8, v0, 4, 5
    v_lshlrev_b32 v8, 6, v8
    v_lshrrev_b32 v9, 9, v0
    v_lshl_add_u32 v8, v9, 3, v8
    s_waitcnt lgkmcnt(0)
    v_mfma_f32_32x32x16_bf16 v[160:175], v[248:251], v[124:127], v[160:175]
    s_barrier
    v_add_u32 v1, 65536, v200
    v_xor_b32 v2, 32, v1
    v_xor_b32 v3, 64, v1
    v_xor_b32 v4, 0x60, v1
    ds_read_b64_tr_b16 v[224:225], v1 offset:0
    ds_read_b64_tr_b16 v[226:227], v1 offset:512
    ds_read_b64_tr_b16 v[228:229], v2 offset:0
    ds_read_b64_tr_b16 v[230:231], v2 offset:512
    ds_read_b64_tr_b16 v[232:233], v1 offset:2048
    ds_read_b64_tr_b16 v[234:235], v1 offset:2560
    ds_read_b64_tr_b16 v[236:237], v2 offset:2048
    ds_read_b64_tr_b16 v[238:239], v2 offset:2560
    v_add_u32 v8, s5, v8
    v_bfe_u32 v10, v0, 6, 2
    v_lshl_add_u32 v10, v9, 2, v10
    v_lshlrev_b32 v10, 6, v10
    v_mfma_f32_32x32x16_bf16 v[176:191], v[252:255], v[124:127], v[176:191]
    v_bfe_u32 v11, v0, 8, 1
    v_lshl_add_u32 v10, v11, 5, v10
    v_bfe_u32 v11, v0, 4, 2
    v_lshl_add_u32 v10, v11, 3, v10
    v_add_u32 v10, s5, v10
    s_cmp_lt_u32 s61, 4
    s_cbranch_scc1 K1_QKV
    buffer_load_dword v14, off, s[80:83], 0 sc1
    s_waitcnt lgkmcnt(4)
    v_mfma_f32_32x32x16_bf16 v[192:207], v[224:227], v[16:19], 0
    ds_read_b64_tr_b16 v[240:241], v1 offset:4096
    ds_read_b64_tr_b16 v[242:243], v1 offset:4608
    ds_read_b64_tr_b16 v[248:249], v1 offset:6144
    ds_read_b64_tr_b16 v[250:251], v1 offset:6656
    v_mfma_f32_32x32x16_bf16 v[208:223], v[228:231], v[16:19], 0
    ds_read_b64_tr_b16 v[244:245], v2 offset:4096
    ds_read_b64_tr_b16 v[246:247], v2 offset:4608
    ds_read_b64_tr_b16 v[252:253], v2 offset:6144
    ds_read_b64_tr_b16 v[254:255], v2 offset:6656
    s_waitcnt lgkmcnt(8)
    v_mfma_f32_32x32x16_bf16 v[192:207], v[232:235], v[20:23], v[192:207]
    ds_read_b64_tr_b16 v[224:225], v1 offset:16384
    ds_read_b64_tr_b16 v[226:227], v1 offset:16896
    v_mfma_f32_32x32x16_bf16 v[208:223], v[236:239], v[20:23], v[208:223]
    ds_read_b64_tr_b16 v[228:229], v2 offset:16384
    ds_read_b64_tr_b16 v[230:231], v2 offset:16896
    v_mul_f32 v128, s75, v128
    v_mul_f32 v129, s75, v129
    s_waitcnt lgkmcnt(6)
    v_mfma_f32_32x32x16_bf16 v[192:207], v[240:243], v[24:27], v[192:207]
    ds_read_b64_tr_b16 v[232:233], v1 offset:18432
    ds_read_b64_tr_b16 v[234:235], v1 offset:18944
    v_mul_f32 v130, s75, v130
    v_mul_f32 v131, s75, v131
    v_mul_f32 v132, s75, v132
    v_mfma_f32_32x32x16_bf16 v[208:223], v[244:247], v[24:27], v[208:223]
    ds_read_b64_tr_b16 v[236:237], v2 offset:18432
    ds_read_b64_tr_b16 v[238:239], v2 offset:18944
    v_mul_f32 v133, s75, v133
    v_mul_f32 v134, s75, v134
    s_waitcnt lgkmcnt(8)
    v_mfma_f32_32x32x16_bf16 v[192:207], v[248:251], v[28:31], v[192:207]
    ds_read_b64_tr_b16 v[240:241], v1 offset:20480
    ds_read_b64_tr_b16 v[242:243], v1 offset:20992
    v_mul_f32 v135, s75, v135
    v_exp_f32 v128, v128
    v_exp_f32 v129, v129
    v_mfma_f32_32x32x16_bf16 v[208:223], v[252:255], v[28:31], v[208:223]
    ds_read_b64_tr_b16 v[244:245], v2 offset:20480
    ds_read_b64_tr_b16 v[246:247], v2 offset:20992
    v_exp_f32 v130, v130
    v_exp_f32 v131, v131
    s_waitcnt lgkmcnt(8)
    v_mfma_f32_32x32x16_bf16 v[192:207], v[224:227], v[32:35], v[192:207]
    ds_read_b64_tr_b16 v[248:249], v1 offset:22528
    ds_read_b64_tr_b16 v[250:251], v1 offset:23040
    v_exp_f32 v132, v132
    v_exp_f32 v133, v133
    v_exp_f32 v134, v134
    v_mfma_f32_32x32x16_bf16 v[208:223], v[228:231], v[32:35], v[208:223]
    ds_read_b64_tr_b16 v[252:253], v2 offset:22528
    ds_read_b64_tr_b16 v[254:255], v2 offset:23040
    v_exp_f32 v135, v135
    v_add_f32 v128, 1.0, v128
    s_waitcnt lgkmcnt(8)
    v_mfma_f32_32x32x16_bf16 v[192:207], v[232:235], v[36:39], v[192:207]
    ds_read_b64_tr_b16 v[224:225], v1 offset:32768
    ds_read_b64_tr_b16 v[226:227], v1 offset:33280
    v_add_f32 v129, 1.0, v129
    v_add_f32 v130, 1.0, v130
    v_add_f32 v131, 1.0, v131
    v_mfma_f32_32x32x16_bf16 v[208:223], v[236:239], v[36:39], v[208:223]
    ds_read_b64_tr_b16 v[228:229], v2 offset:32768
    ds_read_b64_tr_b16 v[230:231], v2 offset:33280
    v_add_f32 v132, 1.0, v132
    v_add_f32 v133, 1.0, v133
    s_waitcnt lgkmcnt(8)
    v_mfma_f32_32x32x16_bf16 v[192:207], v[240:243], v[40:43], v[192:207]
    ds_read_b64_tr_b16 v[232:233], v1 offset:34816
    ds_read_b64_tr_b16 v[234:235], v1 offset:35328
    v_add_f32 v134, 1.0, v134
    v_add_f32 v135, 1.0, v135
    v_rcp_f32 v128, v128
    v_mfma_f32_32x32x16_bf16 v[208:223], v[244:247], v[40:43], v[208:223]
    ds_read_b64_tr_b16 v[236:237], v2 offset:34816
    ds_read_b64_tr_b16 v[238:239], v2 offset:35328
    v_rcp_f32 v129, v129
    v_rcp_f32 v130, v130
    v_rcp_f32 v131, v131
    s_waitcnt lgkmcnt(8)
    v_mfma_f32_32x32x16_bf16 v[192:207], v[248:251], v[44:47], v[192:207]
    ds_read_b64_tr_b16 v[240:241], v1 offset:36864
    ds_read_b64_tr_b16 v[242:243], v1 offset:37376
    v_rcp_f32 v132, v132
    v_rcp_f32 v133, v133
    v_mfma_f32_32x32x16_bf16 v[208:223], v[252:255], v[44:47], v[208:223]
    ds_read_b64_tr_b16 v[244:245], v2 offset:36864
    ds_read_b64_tr_b16 v[246:247], v2 offset:37376
    v_rcp_f32 v134, v134
    v_rcp_f32 v135, v135
    v_mul_f32 v128, v128, v136
    s_waitcnt lgkmcnt(8)
    v_mfma_f32_32x32x16_bf16 v[192:207], v[224:227], v[48:51], v[192:207]
    ds_read_b64_tr_b16 v[248:249], v1 offset:38912
    ds_read_b64_tr_b16 v[250:251], v1 offset:39424
    v_mul_f32 v129, v129, v137
    v_mul_f32 v130, v130, v138
    v_mfma_f32_32x32x16_bf16 v[208:223], v[228:231], v[48:51], v[208:223]
    ds_read_b64_tr_b16 v[252:253], v2 offset:38912
    ds_read_b64_tr_b16 v[254:255], v2 offset:39424
    v_mul_f32 v131, v131, v139
    v_mul_f32 v132, v132, v140
    v_mul_f32 v133, v133, v141
    s_waitcnt lgkmcnt(8)
    v_mfma_f32_32x32x16_bf16 v[192:207], v[232:235], v[52:55], v[192:207]
    ds_read_b64_tr_b16 v[224:225], v1 offset:49152
    ds_read_b64_tr_b16 v[226:227], v1 offset:49664
    v_mul_f32 v134, v134, v142
    v_mul_f32 v135, v135, v143
    v_mfma_f32_32x32x16_bf16 v[208:223], v[236:239], v[52:55], v[208:223]
    ds_read_b64_tr_b16 v[228:229], v2 offset:49152
    ds_read_b64_tr_b16 v[230:231], v2 offset:49664
    v_cvt_pk_bf16_f32 v136, v128, v129
    v_cvt_pk_bf16_f32 v137, v130, v131
    v_cvt_pk_bf16_f32 v138, v132, v133
    s_waitcnt lgkmcnt(8)
    v_mfma_f32_32x32x16_bf16 v[192:207], v[240:243], v[56:59], v[192:207]
    ds_read_b64_tr_b16 v[232:233], v1 offset:51200
    ds_read_b64_tr_b16 v[234:235], v1 offset:51712
    v_cvt_pk_bf16_f32 v139, v134, v135
    buffer_store_dwordx4 v[136:139], v0, s[52:55], s65 offen offset:0 sc1
    v_mfma_f32_32x32x16_bf16 v[208:223], v[244:247], v[56:59], v[208:223]
    ds_read_b64_tr_b16 v[236:237], v2 offset:51200
    ds_read_b64_tr_b16 v[238:239], v2 offset:51712
    v_mul_f32 v144, s75, v144
    v_mul_f32 v145, s75, v145
    v_mul_f32 v146, s75, v146
    s_waitcnt lgkmcnt(8)
    v_mfma_f32_32x32x16_bf16 v[192:207], v[248:251], v[60:63], v[192:207]
    ds_read_b64_tr_b16 v[240:241], v1 offset:53248
    ds_read_b64_tr_b16 v[242:243], v1 offset:53760
    v_mul_f32 v147, s75, v147
    v_mul_f32 v148, s75, v148
    v_mfma_f32_32x32x16_bf16 v[208:223], v[252:255], v[60:63], v[208:223]
    ds_read_b64_tr_b16 v[244:245], v2 offset:53248
    ds_read_b64_tr_b16 v[246:247], v2 offset:53760
    v_mul_f32 v149, s75, v149
    v_mul_f32 v150, s75, v150
    v_mul_f32 v151, s75, v151
    s_waitcnt lgkmcnt(8)
    v_mfma_f32_32x32x16_bf16 v[192:207], v[224:227], v[64:67], v[192:207]
    ds_read_b64_tr_b16 v[248:249], v1 offset:55296
    ds_read_b64_tr_b16 v[250:251], v1 offset:55808
    v_exp_f32 v144, v144
    v_exp_f32 v145, v145
    v_exp_f32 v146, v146
    v_mfma_f32_32x32x16_bf16 v[208:223], v[228:231], v[64:67], v[208:223]
    ds_read_b64_tr_b16 v[252:253], v2 offset:55296
    ds_read_b64_tr_b16 v[254:255], v2 offset:55808
    v_exp_f32 v147, v147
    v_exp_f32 v148, v148
    s_waitcnt lgkmcnt(8)
    v_mfma_f32_32x32x16_bf16 v[192:207], v[232:235], v[68:71], v[192:207]
    v_add_u32 v1, 32768, v1
    v_add_u32 v2, 32768, v2
    v_add_u32 v3, 32768, v3
    v_add_u32 v4, 32768, v4
    ds_read_b64_tr_b16 v[224:225], v1 offset:32768
    ds_read_b64_tr_b16 v[226:227], v1 offset:33280
    v_exp_f32 v149, v149
    v_exp_f32 v150, v150
    v_exp_f32 v151, v151
    v_mfma_f32_32x32x16_bf16 v[208:223], v[236:239], v[68:71], v[208:223]
    ds_read_b64_tr_b16 v[228:229], v2 offset:32768
    ds_read_b64_tr_b16 v[230:231], v2 offset:33280
    v_add_f32 v144, 1.0, v144
    v_add_f32 v145, 1.0, v145
    s_waitcnt lgkmcnt(8)
    v_mfma_f32_32x32x16_bf16 v[192:207], v[240:243], v[72:75], v[192:207]
    ds_read_b64_tr_b16 v[232:233], v1 offset:34816
    ds_read_b64_tr_b16 v[234:235], v1 offset:35328
    v_add_f32 v146, 1.0, v146
    v_add_f32 v147, 1.0, v147
    v_add_f32 v148, 1.0, v148
    v_mfma_f32_32x32x16_bf16 v[208:223], v[244:247], v[72:75], v[208:223]
    ds_read_b64_tr_b16 v[236:237], v2 offset:34816
    ds_read_b64_tr_b16 v[238:239], v2 offset:35328
    v_add_f32 v149, 1.0, v149
    v_add_f32 v150, 1.0, v150
    s_waitcnt lgkmcnt(8)
    v_mfma_f32_32x32x16_bf16 v[192:207], v[248:251], v[76:79], v[192:207]
    ds_read_b64_tr_b16 v[240:241], v1 offset:36864
    ds_read_b64_tr_b16 v[242:243], v1 offset:37376
    s_mov_b32 s40, s24
    s_mov_b32 s41, s25
    s_mov_b32 s42, 1605632
    v_add_f32 v151, 1.0, v151
    v_rcp_f32 v144, v144
    v_rcp_f32 v145, v145
    v_mfma_f32_32x32x16_bf16 v[208:223], v[252:255], v[76:79], v[208:223]
    ds_read_b64_tr_b16 v[244:245], v2 offset:36864
    ds_read_b64_tr_b16 v[246:247], v2 offset:37376
    s_mov_b32 s43, 0x20000
    s_and_b32 s4, s61, 7
    s_cmp_lt_u32 s61, 8
    v_rcp_f32 v146, v146
    v_rcp_f32 v147, v147
    s_waitcnt lgkmcnt(8)
    v_mfma_f32_32x32x16_bf16 v[192:207], v[224:227], v[80:83], v[192:207]
    ds_read_b64_tr_b16 v[248:249], v1 offset:38912
    ds_read_b64_tr_b16 v[250:251], v1 offset:39424
    s_cselect_b32 s5, 3, 7
    s_cmp_gt_u32 s4, s5
    s_subb_u32 s70, s4, 0
    v_rcp_f32 v148, v148
    v_rcp_f32 v149, v149
    v_rcp_f32 v150, v150
    v_mfma_f32_32x32x16_bf16 v[208:223], v[228:231], v[80:83], v[208:223]
    ds_read_b64_tr_b16 v[252:253], v2 offset:38912
    ds_read_b64_tr_b16 v[254:255], v2 offset:39424
    s_cmp_eq_u32 s4, s5
    s_and_b32 s5, s60, 3
    s_mul_i32 s5, s5, 7
    s_lshl_b32 s6, s70, 2
    v_rcp_f32 v151, v151
    v_mul_f32 v144, v144, v152
    s_waitcnt lgkmcnt(8)
    v_mfma_f32_32x32x16_bf16 v[192:207], v[232:235], v[84:87], v[192:207]
    ds_read_b64_tr_b16 v[224:225], v1 offset:49152
    ds_read_b64_tr_b16 v[226:227], v1 offset:49664
    s_add_u32 s5, s5, s6
    s_cmp_ge_u32 s5, 28
    s_cselect_b32 s6, 28, 0
    v_mul_f32 v145, v145, v153
    v_mul_f32 v146, v146, v154
    v_mul_f32 v147, v147, v155
    v_mfma_f32_32x32x16_bf16 v[208:223], v[236:239], v[84:87], v[208:223]
    ds_read_b64_tr_b16 v[228:229], v2 offset:49152
    ds_read_b64_tr_b16 v[230:231], v2 offset:49664
    s_sub_u32 s63, s5, s6
    s_add_u32 s5, s63, 6
    s_cmp_ge_u32 s5, 28
    v_mul_f32 v148, v148, v156
    v_mul_f32 v149, v149, v157
    v_mul_f32 v150, v150, v158
    s_waitcnt lgkmcnt(8)
    v_mfma_f32_32x32x16_bf16 v[192:207], v[240:243], v[88:91], v[192:207]
    ds_read_b64_tr_b16 v[232:233], v1 offset:51200
    ds_read_b64_tr_b16 v[234:235], v1 offset:51712
    s_cselect_b32 s6, 28, 0
    s_sub_u32 s5, s5, s6
    s_mul_i32 s73, s5, 14336
    s_mul_i32 s74, s62, 12288
    v_mul_f32 v151, v151, v159
    v_cvt_pk_bf16_f32 v152, v144, v145
    v_mfma_f32_32x32x16_bf16 v[208:223], v[244:247], v[88:91], v[208:223]
    ds_read_b64_tr_b16 v[236:237], v2 offset:51200
    ds_read_b64_tr_b16 v[238:239], v2 offset:51712
    s_add_u32 s74, s74, 16384
    s_lshl_b32 s5, s70, 7
    s_mul_i32 s6, s62, 401408
    v_cvt_pk_bf16_f32 v153, v146, v147
    v_cvt_pk_bf16_f32 v154, v148, v149
    v_cvt_pk_bf16_f32 v155, v150, v151
    s_waitcnt lgkmcnt(8)
    v_mfma_f32_32x32x16_bf16 v[192:207], v[248:251], v[92:95], v[192:207]
    ds_read_b64_tr_b16 v[240:241], v1 offset:53248
    ds_read_b64_tr_b16 v[242:243], v1 offset:53760
    s_add_u32 s5, s5, s6
    v_lshrrev_b32 v7, 7, v0
    v_mul_u32_u24 v7, 896, v7
    buffer_store_dwordx4 v[152:155], v0, s[52:55], s65 offen offset:1024 sc1
    v_mul_f32 v160, s75, v160
    v_mfma_f32_32x32x16_bf16 v[208:223], v[252:255], v[92:95], v[208:223]
    ds_read_b64_tr_b16 v[244:245], v2 offset:53248
    ds_read_b64_tr_b16 v[246:247], v2 offset:53760
    v_and_b32 v13, 0x70, v0
    v_add_u32 v7, v7, v13
    v_add_u32 v12, s5, v7
    v_add_u32 v13, 7168, v12
    v_mul_f32 v161, s75, v161
    v_mul_f32 v162, s75, v162
    v_mul_f32 v163, s75, v163
    s_waitcnt lgkmcnt(8)
    v_mfma_f32_32x32x16_bf16 v[192:207], v[224:227], v[96:99], v[192:207]
    ds_read_b64_tr_b16 v[248:249], v1 offset:55296
    ds_read_b64_tr_b16 v[250:251], v1 offset:55808
    v_mul_f32 v164, s75, v164
    v_mul_f32 v165, s75, v165
    v_mfma_f32_32x32x16_bf16 v[208:223], v[228:231], v[96:99], v[208:223]
    ds_read_b64_tr_b16 v[252:253], v2 offset:55296
    ds_read_b64_tr_b16 v[254:255], v2 offset:55808
    v_mul_f32 v166, s75, v166
    v_mul_f32 v167, s75, v167
    v_exp_f32 v160, v160
    s_waitcnt lgkmcnt(8)
    v_mfma_f32_32x32x16_bf16 v[192:207], v[232:235], v[100:103], v[192:207]
    v_add_u32 v1, 4294868992, v1
    v_add_u32 v2, 4294868992, v2
    v_add_u32 v3, 4294868992, v3
    v_add_u32 v4, 4294868992, v4
    ds_read_b64_tr_b16 v[224:225], v1 offset:0
    ds_read_b64_tr_b16 v[226:227], v1 offset:512
    v_exp_f32 v161, v161
    v_exp_f32 v162, v162
    v_mfma_f32_32x32x16_bf16 v[208:223], v[236:239], v[100:103], v[208:223]
    ds_read_b64_tr_b16 v[228:229], v2 offset:0
    ds_read_b64_tr_b16 v[230:231], v2 offset:512
    v_exp_f32 v163, v163
    v_exp_f32 v164, v164
    v_exp_f32 v165, v165
    s_waitcnt lgkmcnt(8)
    v_mfma_f32_32x32x16_bf16 v[192:207], v[240:243], v[104:107], v[192:207]
    ds_read_b64_tr_b16 v[232:233], v1 offset:2048
    ds_read_b64_tr_b16 v[234:235], v1 offset:2560
    v_exp_f32 v166, v166
    v_exp_f32 v167, v167
    v_mfma_f32_32x32x16_bf16 v[208:223], v[244:247], v[104:107], v[208:223]
    ds_read_b64_tr_b16 v[236:237], v2 offset:2048
    ds_read_b64_tr_b16 v[238:239], v2 offset:2560
    v_add_f32 v160, 1.0, v160
    v_add_f32 v161, 1.0, v161
    v_add_f32 v162, 1.0, v162
    s_waitcnt lgkmcnt(8)
    v_mfma_f32_32x32x16_bf16 v[192:207], v[248:251], v[108:111], v[192:207]
    ds_read_b64_tr_b16 v[240:241], v1 offset:4096
    ds_read_b64_tr_b16 v[242:243], v1 offset:4608
    v_add_f32 v163, 1.0, v163
    v_add_f32 v164, 1.0, v164
    v_add_f32 v165, 1.0, v165
    v_mfma_f32_32x32x16_bf16 v[208:223], v[252:255], v[108:111], v[208:223]
    ds_read_b64_tr_b16 v[244:245], v2 offset:4096
    ds_read_b64_tr_b16 v[246:247], v2 offset:4608
    v_add_f32 v166, 1.0, v166
    v_add_f32 v167, 1.0, v167
    s_waitcnt lgkmcnt(8)
    v_mfma_f32_32x32x16_bf16 v[192:207], v[224:227], v[112:115], v[192:207]
    ds_read_b64_tr_b16 v[248:249], v1 offset:6144
    ds_read_b64_tr_b16 v[250:251], v1 offset:6656
    v_rcp_f32 v160, v160
    v_rcp_f32 v161, v161
    v_rcp_f32 v162, v162
    v_mfma_f32_32x32x16_bf16 v[208:223], v[228:231], v[112:115], v[208:223]
    ds_read_b64_tr_b16 v[252:253], v2 offset:6144
    ds_read_b64_tr_b16 v[254:255], v2 offset:6656
    v_rcp_f32 v163, v163
    v_rcp_f32 v164, v164
    s_waitcnt lgkmcnt(8)
    v_mfma_f32_32x32x16_bf16 v[192:207], v[232:235], v[116:119], v[192:207]
    v_add_u32 v1, 65536, v1
    v_add_u32 v2, 65536, v2
    v_add_u32 v3, 65536, v3
    v_add_u32 v4, 65536, v4
    ds_read_b64_tr_b16 v[224:225], v3 offset:0
    ds_read_b64_tr_b16 v[226:227], v3 offset:512
    v_rcp_f32 v165, v165
    v_rcp_f32 v166, v166
    v_rcp_f32 v167, v167
    v_mfma_f32_32x32x16_bf16 v[208:223], v[236:239], v[116:119], v[208:223]
    ds_read_b64_tr_b16 v[228:229], v4 offset:0
    ds_read_b64_tr_b16 v[230:231], v4 offset:512
    v_mul_f32 v160, v160, v168
    v_mul_f32 v161, v161, v169
    s_waitcnt lgkmcnt(8)
    v_mfma_f32_32x32x16_bf16 v[192:207], v[240:243], v[120:123], v[192:207]
    ds_read_b64_tr_b16 v[232:233], v3 offset:2048
    ds_read_b64_tr_b16 v[234:235], v3 offset:2560
    v_mul_f32 v162, v162, v170
    v_mul_f32 v163, v163, v171
    v_mul_f32 v164, v164, v172
    v_mfma_f32_32x32x16_bf16 v[208:223], v[244:247], v[120:123], v[208:223]
    ds_read_b64_tr_b16 v[236:237], v4 offset:2048
    ds_read_b64_tr_b16 v[238:239], v4 offset:2560
    v_mul_f32 v165, v165, v173
    v_mul_f32 v166, v166, v174
    s_waitcnt lgkmcnt(8)
    v_mfma_f32_32x32x16_bf16 v[192:207], v[248:251], v[124:127], v[192:207]
    ds_read_b64_tr_b16 v[240:241], v3 offset:4096
    ds_read_b64_tr_b16 v[242:243], v3 offset:4608
    v_mul_f32 v167, v167, v175
    v_cvt_pk_bf16_f32 v168, v160, v161
    v_cvt_pk_bf16_f32 v169, v162, v163
    v_mfma_f32_32x32x16_bf16 v[208:223], v[252:255], v[124:127], v[208:223]
    ds_read_b64_tr_b16 v[244:245], v4 offset:4096
    ds_read_b64_tr_b16 v[246:247], v4 offset:4608
    v_cvt_pk_bf16_f32 v170, v164, v165
    v_cvt_pk_bf16_f32 v171, v166, v167
    buffer_store_dwordx4 v[168:171], v0, s[52:55], s65 offen offset:2048 sc1
    s_waitcnt lgkmcnt(8)
    v_mfma_f32_32x32x16_bf16 v[128:143], v[224:227], v[16:19], 0
    ds_read_b64_tr_b16 v[248:249], v3 offset:6144
    ds_read_b64_tr_b16 v[250:251], v3 offset:6656
    v_mfma_f32_32x32x16_bf16 v[144:159], v[228:231], v[16:19], 0
    ds_read_b64_tr_b16 v[252:253], v4 offset:6144
    ds_read_b64_tr_b16 v[254:255], v4 offset:6656
    v_mul_f32 v176, s75, v176
    v_mul_f32 v177, s75, v177
    s_waitcnt lgkmcnt(8)
    v_mfma_f32_32x32x16_bf16 v[128:143], v[232:235], v[20:23], v[128:143]
    ds_read_b64_tr_b16 v[224:225], v3 offset:16384
    ds_read_b64_tr_b16 v[226:227], v3 offset:16896
    v_mul_f32 v178, s75, v178
    v_mul_f32 v179, s75, v179
    v_mfma_f32_32x32x16_bf16 v[144:159], v[236:239], v[20:23], v[144:159]
    ds_read_b64_tr_b16 v[228:229], v4 offset:16384
    ds_read_b64_tr_b16 v[230:231], v4 offset:16896
    v_mul_f32 v180, s75, v180
    v_mul_f32 v181, s75, v181
    v_mul_f32 v182, s75, v182
    s_waitcnt lgkmcnt(8)
    v_mfma_f32_32x32x16_bf16 v[128:143], v[240:243], v[24:27], v[128:143]
    ds_read_b64_tr_b16 v[232:233], v3 offset:18432
    ds_read_b64_tr_b16 v[234:235], v3 offset:18944
    v_mul_f32 v183, s75, v183
    v_exp_f32 v176, v176
    v_mfma_f32_32x32x16_bf16 v[144:159], v[244:247], v[24:27], v[144:159]
    ds_read_b64_tr_b16 v[236:237], v4 offset:18432
    ds_read_b64_tr_b16 v[238:239], v4 offset:18944
    v_exp_f32 v177, v177
    v_exp_f32 v178, v178
    v_exp_f32 v179, v179
    s_waitcnt lgkmcnt(8)
    v_mfma_f32_32x32x16_bf16 v[128:143], v[248:251], v[28:31], v[128:143]
    ds_read_b64_tr_b16 v[240:241], v3 offset:20480
    ds_read_b64_tr_b16 v[242:243], v3 offset:20992
    v_exp_f32 v180, v180
    v_exp_f32 v181, v181
    v_mfma_f32_32x32x16_bf16 v[144:159], v[252:255], v[28:31], v[144:159]
    ds_read_b64_tr_b16 v[244:245], v4 offset:20480
    ds_read_b64_tr_b16 v[246:247], v4 offset:20992
    v_exp_f32 v182, v182
    v_exp_f32 v183, v183
    v_add_f32 v176, 1.0, v176
    s_waitcnt lgkmcnt(8)
    v_mfma_f32_32x32x16_bf16 v[128:143], v[224:227], v[32:35], v[128:143]
    ds_read_b64_tr_b16 v[248:249], v3 offset:22528
    ds_read_b64_tr_b16 v[250:251], v3 offset:23040
    v_add_f32 v177, 1.0, v177
    v_add_f32 v178, 1.0, v178
    v_mfma_f32_32x32x16_bf16 v[144:159], v[228:231], v[32:35], v[144:159]
    ds_read_b64_tr_b16 v[252:253], v4 offset:22528
    ds_read_b64_tr_b16 v[254:255], v4 offset:23040
    v_add_f32 v179, 1.0, v179
    v_add_f32 v180, 1.0, v180
    v_add_f32 v181, 1.0, v181
    s_waitcnt lgkmcnt(8)
    v_mfma_f32_32x32x16_bf16 v[128:143], v[232:235], v[36:39], v[128:143]
    ds_read_b64_tr_b16 v[224:225], v3 offset:32768
    ds_read_b64_tr_b16 v[226:227], v3 offset:33280
    v_add_f32 v182, 1.0, v182
    v_add_f32 v183, 1.0, v183
    v_mfma_f32_32x32x16_bf16 v[144:159], v[236:239], v[36:39], v[144:159]
    ds_read_b64_tr_b16 v[228:229], v4 offset:32768
    ds_read_b64_tr_b16 v[230:231], v4 offset:33280
    v_rcp_f32 v176, v176
    v_rcp_f32 v177, v177
    v_rcp_f32 v178, v178
    s_waitcnt lgkmcnt(8)
    v_mfma_f32_32x32x16_bf16 v[128:143], v[240:243], v[40:43], v[128:143]
    ds_read_b64_tr_b16 v[232:233], v3 offset:34816
    ds_read_b64_tr_b16 v[234:235], v3 offset:35328
    v_rcp_f32 v179, v179
    v_rcp_f32 v180, v180
    v_mfma_f32_32x32x16_bf16 v[144:159], v[244:247], v[40:43], v[144:159]
    ds_read_b64_tr_b16 v[236:237], v4 offset:34816
    ds_read_b64_tr_b16 v[238:239], v4 offset:35328
    v_rcp_f32 v181, v181
    v_rcp_f32 v182, v182
    s_waitcnt lgkmcnt(8)
    v_mfma_f32_32x32x16_bf16 v[128:143], v[248:251], v[44:47], v[128:143]
    ds_read_b64_tr_b16 v[240:241], v3 offset:36864
    ds_read_b64_tr_b16 v[242:243], v3 offset:37376
    v_rcp_f32 v183, v183
    v_mul_f32 v176, v176, v184
    v_mul_f32 v177, v177, v185
    v_mfma_f32_32x32x16_bf16 v[144:159], v[252:255], v[44:47], v[144:159]
    ds_read_b64_tr_b16 v[244:245], v4 offset:36864
    ds_read_b64_tr_b16 v[246:247], v4 offset:37376
    v_mul_f32 v178, v178, v186
    v_mul_f32 v179, v179, v187
    s_waitcnt lgkmcnt(8)
    v_mfma_f32_32x32x16_bf16 v[128:143], v[224:227], v[48:51], v[128:143]
    ds_read_b64_tr_b16 v[248:249], v3 offset:38912
    ds_read_b64_tr_b16 v[250:251], v3 offset:39424
    v_mul_f32 v180, v180, v188
    v_mul_f32 v181, v181, v189
    v_mul_f32 v182, v182, v190
    v_mfma_f32_32x32x16_bf16 v[144:159], v[228:231], v[48:51], v[144:159]
    ds_read_b64_tr_b16 v[252:253], v4 offset:38912
    ds_read_b64_tr_b16 v[254:255], v4 offset:39424
    v_mul_f32 v183, v183, v191
    v_cvt_pk_bf16_f32 v184, v176, v177
    s_waitcnt lgkmcnt(8)
    v_mfma_f32_32x32x16_bf16 v[128:143], v[232:235], v[52:55], v[128:143]
    ds_read_b64_tr_b16 v[224:225], v3 offset:49152
    ds_read_b64_tr_b16 v[226:227], v3 offset:49664
    v_cvt_pk_bf16_f32 v185, v178, v179
    v_cvt_pk_bf16_f32 v186, v180, v181
    v_cvt_pk_bf16_f32 v187, v182, v183
    v_mfma_f32_32x32x16_bf16 v[144:159], v[236:239], v[52:55], v[144:159]
    ds_read_b64_tr_b16 v[228:229], v4 offset:49152
    ds_read_b64_tr_b16 v[230:231], v4 offset:49664
    buffer_store_dwordx4 v[184:187], v0, s[52:55], s65 offen offset:3072 sc1
    v_mul_f32 v192, s75, v192
    s_waitcnt lgkmcnt(8)
    v_mfma_f32_32x32x16_bf16 v[128:143], v[240:243], v[56:59], v[128:143]
    ds_read_b64_tr_b16 v[232:233], v3 offset:51200
    ds_read_b64_tr_b16 v[234:235], v3 offset:51712
    v_mul_f32 v193, s75, v193
    v_mul_f32 v194, s75, v194
    v_mul_f32 v195, s75, v195
    v_mfma_f32_32x32x16_bf16 v[144:159], v[244:247], v[56:59], v[144:159]
    ds_read_b64_tr_b16 v[236:237], v4 offset:51200
    ds_read_b64_tr_b16 v[238:239], v4 offset:51712
    v_mul_f32 v196, s75, v196
    v_mul_f32 v197, s75, v197
    s_waitcnt lgkmcnt(8)
    v_mfma_f32_32x32x16_bf16 v[128:143], v[248:251], v[60:63], v[128:143]
    ds_read_b64_tr_b16 v[240:241], v3 offset:53248
    ds_read_b64_tr_b16 v[242:243], v3 offset:53760
    v_mul_f32 v198, s75, v198
    v_mul_f32 v199, s75, v199
    v_exp_f32 v192, v192
    v_mfma_f32_32x32x16_bf16 v[144:159], v[252:255], v[60:63], v[144:159]
    ds_read_b64_tr_b16 v[244:245], v4 offset:53248
    ds_read_b64_tr_b16 v[246:247], v4 offset:53760
    v_exp_f32 v193, v193
    v_exp_f32 v194, v194
    s_waitcnt lgkmcnt(8)
    v_mfma_f32_32x32x16_bf16 v[128:143], v[224:227], v[64:67], v[128:143]
    ds_read_b64_tr_b16 v[248:249], v3 offset:55296
    ds_read_b64_tr_b16 v[250:251], v3 offset:55808
    v_exp_f32 v195, v195
    v_exp_f32 v196, v196
    v_mfma_f32_32x32x16_bf16 v[144:159], v[228:231], v[64:67], v[144:159]
    ds_read_b64_tr_b16 v[252:253], v4 offset:55296
    ds_read_b64_tr_b16 v[254:255], v4 offset:55808
    v_exp_f32 v197, v197
    v_exp_f32 v198, v198
    v_exp_f32 v199, v199
    s_waitcnt lgkmcnt(8)
    v_mfma_f32_32x32x16_bf16 v[128:143], v[232:235], v[68:71], v[128:143]
    v_add_u32 v1, 32768, v1
    v_add_u32 v2, 32768, v2
    v_add_u32 v3, 32768, v3
    v_add_u32 v4, 32768, v4
    ds_read_b64_tr_b16 v[224:225], v3 offset:32768
    ds_read_b64_tr_b16 v[226:227], v3 offset:33280
    v_add_f32 v192, 1.0, v192
    v_add_f32 v193, 1.0, v193
    v_mfma_f32_32x32x16_bf16 v[144:159], v[236:239], v[68:71], v[144:159]
    ds_read_b64_tr_b16 v[228:229], v4 offset:32768
    ds_read_b64_tr_b16 v[230:231], v4 offset:33280
    v_add_f32 v194, 1.0, v194
    v_add_f32 v195, 1.0, v195
    v_add_f32 v196, 1.0, v196
    s_waitcnt lgkmcnt(8)
    v_mfma_f32_32x32x16_bf16 v[128:143], v[240:243], v[72:75], v[128:143]
    ds_read_b64_tr_b16 v[232:233], v3 offset:34816
    ds_read_b64_tr_b16 v[234:235], v3 offset:35328
    s_barrier
    v_add_f32 v197, 1.0, v197
    v_add_f32 v198, 1.0, v198
    v_mfma_f32_32x32x16_bf16 v[144:159], v[244:247], v[72:75], v[144:159]
    ds_read_b64_tr_b16 v[236:237], v4 offset:34816
    ds_read_b64_tr_b16 v[238:239], v4 offset:35328
    v_add_f32 v199, 1.0, v199
    v_rcp_f32 v192, v192
    v_rcp_f32 v193, v193
    s_waitcnt lgkmcnt(8)
    v_mfma_f32_32x32x16_bf16 v[128:143], v[248:251], v[76:79], v[128:143]
    ds_read_b64_tr_b16 v[240:241], v3 offset:36864
    ds_read_b64_tr_b16 v[242:243], v3 offset:37376
    v_rcp_f32 v194, v194
    v_rcp_f32 v195, v195
    v_mfma_f32_32x32x16_bf16 v[144:159], v[252:255], v[76:79], v[144:159]
    ds_read_b64_tr_b16 v[244:245], v4 offset:36864
    ds_read_b64_tr_b16 v[246:247], v4 offset:37376
    v_rcp_f32 v196, v196
    v_rcp_f32 v197, v197
    v_rcp_f32 v198, v198
    s_waitcnt lgkmcnt(8)
    v_mfma_f32_32x32x16_bf16 v[128:143], v[224:227], v[80:83], v[128:143]
    ds_read_b64_tr_b16 v[248:249], v3 offset:38912
    ds_read_b64_tr_b16 v[250:251], v3 offset:39424
    v_rcp_f32 v199, v199
    v_mul_f32 v192, v192, v200
    v_mfma_f32_32x32x16_bf16 v[144:159], v[228:231], v[80:83], v[144:159]
    ds_read_b64_tr_b16 v[252:253], v4 offset:38912
    ds_read_b64_tr_b16 v[254:255], v4 offset:39424
    v_mul_f32 v193, v193, v201
    v_mul_f32 v194, v194, v202
    v_mul_f32 v195, v195, v203
    s_waitcnt lgkmcnt(8)
    v_mfma_f32_32x32x16_bf16 v[128:143], v[232:235], v[84:87], v[128:143]
    ds_read_b64_tr_b16 v[224:225], v3 offset:49152
    ds_read_b64_tr_b16 v[226:227], v3 offset:49664
    v_mul_f32 v196, v196, v204
    v_mul_f32 v197, v197, v205
    v_mfma_f32_32x32x16_bf16 v[144:159], v[236:239], v[84:87], v[144:159]
    ds_read_b64_tr_b16 v[228:229], v4 offset:49152
    ds_read_b64_tr_b16 v[230:231], v4 offset:49664
    v_mul_f32 v198, v198, v206
    v_mul_f32 v199, v199, v207
    s_waitcnt lgkmcnt(8)
    v_mfma_f32_32x32x16_bf16 v[128:143], v[240:243], v[88:91], v[128:143]
    ds_read_b64_tr_b16 v[232:233], v3 offset:51200
    ds_read_b64_tr_b16 v[234:235], v3 offset:51712
    v_cvt_pk_bf16_f32 v200, v192, v193
    v_cvt_pk_bf16_f32 v201, v194, v195
    v_cvt_pk_bf16_f32 v202, v196, v197
    v_mfma_f32_32x32x16_bf16 v[144:159], v[244:247], v[88:91], v[144:159]
    ds_read_b64_tr_b16 v[236:237], v4 offset:51200
    ds_read_b64_tr_b16 v[238:239], v4 offset:51712
    v_cvt_pk_bf16_f32 v203, v198, v199
    buffer_store_dwordx4 v[200:203], v0, s[52:55], s66 offen offset:0 sc1
    s_waitcnt lgkmcnt(8)
    v_mfma_f32_32x32x16_bf16 v[128:143], v[248:251], v[92:95], v[128:143]
    ds_read_b64_tr_b16 v[240:241], v3 offset:53248
    ds_read_b64_tr_b16 v[242:243], v3 offset:53760
    v_mul_f32 v208, s75, v208
    v_mul_f32 v209, s75, v209
    v_mul_f32 v210, s75, v210
    v_mfma_f32_32x32x16_bf16 v[144:159], v[252:255], v[92:95], v[144:159]
    ds_read_b64_tr_b16 v[244:245], v4 offset:53248
    ds_read_b64_tr_b16 v[246:247], v4 offset:53760
    v_mul_f32 v211, s75, v211
    v_mul_f32 v212, s75, v212
    s_waitcnt lgkmcnt(8)
    v_mfma_f32_32x32x16_bf16 v[128:143], v[224:227], v[96:99], v[128:143]
    ds_read_b64_tr_b16 v[248:249], v3 offset:55296
    ds_read_b64_tr_b16 v[250:251], v3 offset:55808
    v_mul_f32 v213, s75, v213
    v_mul_f32 v214, s75, v214
    v_mul_f32 v215, s75, v215
    v_mfma_f32_32x32x16_bf16 v[144:159], v[228:231], v[96:99], v[144:159]
    ds_read_b64_tr_b16 v[252:253], v4 offset:55296
    ds_read_b64_tr_b16 v[254:255], v4 offset:55808
    v_exp_f32 v208, v208
    v_exp_f32 v209, v209
    s_waitcnt lgkmcnt(8)
    v_mfma_f32_32x32x16_bf16 v[128:143], v[232:235], v[100:103], v[128:143]
    v_add_u32 v1, 4294868992, v1
    v_add_u32 v2, 4294868992, v2
    v_add_u32 v3, 4294868992, v3
    v_add_u32 v4, 4294868992, v4
    ds_read_b64_tr_b16 v[224:225], v3 offset:0
    ds_read_b64_tr_b16 v[226:227], v3 offset:512
    v_exp_f32 v210, v210
    v_exp_f32 v211, v211
    v_exp_f32 v212, v212
    v_mfma_f32_32x32x16_bf16 v[144:159], v[236:239], v[100:103], v[144:159]
    ds_read_b64_tr_b16 v[228:229], v4 offset:0
    ds_read_b64_tr_b16 v[230:231], v4 offset:512
    v_exp_f32 v213, v213
    v_exp_f32 v214, v214
    s_waitcnt lgkmcnt(8)
    v_mfma_f32_32x32x16_bf16 v[128:143], v[240:243], v[104:107], v[128:143]
    ds_read_b64_tr_b16 v[232:233], v3 offset:2048
    ds_read_b64_tr_b16 v[234:235], v3 offset:2560
    v_exp_f32 v215, v215
    v_add_f32 v208, 1.0, v208
    v_add_f32 v209, 1.0, v209
    v_mfma_f32_32x32x16_bf16 v[144:159], v[244:247], v[104:107], v[144:159]
    ds_read_b64_tr_b16 v[236:237], v4 offset:2048
    ds_read_b64_tr_b16 v[238:239], v4 offset:2560
    v_add_f32 v210, 1.0, v210
    v_add_f32 v211, 1.0, v211
    s_waitcnt lgkmcnt(8)
    v_mfma_f32_32x32x16_bf16 v[128:143], v[248:251], v[108:111], v[128:143]
    ds_read_b64_tr_b16 v[240:241], v3 offset:4096
    ds_read_b64_tr_b16 v[242:243], v3 offset:4608
    v_add_f32 v212, 1.0, v212
    v_add_f32 v213, 1.0, v213
    v_mfma_f32_32x32x16_bf16 v[144:159], v[252:255], v[108:111], v[144:159]
    ds_read_b64_tr_b16 v[244:245], v4 offset:4096
    ds_read_b64_tr_b16 v[246:247], v4 offset:4608
    v_add_f32 v214, 1.0, v214
    v_add_f32 v215, 1.0, v215
    v_rcp_f32 v208, v208
    s_waitcnt lgkmcnt(8)
    v_mfma_f32_32x32x16_bf16 v[128:143], v[224:227], v[112:115], v[128:143]
    ds_read_b64_tr_b16 v[248:249], v3 offset:6144
    ds_read_b64_tr_b16 v[250:251], v3 offset:6656
    v_rcp_f32 v209, v209
    v_rcp_f32 v210, v210
    v_mfma_f32_32x32x16_bf16 v[144:159], v[228:231], v[112:115], v[144:159]
    ds_read_b64_tr_b16 v[252:253], v4 offset:6144
    ds_read_b64_tr_b16 v[254:255], v4 offset:6656
    v_rcp_f32 v211, v211
    v_rcp_f32 v212, v212
    v_rcp_f32 v213, v213
    s_waitcnt lgkmcnt(8)
    v_mfma_f32_32x32x16_bf16 v[128:143], v[232:235], v[116:119], v[128:143]
    v_rcp_f32 v214, v214
    v_rcp_f32 v215, v215
    v_mfma_f32_32x32x16_bf16 v[144:159], v[236:239], v[116:119], v[144:159]
    v_mul_f32 v208, v208, v216
    v_mul_f32 v209, v209, v217
    v_mul_f32 v210, v210, v218
    s_waitcnt lgkmcnt(4)
    v_mfma_f32_32x32x16_bf16 v[128:143], v[240:243], v[120:123], v[128:143]
    v_mul_f32 v211, v211, v219
    v_mul_f32 v212, v212, v220
    v_mfma_f32_32x32x16_bf16 v[144:159], v[244:247], v[120:123], v[144:159]
    v_mul_f32 v213, v213, v221
    v_mul_f32 v214, v214, v222
    v_mul_f32 v215, v215, v223
    s_waitcnt lgkmcnt(0)
    v_mfma_f32_32x32x16_bf16 v[128:143], v[248:251], v[124:127], v[128:143]
    v_cvt_pk_bf16_f32 v216, v208, v209
    v_cvt_pk_bf16_f32 v217, v210, v211
    v_mfma_f32_32x32x16_bf16 v[144:159], v[252:255], v[124:127], v[144:159]
    v_cvt_pk_bf16_f32 v218, v212, v213
    v_cvt_pk_bf16_f32 v219, v214, v215
    buffer_store_dwordx4 v[216:219], v0, s[52:55], s66 offen offset:1024 sc1
    s_nop 5
    v_mul_f32 v128, s75, v128
    v_mul_f32 v129, s75, v129
    v_mul_f32 v130, s75, v130
    v_mul_f32 v131, s75, v131
    v_mul_f32 v132, s75, v132
    v_mul_f32 v133, s75, v133
    v_mul_f32 v134, s75, v134
    v_mul_f32 v135, s75, v135
    v_exp_f32 v128, v128
    v_exp_f32 v129, v129
    v_exp_f32 v130, v130
    v_exp_f32 v131, v131
    v_exp_f32 v132, v132
    v_exp_f32 v133, v133
    v_exp_f32 v134, v134
    v_exp_f32 v135, v135
    v_add_f32 v128, 1.0, v128
    v_add_f32 v129, 1.0, v129
    v_add_f32 v130, 1.0, v130
    v_add_f32 v131, 1.0, v131
    v_add_f32 v132, 1.0, v132
    v_add_f32 v133, 1.0, v133
    v_add_f32 v134, 1.0, v134
    v_add_f32 v135, 1.0, v135
    v_rcp_f32 v128, v128
    v_rcp_f32 v129, v129
    v_rcp_f32 v130, v130
    v_rcp_f32 v131, v131
    v_rcp_f32 v132, v132
    v_rcp_f32 v133, v133
    v_rcp_f32 v134, v134
    v_rcp_f32 v135, v135
    v_mul_f32 v128, v128, v136
    v_mul_f32 v129, v129, v137
    v_mul_f32 v130, v130, v138
    v_mul_f32 v131, v131, v139
    v_mul_f32 v132, v132, v140
    v_mul_f32 v133, v133, v141
    v_mul_f32 v134, v134, v142
    v_mul_f32 v135, v135, v143
    v_cvt_pk_bf16_f32 v136, v128, v129
    v_cvt_pk_bf16_f32 v137, v130, v131
    v_cvt_pk_bf16_f32 v138, v132, v133
    v_cvt_pk_bf16_f32 v139, v134, v135
    buffer_store_dwordx4 v[136:139], v0, s[52:55], s66 offen offset:2048 sc1
    v_mul_f32 v144, s75, v144
    v_mul_f32 v145, s75, v145
    v_mul_f32 v146, s75, v146
    v_mul_f32 v147, s75, v147
    v_mul_f32 v148, s75, v148
    v_mul_f32 v149, s75, v149
    v_mul_f32 v150, s75, v150
    v_mul_f32 v151, s75, v151
    v_exp_f32 v144, v144
    v_exp_f32 v145, v145
    v_exp_f32 v146, v146
    v_exp_f32 v147, v147
    v_exp_f32 v148, v148
    v_exp_f32 v149, v149
    v_exp_f32 v150, v150
    v_exp_f32 v151, v151
    v_add_f32 v144, 1.0, v144
    v_add_f32 v145, 1.0, v145
    v_add_f32 v146, 1.0, v146
    v_add_f32 v147, 1.0, v147
    v_add_f32 v148, 1.0, v148
    v_add_f32 v149, 1.0, v149
    v_add_f32 v150, 1.0, v150
    v_add_f32 v151, 1.0, v151
    v_rcp_f32 v144, v144
    v_rcp_f32 v145, v145
    v_rcp_f32 v146, v146
    v_rcp_f32 v147, v147
    v_rcp_f32 v148, v148
    v_rcp_f32 v149, v149
    v_rcp_f32 v150, v150
    v_rcp_f32 v151, v151
    v_mul_f32 v144, v144, v152
    v_mul_f32 v145, v145, v153
    v_mul_f32 v146, v146, v154
    v_mul_f32 v147, v147, v155
    v_mul_f32 v148, v148, v156
    v_mul_f32 v149, v149, v157
    v_mul_f32 v150, v150, v158
    v_mul_f32 v151, v151, v159
    v_cvt_pk_bf16_f32 v152, v144, v145
    v_cvt_pk_bf16_f32 v153, v146, v147
    v_cvt_pk_bf16_f32 v154, v148, v149
    v_cvt_pk_bf16_f32 v155, v150, v151
    buffer_store_dwordx4 v[152:155], v0, s[52:55], s66 offen offset:3072 sc1
    s_branch K1_CDONE
K1_QKV:
    s_cmp_eq_u32 s61, 3
    s_cbranch_scc1 K1_KV
    buffer_load_dword v14, off, s[80:83], 0 sc1
    s_waitcnt lgkmcnt(4)
    v_mfma_f32_32x32x16_bf16 v[192:207], v[224:227], v[16:19], 0
    ds_read_b64_tr_b16 v[240:241], v1 offset:4096
    ds_read_b64_tr_b16 v[242:243], v1 offset:4608
    ds_read_b64_tr_b16 v[248:249], v1 offset:6144
    ds_read_b64_tr_b16 v[250:251], v1 offset:6656
    v_cvt_pk_bf16_f32 v128, v128, v129
    v_cvt_pk_bf16_f32 v129, v130, v131
    v_cvt_pk_bf16_f32 v130, v132, v133
    v_cvt_pk_bf16_f32 v131, v134, v135
    v_cvt_pk_bf16_f32 v132, v136, v137
    v_cvt_pk_bf16_f32 v133, v138, v139
    v_cvt_pk_bf16_f32 v134, v140, v141
    v_cvt_pk_bf16_f32 v135, v142, v143
    buffer_store_dwordx4 v[128:131], v0, s[52:55], s67 offen offset:0 sc1
    buffer_store_dwordx4 v[132:135], v0, s[52:55], s68 offen offset:0 sc1
    v_mfma_f32_32x32x16_bf16 v[208:223], v[228:231], v[16:19], 0
    ds_read_b64_tr_b16 v[244:245], v2 offset:4096
    ds_read_b64_tr_b16 v[246:247], v2 offset:4608
    ds_read_b64_tr_b16 v[252:253], v2 offset:6144
    ds_read_b64_tr_b16 v[254:255], v2 offset:6656
    v_cvt_pk_bf16_f32 v144, v144, v145
    v_cvt_pk_bf16_f32 v145, v146, v147
    v_cvt_pk_bf16_f32 v146, v148, v149
    v_cvt_pk_bf16_f32 v147, v150, v151
    v_cvt_pk_bf16_f32 v148, v152, v153
    v_cvt_pk_bf16_f32 v149, v154, v155
    v_cvt_pk_bf16_f32 v150, v156, v157
    v_cvt_pk_bf16_f32 v151, v158, v159
    buffer_store_dwordx4 v[144:147], v0, s[52:55], s67 offen offset:1024 sc1
    buffer_store_dwordx4 v[148:151], v0, s[52:55], s68 offen offset:1024 sc1
    s_waitcnt lgkmcnt(8)
    v_mfma_f32_32x32x16_bf16 v[192:207], v[232:235], v[20:23], v[192:207]
    ds_read_b64_tr_b16 v[224:225], v1 offset:16384
    ds_read_b64_tr_b16 v[226:227], v1 offset:16896
    v_cvt_pk_bf16_f32 v160, v160, v161
    v_cvt_pk_bf16_f32 v161, v162, v163
    v_cvt_pk_bf16_f32 v162, v164, v165
    v_cvt_pk_bf16_f32 v163, v166, v167
    v_cvt_pk_bf16_f32 v164, v168, v169
    v_cvt_pk_bf16_f32 v165, v170, v171
    v_cvt_pk_bf16_f32 v166, v172, v173
    v_cvt_pk_bf16_f32 v167, v174, v175
    buffer_store_dwordx4 v[160:163], v0, s[52:55], s67 offen offset:2048 sc1
    buffer_store_dwordx4 v[164:167], v0, s[52:55], s68 offen offset:2048 sc1
    v_mfma_f32_32x32x16_bf16 v[208:223], v[236:239], v[20:23], v[208:223]
    ds_read_b64_tr_b16 v[228:229], v2 offset:16384
    ds_read_b64_tr_b16 v[230:231], v2 offset:16896
    v_cvt_pk_bf16_f32 v176, v176, v177
    v_cvt_pk_bf16_f32 v177, v178, v179
    v_cvt_pk_bf16_f32 v178, v180, v181
    v_cvt_pk_bf16_f32 v179, v182, v183
    v_cvt_pk_bf16_f32 v180, v184, v185
    v_cvt_pk_bf16_f32 v181, v186, v187
    v_cvt_pk_bf16_f32 v182, v188, v189
    v_cvt_pk_bf16_f32 v183, v190, v191
    buffer_store_dwordx4 v[176:179], v0, s[52:55], s67 offen offset:3072 sc1
    buffer_store_dwordx4 v[180:183], v0, s[52:55], s68 offen offset:3072 sc1
    s_waitcnt lgkmcnt(6)
    v_mfma_f32_32x32x16_bf16 v[192:207], v[240:243], v[24:27], v[192:207]
    ds_read_b64_tr_b16 v[232:233], v1 offset:18432
    ds_read_b64_tr_b16 v[234:235], v1 offset:18944
    s_lshl_b32 s5, s60, 11
    v_mfma_f32_32x32x16_bf16 v[208:223], v[244:247], v[24:27], v[208:223]
    ds_read_b64_tr_b16 v[236:237], v2 offset:18432
    ds_read_b64_tr_b16 v[238:239], v2 offset:18944
    s_lshl_b32 s6, s61, 9
    s_waitcnt lgkmcnt(8)
    v_mfma_f32_32x32x16_bf16 v[192:207], v[248:251], v[28:31], v[192:207]
    ds_read_b64_tr_b16 v[240:241], v1 offset:20480
    ds_read_b64_tr_b16 v[242:243], v1 offset:20992
    s_add_u32 s5, s5, s6
    v_mfma_f32_32x32x16_bf16 v[208:223], v[252:255], v[28:31], v[208:223]
    ds_read_b64_tr_b16 v[244:245], v2 offset:20480
    ds_read_b64_tr_b16 v[246:247], v2 offset:20992
    s_lshl_b32 s6, s62, 7
    s_waitcnt lgkmcnt(8)
    v_mfma_f32_32x32x16_bf16 v[192:207], v[224:227], v[32:35], v[192:207]
    ds_read_b64_tr_b16 v[248:249], v1 offset:22528
    ds_read_b64_tr_b16 v[250:251], v1 offset:23040
    s_add_u32 s5, s5, s6
    v_mfma_f32_32x32x16_bf16 v[208:223], v[228:231], v[32:35], v[208:223]
    ds_read_b64_tr_b16 v[252:253], v2 offset:22528
    ds_read_b64_tr_b16 v[254:255], v2 offset:23040
    s_add_u32 s79, s5, 20971520
    s_waitcnt lgkmcnt(8)
    v_mfma_f32_32x32x16_bf16 v[192:207], v[232:235], v[36:39], v[192:207]
    ds_read_b64_tr_b16 v[224:225], v1 offset:32768
    ds_read_b64_tr_b16 v[226:227], v1 offset:33280
    v_mfma_f32_32x32x16_bf16 v[208:223], v[236:239], v[36:39], v[208:223]
    ds_read_b64_tr_b16 v[228:229], v2 offset:32768
    ds_read_b64_tr_b16 v[230:231], v2 offset:33280
    s_waitcnt lgkmcnt(8)
    v_mfma_f32_32x32x16_bf16 v[192:207], v[240:243], v[40:43], v[192:207]
    ds_read_b64_tr_b16 v[232:233], v1 offset:34816
    ds_read_b64_tr_b16 v[234:235], v1 offset:35328
    v_mfma_f32_32x32x16_bf16 v[208:223], v[244:247], v[40:43], v[208:223]
    ds_read_b64_tr_b16 v[236:237], v2 offset:34816
    ds_read_b64_tr_b16 v[238:239], v2 offset:35328
    s_waitcnt lgkmcnt(8)
    v_mfma_f32_32x32x16_bf16 v[192:207], v[248:251], v[44:47], v[192:207]
    ds_read_b64_tr_b16 v[240:241], v1 offset:36864
    ds_read_b64_tr_b16 v[242:243], v1 offset:37376
    v_mfma_f32_32x32x16_bf16 v[208:223], v[252:255], v[44:47], v[208:223]
    ds_read_b64_tr_b16 v[244:245], v2 offset:36864
    ds_read_b64_tr_b16 v[246:247], v2 offset:37376
    s_waitcnt lgkmcnt(8)
    v_mfma_f32_32x32x16_bf16 v[192:207], v[224:227], v[48:51], v[192:207]
    ds_read_b64_tr_b16 v[248:249], v1 offset:38912
    ds_read_b64_tr_b16 v[250:251], v1 offset:39424
    v_mfma_f32_32x32x16_bf16 v[208:223], v[228:231], v[48:51], v[208:223]
    ds_read_b64_tr_b16 v[252:253], v2 offset:38912
    ds_read_b64_tr_b16 v[254:255], v2 offset:39424
    s_waitcnt lgkmcnt(8)
    v_mfma_f32_32x32x16_bf16 v[192:207], v[232:235], v[52:55], v[192:207]
    ds_read_b64_tr_b16 v[224:225], v1 offset:49152
    ds_read_b64_tr_b16 v[226:227], v1 offset:49664
    v_mfma_f32_32x32x16_bf16 v[208:223], v[236:239], v[52:55], v[208:223]
    ds_read_b64_tr_b16 v[228:229], v2 offset:49152
    ds_read_b64_tr_b16 v[230:231], v2 offset:49664
    s_waitcnt lgkmcnt(8)
    v_mfma_f32_32x32x16_bf16 v[192:207], v[240:243], v[56:59], v[192:207]
    ds_read_b64_tr_b16 v[232:233], v1 offset:51200
    ds_read_b64_tr_b16 v[234:235], v1 offset:51712
    v_mfma_f32_32x32x16_bf16 v[208:223], v[244:247], v[56:59], v[208:223]
    ds_read_b64_tr_b16 v[236:237], v2 offset:51200
    ds_read_b64_tr_b16 v[238:239], v2 offset:51712
    s_waitcnt lgkmcnt(8)
    v_mfma_f32_32x32x16_bf16 v[192:207], v[248:251], v[60:63], v[192:207]
    ds_read_b64_tr_b16 v[240:241], v1 offset:53248
    ds_read_b64_tr_b16 v[242:243], v1 offset:53760
    v_mfma_f32_32x32x16_bf16 v[208:223], v[252:255], v[60:63], v[208:223]
    ds_read_b64_tr_b16 v[244:245], v2 offset:53248
    ds_read_b64_tr_b16 v[246:247], v2 offset:53760
    s_waitcnt lgkmcnt(8)
    v_mfma_f32_32x32x16_bf16 v[192:207], v[224:227], v[64:67], v[192:207]
    ds_read_b64_tr_b16 v[248:249], v1 offset:55296
    ds_read_b64_tr_b16 v[250:251], v1 offset:55808
    v_mfma_f32_32x32x16_bf16 v[208:223], v[228:231], v[64:67], v[208:223]
    ds_read_b64_tr_b16 v[252:253], v2 offset:55296
    ds_read_b64_tr_b16 v[254:255], v2 offset:55808
    s_waitcnt vmcnt(0)
    v_readfirstlane_b32 s4, v14
    s_nop 0
    s_cmp_lg_u32 s4, 0
    s_cbranch_scc1 NC5E
    s_mov_b32 s5, 400000
NC5:
    buffer_load_dword v14, off, s[80:83], 0 sc1
    s_waitcnt vmcnt(0)
    v_readfirstlane_b32 s4, v14
    s_nop 0
    s_cmp_lg_u32 s4, 0
    s_cbranch_scc1 NC5E
    s_sub_u32 s5, s5, 1
    s_cmp_lg_u32 s5, 0
    s_cbranch_scc1 NC5
NC5E:
    s_mov_b64 exec, 1
    buffer_store_dword v14, off, s[52:55], s79 sc1
    s_mov_b64 exec, -1
    s_barrier
    s_waitcnt lgkmcnt(8)
    v_mfma_f32_32x32x16_bf16 v[192:207], v[232:235], v[68:71], v[192:207]
    v_add_u32 v1, 32768, v1
    v_add_u32 v2, 32768, v2
    v_add_u32 v3, 32768, v3
    v_add_u32 v4, 32768, v4
    ds_read_b64_tr_b16 v[224:225], v1 offset:32768
    ds_read_b64_tr_b16 v[226:227], v1 offset:33280
    v_mfma_f32_32x32x16_bf16 v[208:223], v[236:239], v[68:71], v[208:223]
    ds_read_b64_tr_b16 v[228:229], v2 offset:32768
    ds_read_b64_tr_b16 v[230:231], v2 offset:33280
    s_waitcnt lgkmcnt(8)
    v_mfma_f32_32x32x16_bf16 v[192:207], v[240:243], v[72:75], v[192:207]
    ds_read_b64_tr_b16 v[232:233], v1 offset:34816
    ds_read_b64_tr_b16 v[234:235], v1 offset:35328
    v_mfma_f32_32x32x16_bf16 v[208:223], v[244:247], v[72:75], v[208:223]
    ds_read_b64_tr_b16 v[236:237], v2 offset:34816
    ds_read_b64_tr_b16 v[238:239], v2 offset:35328
    s_waitcnt lgkmcnt(8)
    v_mfma_f32_32x32x16_bf16 v[192:207], v[248:251], v[76:79], v[192:207]
    ds_read_b64_tr_b16 v[240:241], v1 offset:36864
    ds_read_b64_tr_b16 v[242:243], v1 offset:37376
    s_mov_b32 s40, s24
    s_mov_b32 s41, s25
    s_mov_b32 s42, 1605632
    v_mfma_f32_32x32x16_bf16 v[208:223], v[252:255], v[76:79], v[208:223]
    ds_read_b64_tr_b16 v[244:245], v2 offset:36864
    ds_read_b64_tr_b16 v[246:247], v2 offset:37376
    s_mov_b32 s43, 0x20000
    s_and_b32 s4, s61, 7
    s_cmp_lt_u32 s61, 8
    s_waitcnt lgkmcnt(8)
    v_mfma_f32_32x32x16_bf16 v[192:207], v[224:227], v[80:83], v[192:207]
    ds_read_b64_tr_b16 v[248:249], v1 offset:38912
    ds_read_b64_tr_b16 v[250:251], v1 offset:39424
    s_cselect_b32 s5, 3, 7
    s_cmp_gt_u32 s4, s5
    s_subb_u32 s70, s4, 0
    v_mfma_f32_32x32x16_bf16 v[208:223], v[228:231], v[80:83], v[208:223]
    ds_read_b64_tr_b16 v[252:253], v2 offset:38912
    ds_read_b64_tr_b16 v[254:255], v2 offset:39424
    s_cmp_eq_u32 s4, s5
    s_and_b32 s5, s60, 3
    s_mul_i32 s5, s5, 7
    s_lshl_b32 s6, s70, 2
    s_waitcnt lgkmcnt(8)
    v_mfma_f32_32x32x16_bf16 v[192:207], v[232:235], v[84:87], v[192:207]
    ds_read_b64_tr_b16 v[224:225], v1 offset:49152
    ds_read_b64_tr_b16 v[226:227], v1 offset:49664
    s_add_u32 s5, s5, s6
    s_cmp_ge_u32 s5, 28
    s_cselect_b32 s6, 28, 0
    v_mfma_f32_32x32x16_bf16 v[208:223], v[236:239], v[84:87], v[208:223]
    ds_read_b64_tr_b16 v[228:229], v2 offset:49152
    ds_read_b64_tr_b16 v[230:231], v2 offset:49664
    s_sub_u32 s63, s5, s6
    s_add_u32 s5, s63, 6
    s_cmp_ge_u32 s5, 28
    s_waitcnt lgkmcnt(8)
    v_mfma_f32_32x32x16_bf16 v[192:207], v[240:243], v[88:91], v[192:207]
    ds_read_b64_tr_b16 v[232:233], v1 offset:51200
    ds_read_b64_tr_b16 v[234:235], v1 offset:51712
    s_cselect_b32 s6, 28, 0
    s_sub_u32 s5, s5, s6
    s_mul_i32 s73, s5, 14336
    s_mul_i32 s74, s62, 12288
    v_mfma_f32_32x32x16_bf16 v[208:223], v[244:247], v[88:91], v[208:223]
    ds_read_b64_tr_b16 v[236:237], v2 offset:51200
    ds_read_b64_tr_b16 v[238:239], v2 offset:51712
    s_add_u32 s74, s74, 16384
    s_lshl_b32 s5, s70, 7
    s_mul_i32 s6, s62, 401408
    s_waitcnt lgkmcnt(8)
    v_mfma_f32_32x32x16_bf16 v[192:207], v[248:251], v[92:95], v[192:207]
    ds_read_b64_tr_b16 v[240:241], v1 offset:53248
    ds_read_b64_tr_b16 v[242:243], v1 offset:53760
    s_add_u32 s5, s5, s6
    v_lshrrev_b32 v7, 7, v0
    v_mul_u32_u24 v7, 896, v7
    v_mfma_f32_32x32x16_bf16 v[208:223], v[252:255], v[92:95], v[208:223]
    ds_read_b64_tr_b16 v[244:245], v2 offset:53248
    ds_read_b64_tr_b16 v[246:247], v2 offset:53760
    v_and_b32 v13, 0x70, v0
    v_add_u32 v7, v7, v13
    v_add_u32 v12, s5, v7
    v_add_u32 v13, 7168, v12
    s_waitcnt lgkmcnt(8)
    v_mfma_f32_32x32x16_bf16 v[192:207], v[224:227], v[96:99], v[192:207]
    ds_read_b64_tr_b16 v[248:249], v1 offset:55296
    ds_read_b64_tr_b16 v[250:251], v1 offset:55808
    v_mfma_f32_32x32x16_bf16 v[208:223], v[228:231], v[96:99], v[208:223]
    ds_read_b64_tr_b16 v[252:253], v2 offset:55296
    ds_read_b64_tr_b16 v[254:255], v2 offset:55808
    s_waitcnt lgkmcnt(8)
    v_mfma_f32_32x32x16_bf16 v[192:207], v[232:235], v[100:103], v[192:207]
    v_add_u32 v1, 4294868992, v1
    v_add_u32 v2, 4294868992, v2
    v_add_u32 v3, 4294868992, v3
    v_add_u32 v4, 4294868992, v4
    ds_read_b64_tr_b16 v[224:225], v1 offset:0
    ds_read_b64_tr_b16 v[226:227], v1 offset:512
    v_mfma_f32_32x32x16_bf16 v[208:223], v[236:239], v[100:103], v[208:223]
    ds_read_b64_tr_b16 v[228:229], v2 offset:0
    ds_read_b64_tr_b16 v[230:231], v2 offset:512
    s_waitcnt lgkmcnt(8)
    v_mfma_f32_32x32x16_bf16 v[192:207], v[240:243], v[104:107], v[192:207]
    ds_read_b64_tr_b16 v[232:233], v1 offset:2048
    ds_read_b64_tr_b16 v[234:235], v1 offset:2560
    v_mfma_f32_32x32x16_bf16 v[208:223], v[244:247], v[104:107], v[208:223]
    ds_read_b64_tr_b16 v[236:237], v2 offset:2048
    ds_read_b64_tr_b16 v[238:239], v2 offset:2560
    s_waitcnt lgkmcnt(8)
    v_mfma_f32_32x32x16_bf16 v[192:207], v[248:251], v[108:111], v[192:207]
    ds_read_b64_tr_b16 v[240:241], v1 offset:4096
    ds_read_b64_tr_b16 v[242:243], v1 offset:4608
    v_mfma_f32_32x32x16_bf16 v[208:223], v[252:255], v[108:111], v[208:223]
    ds_read_b64_tr_b16 v[244:245], v2 offset:4096
    ds_read_b64_tr_b16 v[246:247], v2 offset:4608
    s_waitcnt lgkmcnt(8)
    v_mfma_f32_32x32x16_bf16 v[192:207], v[224:227], v[112:115], v[192:207]
    ds_read_b64_tr_b16 v[248:249], v1 offset:6144
    ds_read_b64_tr_b16 v[250:251], v1 offset:6656
    v_mfma_f32_32x32x16_bf16 v[208:223], v[228:231], v[112:115], v[208:223]
    ds_read_b64_tr_b16 v[252:253], v2 offset:6144
    ds_read_b64_tr_b16 v[254:255], v2 offset:6656
    s_waitcnt lgkmcnt(8)
    v_mfma_f32_32x32x16_bf16 v[192:207], v[232:235], v[116:119], v[192:207]
    v_add_u32 v1, 65536, v1
    v_add_u32 v2, 65536, v2
    v_add_u32 v3, 65536, v3
    v_add_u32 v4, 65536, v4
    ds_read_b64_tr_b16 v[224:225], v3 offset:0
    ds_read_b64_tr_b16 v[226:227], v3 offset:512
    v_mfma_f32_32x32x16_bf16 v[208:223], v[236:239], v[116:119], v[208:223]
    ds_read_b64_tr_b16 v[228:229], v4 offset:0
    ds_read_b64_tr_b16 v[230:231], v4 offset:512
    s_waitcnt lgkmcnt(8)
    v_mfma_f32_32x32x16_bf16 v[192:207], v[240:243], v[120:123], v[192:207]
    ds_read_b64_tr_b16 v[232:233], v3 offset:2048
    ds_read_b64_tr_b16 v[234:235], v3 offset:2560
    v_mfma_f32_32x32x16_bf16 v[208:223], v[244:247], v[120:123], v[208:223]
    ds_read_b64_tr_b16 v[236:237], v4 offset:2048
    ds_read_b64_tr_b16 v[238:239], v4 offset:2560
    s_waitcnt lgkmcnt(8)
    v_mfma_f32_32x32x16_bf16 v[192:207], v[248:251], v[124:127], v[192:207]
    ds_read_b64_tr_b16 v[240:241], v3 offset:4096
    ds_read_b64_tr_b16 v[242:243], v3 offset:4608
    v_mfma_f32_32x32x16_bf16 v[208:223], v[252:255], v[124:127], v[208:223]
    ds_read_b64_tr_b16 v[244:245], v4 offset:4096
    ds_read_b64_tr_b16 v[246:247], v4 offset:4608
    s_waitcnt lgkmcnt(8)
    v_mfma_f32_32x32x16_bf16 v[128:143], v[224:227], v[16:19], 0
    ds_read_b64_tr_b16 v[248:249], v3 offset:6144
    ds_read_b64_tr_b16 v[250:251], v3 offset:6656
    v_mfma_f32_32x32x16_bf16 v[144:159], v[228:231], v[16:19], 0
    ds_read_b64_tr_b16 v[252:253], v4 offset:6144
    ds_read_b64_tr_b16 v[254:255], v4 offset:6656
    s_waitcnt lgkmcnt(8)
    v_mfma_f32_32x32x16_bf16 v[128:143], v[232:235], v[20:23], v[128:143]
    ds_read_b64_tr_b16 v[224:225], v3 offset:16384
    ds_read_b64_tr_b16 v[226:227], v3 offset:16896
    v_mfma_f32_32x32x16_bf16 v[144:159], v[236:239], v[20:23], v[144:159]
    ds_read_b64_tr_b16 v[228:229], v4 offset:16384
    ds_read_b64_tr_b16 v[230:231], v4 offset:16896
    s_waitcnt lgkmcnt(8)
    v_mfma_f32_32x32x16_bf16 v[128:143], v[240:243], v[24:27], v[128:143]
    ds_read_b64_tr_b16 v[232:233], v3 offset:18432
    ds_read_b64_tr_b16 v[234:235], v3 offset:18944
    v_mul_f32 v192, s75, v192
    v_mfma_f32_32x32x16_bf16 v[144:159], v[244:247], v[24:27], v[144:159]
    ds_read_b64_tr_b16 v[236:237], v4 offset:18432
    ds_read_b64_tr_b16 v[238:239], v4 offset:18944
    v_mul_f32 v193, s75, v193
    v_mul_f32 v194, s75, v194
    s_waitcnt lgkmcnt(8)
    v_mfma_f32_32x32x16_bf16 v[128:143], v[248:251], v[28:31], v[128:143]
    ds_read_b64_tr_b16 v[240:241], v3 offset:20480
    ds_read_b64_tr_b16 v[242:243], v3 offset:20992
    v_mul_f32 v195, s75, v195
    v_mul_f32 v196, s75, v196
    v_mfma_f32_32x32x16_bf16 v[144:159], v[252:255], v[28:31], v[144:159]
    ds_read_b64_tr_b16 v[244:245], v4 offset:20480
    ds_read_b64_tr_b16 v[246:247], v4 offset:20992
    v_mul_f32 v197, s75, v197
    s_waitcnt lgkmcnt(8)
    v_mfma_f32_32x32x16_bf16 v[128:143], v[224:227], v[32:35], v[128:143]
    ds_read_b64_tr_b16 v[248:249], v3 offset:22528
    ds_read_b64_tr_b16 v[250:251], v3 offset:23040
    v_mul_f32 v198, s75, v198
    v_mul_f32 v199, s75, v199
    v_mfma_f32_32x32x16_bf16 v[144:159], v[228:231], v[32:35], v[144:159]
    ds_read_b64_tr_b16 v[252:253], v4 offset:22528
    ds_read_b64_tr_b16 v[254:255], v4 offset:23040
    v_exp_f32 v192, v192
    v_exp_f32 v193, v193
    s_waitcnt lgkmcnt(8)
    v_mfma_f32_32x32x16_bf16 v[128:143], v[232:235], v[36:39], v[128:143]
    ds_read_b64_tr_b16 v[224:225], v3 offset:32768
    ds_read_b64_tr_b16 v[226:227], v3 offset:33280
    v_exp_f32 v194, v194
    v_exp_f32 v195, v195
    v_mfma_f32_32x32x16_bf16 v[144:159], v[236:239], v[36:39], v[144:159]
    ds_read_b64_tr_b16 v[228:229], v4 offset:32768
    ds_read_b64_tr_b16 v[230:231], v4 offset:33280
    v_exp_f32 v196, v196
    s_waitcnt lgkmcnt(8)
    v_mfma_f32_32x32x16_bf16 v[128:143], v[240:243], v[40:43], v[128:143]
    ds_read_b64_tr_b16 v[232:233], v3 offset:34816
    ds_read_b64_tr_b16 v[234:235], v3 offset:35328
    v_exp_f32 v197, v197
    v_exp_f32 v198, v198
    v_mfma_f32_32x32x16_bf16 v[144:159], v[244:247], v[40:43], v[144:159]
    ds_read_b64_tr_b16 v[236:237], v4 offset:34816
    ds_read_b64_tr_b16 v[238:239], v4 offset:35328
    v_exp_f32 v199, v199
    v_add_f32 v192, 1.0, v192
    s_waitcnt lgkmcnt(8)
    v_mfma_f32_32x32x16_bf16 v[128:143], v[248:251], v[44:47], v[128:143]
    ds_read_b64_tr_b16 v[240:241], v3 offset:36864
    ds_read_b64_tr_b16 v[242:243], v3 offset:37376
    v_add_f32 v193, 1.0, v193
    v_add_f32 v194, 1.0, v194
    v_mfma_f32_32x32x16_bf16 v[144:159], v[252:255], v[44:47], v[144:159]
    ds_read_b64_tr_b16 v[244:245], v4 offset:36864
    ds_read_b64_tr_b16 v[246:247], v4 offset:37376
    v_add_f32 v195, 1.0, v195
    s_waitcnt lgkmcnt(8)
    v_mfma_f32_32x32x16_bf16 v[128:143], v[224:227], v[48:51], v[128:143]
    ds_read_b64_tr_b16 v[248:249], v3 offset:38912
    ds_read_b64_tr_b16 v[250:251], v3 offset:39424
    v_add_f32 v196, 1.0, v196
    v_add_f32 v197, 1.0, v197
    v_mfma_f32_32x32x16_bf16 v[144:159], v[228:231], v[48:51], v[144:159]
    ds_read_b64_tr_b16 v[252:253], v4 offset:38912
    ds_read_b64_tr_b16 v[254:255], v4 offset:39424
    v_add_f32 v198, 1.0, v198
    v_add_f32 v199, 1.0, v199
    s_waitcnt lgkmcnt(8)
    v_mfma_f32_32x32x16_bf16 v[128:143], v[232:235], v[52:55], v[128:143]
    ds_read_b64_tr_b16 v[224:225], v3 offset:49152
    ds_read_b64_tr_b16 v[226:227], v3 offset:49664
    v_rcp_f32 v192, v192
    v_mfma_f32_32x32x16_bf16 v[144:159], v[236:239], v[52:55], v[144:159]
    ds_read_b64_tr_b16 v[228:229], v4 offset:49152
    ds_read_b64_tr_b16 v[230:231], v4 offset:49664
    v_rcp_f32 v193, v193
    v_rcp_f32 v194, v194
    s_waitcnt lgkmcnt(8)
    v_mfma_f32_32x32x16_bf16 v[128:143], v[240:243], v[56:59], v[128:143]
    ds_read_b64_tr_b16 v[232:233], v3 offset:51200
    ds_read_b64_tr_b16 v[234:235], v3 offset:51712
    v_rcp_f32 v195, v195
    v_rcp_f32 v196, v196
    v_mfma_f32_32x32x16_bf16 v[144:159], v[244:247], v[56:59], v[144:159]
    ds_read_b64_tr_b16 v[236:237], v4 offset:51200
    ds_read_b64_tr_b16 v[238:239], v4 offset:51712
    v_rcp_f32 v197, v197
    v_rcp_f32 v198, v198
    s_waitcnt lgkmcnt(8)
    v_mfma_f32_32x32x16_bf16 v[128:143], v[248:251], v[60:63], v[128:143]
    ds_read_b64_tr_b16 v[240:241], v3 offset:53248
    ds_read_b64_tr_b16 v[242:243], v3 offset:53760
    v_rcp_f32 v199, v199
    v_mfma_f32_32x32x16_bf16 v[144:159], v[252:255], v[60:63], v[144:159]
    ds_read_b64_tr_b16 v[244:245], v4 offset:53248
    ds_read_b64_tr_b16 v[246:247], v4 offset:53760
    v_mul_f32 v192, v192, v200
    v_mul_f32 v193, v193, v201
    s_waitcnt lgkmcnt(8)
    v_mfma_f32_32x32x16_bf16 v[128:143], v[224:227], v[64:67], v[128:143]
    ds_read_b64_tr_b16 v[248:249], v3 offset:55296
    ds_read_b64_tr_b16 v[250:251], v3 offset:55808
    s_barrier
    v_mul_f32 v194, v194, v202
    v_mul_f32 v195, v195, v203
    v_mfma_f32_32x32x16_bf16 v[144:159], v[228:231], v[64:67], v[144:159]
    ds_read_b64_tr_b16 v[252:253], v4 offset:55296
    ds_read_b64_tr_b16 v[254:255], v4 offset:55808
    v_mul_f32 v196, v196, v204
    v_mul_f32 v197, v197, v205
    s_waitcnt lgkmcnt(8)
    v_mfma_f32_32x32x16_bf16 v[128:143], v[232:235], v[68:71], v[128:143]
    v_add_u32 v1, 32768, v1
    v_add_u32 v2, 32768, v2
    v_add_u32 v3, 32768, v3
    v_add_u32 v4, 32768, v4
    ds_read_b64_tr_b16 v[224:225], v3 offset:32768
    ds_read_b64_tr_b16 v[226:227], v3 offset:33280
    v_mul_f32 v198, v198, v206
    v_mfma_f32_32x32x16_bf16 v[144:159], v[236:239], v[68:71], v[144:159]
    ds_read_b64_tr_b16 v[228:229], v4 offset:32768
    ds_read_b64_tr_b16 v[230:231], v4 offset:33280
    v_mul_f32 v199, v199, v207
    v_cvt_pk_bf16_f32 v200, v192, v193
    s_waitcnt lgkmcnt(8)
    v_mfma_f32_32x32x16_bf16 v[128:143], v[240:243], v[72:75], v[128:143]
    ds_read_b64_tr_b16 v[232:233], v3 offset:34816
    ds_read_b64_tr_b16 v[234:235], v3 offset:35328
    v_cvt_pk_bf16_f32 v201, v194, v195
    v_cvt_pk_bf16_f32 v202, v196, v197
    v_mfma_f32_32x32x16_bf16 v[144:159], v[244:247], v[72:75], v[144:159]
    ds_read_b64_tr_b16 v[236:237], v4 offset:34816
    ds_read_b64_tr_b16 v[238:239], v4 offset:35328
    v_cvt_pk_bf16_f32 v203, v198, v199
    buffer_store_dwordx4 v[200:203], v0, s[52:55], s66 offen offset:0 sc1
    s_waitcnt lgkmcnt(8)
    v_mfma_f32_32x32x16_bf16 v[128:143], v[248:251], v[76:79], v[128:143]
    ds_read_b64_tr_b16 v[240:241], v3 offset:36864
    ds_read_b64_tr_b16 v[242:243], v3 offset:37376
    v_mul_f32 v208, s75, v208
    v_mfma_f32_32x32x16_bf16 v[144:159], v[252:255], v[76:79], v[144:159]
    ds_read_b64_tr_b16 v[244:245], v4 offset:36864
    ds_read_b64_tr_b16 v[246:247], v4 offset:37376
    v_mul_f32 v209, s75, v209
    v_mul_f32 v210, s75, v210
    s_waitcnt lgkmcnt(8)
    v_mfma_f32_32x32x16_bf16 v[128:143], v[224:227], v[80:83], v[128:143]
    ds_read_b64_tr_b16 v[248:249], v3 offset:38912
    ds_read_b64_tr_b16 v[250:251], v3 offset:39424
    v_mul_f32 v211, s75, v211
    v_mul_f32 v212, s75, v212
    v_mfma_f32_32x32x16_bf16 v[144:159], v[228:231], v[80:83], v[144:159]
    ds_read_b64_tr_b16 v[252:253], v4 offset:38912
    ds_read_b64_tr_b16 v[254:255], v4 offset:39424
    v_mul_f32 v213, s75, v213
    s_waitcnt lgkmcnt(8)
    v_mfma_f32_32x32x16_bf16 v[128:143], v[232:235], v[84:87], v[128:143]
    ds_read_b64_tr_b16 v[224:225], v3 offset:49152
    ds_read_b64_tr_b16 v[226:227], v3 offset:49664
    v_mul_f32 v214, s75, v214
    v_mul_f32 v215, s75, v215
    v_mfma_f32_32x32x16_bf16 v[144:159], v[236:239], v[84:87], v[144:159]
    ds_read_b64_tr_b16 v[228:229], v4 offset:49152
    ds_read_b64_tr_b16 v[230:231], v4 offset:49664
    v_exp_f32 v208, v208
    v_exp_f32 v209, v209
    s_waitcnt lgkmcnt(8)
    v_mfma_f32_32x32x16_bf16 v[128:143], v[240:243], v[88:91], v[128:143]
    ds_read_b64_tr_b16 v[232:233], v3 offset:51200
    ds_read_b64_tr_b16 v[234:235], v3 offset:51712
    v_exp_f32 v210, v210
    v_exp_f32 v211, v211
    v_mfma_f32_32x32x16_bf16 v[144:159], v[244:247], v[88:91], v[144:159]
    ds_read_b64_tr_b16 v[236:237], v4 offset:51200
    ds_read_b64_tr_b16 v[238:239], v4 offset:51712
    v_exp_f32 v212, v212
    s_waitcnt lgkmcnt(8)
    v_mfma_f32_32x32x16_bf16 v[128:143], v[248:251], v[92:95], v[128:143]
    ds_read_b64_tr_b16 v[240:241], v3 offset:53248
    ds_read_b64_tr_b16 v[242:243], v3 offset:53760
    v_exp_f32 v213, v213
    v_exp_f32 v214, v214
    v_mfma_f32_32x32x16_bf16 v[144:159], v[252:255], v[92:95], v[144:159]
    ds_read_b64_tr_b16 v[244:245], v4 offset:53248
    ds_read_b64_tr_b16 v[246:247], v4 offset:53760
    v_exp_f32 v215, v215
    v_add_f32 v208, 1.0, v208
    s_waitcnt lgkmcnt(8)
    v_mfma_f32_32x32x16_bf16 v[128:143], v[224:227], v[96:99], v[128:143]
    ds_read_b64_tr_b16 v[248:249], v3 offset:55296
    ds_read_b64_tr_b16 v[250:251], v3 offset:55808
    v_add_f32 v209, 1.0, v209
    v_add_f32 v210, 1.0, v210
    v_mfma_f32_32x32x16_bf16 v[144:159], v[228:231], v[96:99], v[144:159]
    ds_read_b64_tr_b16 v[252:253], v4 offset:55296
    ds_read_b64_tr_b16 v[254:255], v4 offset:55808
    v_add_f32 v211, 1.0, v211
    s_waitcnt lgkmcnt(8)
    v_mfma_f32_32x32x16_bf16 v[128:143], v[232:235], v[100:103], v[128:143]
    v_add_u32 v1, 4294868992, v1
    v_add_u32 v2, 4294868992, v2
    v_add_u32 v3, 4294868992, v3
    v_add_u32 v4, 4294868992, v4
    ds_read_b64_tr_b16 v[224:225], v3 offset:0
    ds_read_b64_tr_b16 v[226:227], v3 offset:512
    v_add_f32 v212, 1.0, v212
    v_add_f32 v213, 1.0, v213
    v_mfma_f32_32x32x16_bf16 v[144:159], v[236:239], v[100:103], v[144:159]
    ds_read_b64_tr_b16 v[228:229], v4 offset:0
    ds_read_b64_tr_b16 v[230:231], v4 offset:512
    v_add_f32 v214, 1.0, v214
    v_add_f32 v215, 1.0, v215
    s_waitcnt lgkmcnt(8)
    v_mfma_f32_32x32x16_bf16 v[128:143], v[240:243], v[104:107], v[128:143]
    ds_read_b64_tr_b16 v[232:233], v3 offset:2048
    ds_read_b64_tr_b16 v[234:235], v3 offset:2560
    v_rcp_f32 v208, v208
    v_mfma_f32_32x32x16_bf16 v[144:159], v[244:247], v[104:107], v[144:159]
    ds_read_b64_tr_b16 v[236:237], v4 offset:2048
    ds_read_b64_tr_b16 v[238:239], v4 offset:2560
    v_rcp_f32 v209, v209
    v_rcp_f32 v210, v210
    s_waitcnt lgkmcnt(8)
    v_mfma_f32_32x32x16_bf16 v[128:143], v[248:251], v[108:111], v[128:143]
    ds_read_b64_tr_b16 v[240:241], v3 offset:4096
    ds_read_b64_tr_b16 v[242:243], v3 offset:4608
    v_rcp_f32 v211, v211
    v_rcp_f32 v212, v212
    v_mfma_f32_32x32x16_bf16 v[144:159], v[252:255], v[108:111], v[144:159]
    ds_read_b64_tr_b16 v[244:245], v4 offset:4096
    ds_read_b64_tr_b16 v[246:247], v4 offset:4608
    v_rcp_f32 v213, v213
    v_rcp_f32 v214, v214
    s_waitcnt lgkmcnt(8)
    v_mfma_f32_32x32x16_bf16 v[128:143], v[224:227], v[112:115], v[128:143]
    ds_read_b64_tr_b16 v[248:249], v3 offset:6144
    ds_read_b64_tr_b16 v[250:251], v3 offset:6656
    v_rcp_f32 v215, v215
    v_mfma_f32_32x32x16_bf16 v[144:159], v[228:231], v[112:115], v[144:159]
    ds_read_b64_tr_b16 v[252:253], v4 offset:6144
    ds_read_b64_tr_b16 v[254:255], v4 offset:6656
    v_mul_f32 v208, v208, v216
    v_mul_f32 v209, v209, v217
    s_waitcnt lgkmcnt(8)
    v_mfma_f32_32x32x16_bf16 v[128:143], v[232:235], v[116:119], v[128:143]
    v_mul_f32 v210, v210, v218
    v_mul_f32 v211, v211, v219
    v_mfma_f32_32x32x16_bf16 v[144:159], v[236:239], v[116:119], v[144:159]
    v_mul_f32 v212, v212, v220
    v_mul_f32 v213, v213, v221
    s_waitcnt lgkmcnt(4)
    v_mfma_f32_32x32x16_bf16 v[128:143], v[240:243], v[120:123], v[128:143]
    v_mul_f32 v214, v214, v222
    v_mfma_f32_32x32x16_bf16 v[144:159], v[244:247], v[120:123], v[144:159]
    v_mul_f32 v215, v215, v223
    v_cvt_pk_bf16_f32 v216, v208, v209
    s_waitcnt lgkmcnt(0)
    v_mfma_f32_32x32x16_bf16 v[128:143], v[248:251], v[124:127], v[128:143]
    v_cvt_pk_bf16_f32 v217, v210, v211
    v_cvt_pk_bf16_f32 v218, v212, v213
    v_mfma_f32_32x32x16_bf16 v[144:159], v[252:255], v[124:127], v[144:159]
    v_cvt_pk_bf16_f32 v219, v214, v215
    buffer_store_dwordx4 v[216:219], v0, s[52:55], s66 offen offset:1024 sc1
    s_nop 6
    v_mul_f32 v128, s75, v128
    v_mul_f32 v129, s75, v129
    v_mul_f32 v130, s75, v130
    v_mul_f32 v131, s75, v131
    v_mul_f32 v132, s75, v132
    v_mul_f32 v133, s75, v133
    v_mul_f32 v134, s75, v134
    v_mul_f32 v135, s75, v135
    v_exp_f32 v128, v128
    v_exp_f32 v129, v129
    v_exp_f32 v130, v130
    v_exp_f32 v131, v131
    v_exp_f32 v132, v132
    v_exp_f32 v133, v133
    v_exp_f32 v134, v134
    v_exp_f32 v135, v135
    v_add_f32 v128, 1.0, v128
    v_add_f32 v129, 1.0, v129
    v_add_f32 v130, 1.0, v130
    v_add_f32 v131, 1.0, v131
    v_add_f32 v132, 1.0, v132
    v_add_f32 v133, 1.0, v133
    v_add_f32 v134, 1.0, v134
    v_add_f32 v135, 1.0, v135
    v_rcp_f32 v128, v128
    v_rcp_f32 v129, v129
    v_rcp_f32 v130, v130
    v_rcp_f32 v131, v131
    v_rcp_f32 v132, v132
    v_rcp_f32 v133, v133
    v_rcp_f32 v134, v134
    v_rcp_f32 v135, v135
    v_mul_f32 v128, v128, v136
    v_mul_f32 v129, v129, v137
    v_mul_f32 v130, v130, v138
    v_mul_f32 v131, v131, v139
    v_mul_f32 v132, v132, v140
    v_mul_f32 v133, v133, v141
    v_mul_f32 v134, v134, v142
    v_mul_f32 v135, v135, v143
    v_cvt_pk_bf16_f32 v136, v128, v129
    v_cvt_pk_bf16_f32 v137, v130, v131
    v_cvt_pk_bf16_f32 v138, v132, v133
    v_cvt_pk_bf16_f32 v139, v134, v135
    buffer_store_dwordx4 v[136:139], v0, s[52:55], s66 offen offset:2048 sc1
    v_mul_f32 v144, s75, v144
    v_mul_f32 v145, s75, v145
    v_mul_f32 v146, s75, v146
    v_mul_f32 v147, s75, v147
    v_mul_f32 v148, s75, v148
    v_mul_f32 v149, s75, v149
    v_mul_f32 v150, s75, v150
    v_mul_f32 v151, s75, v151
    v_exp_f32 v144, v144
    v_exp_f32 v145, v145
    v_exp_f32 v146, v146
    v_exp_f32 v147, v147
    v_exp_f32 v148, v148
    v_exp_f32 v149, v149
    v_exp_f32 v150, v150
    v_exp_f32 v151, v151
    v_add_f32 v144, 1.0, v144
    v_add_f32 v145, 1.0, v145
    v_add_f32 v146, 1.0, v146
    v_add_f32 v147, 1.0, v147
    v_add_f32 v148, 1.0, v148
    v_add_f32 v149, 1.0, v149
    v_add_f32 v150, 1.0, v150
    v_add_f32 v151, 1.0, v151
    v_rcp_f32 v144, v144
    v_rcp_f32 v145, v145
    v_rcp_f32 v146, v146
    v_rcp_f32 v147, v147
    v_rcp_f32 v148, v148
    v_rcp_f32 v149, v149
    v_rcp_f32 v150, v150
    v_rcp_f32 v151, v151
    v_mul_f32 v144, v144, v152
    v_mul_f32 v145, v145, v153
    v_mul_f32 v146, v146, v154
    v_mul_f32 v147, v147, v155
    v_mul_f32 v148, v148, v156
    v_mul_f32 v149, v149, v157
    v_mul_f32 v150, v150, v158
    v_mul_f32 v151, v151, v159
    v_cvt_pk_bf16_f32 v152, v144, v145
    v_cvt_pk_bf16_f32 v153, v146, v147
    v_cvt_pk_bf16_f32 v154, v148, v149
    v_cvt_pk_bf16_f32 v155, v150, v151
    buffer_store_dwordx4 v[152:155], v0, s[52:55], s66 offen offset:3072 sc1
    s_branch K1_CDONE
K1_KV:
    buffer_load_dword v14, off, s[80:83], 0 sc1
    s_waitcnt lgkmcnt(4)
    v_mfma_f32_32x32x16_bf16 v[192:207], v[224:227], v[16:19], 0
    ds_read_b64_tr_b16 v[240:241], v1 offset:4096
    ds_read_b64_tr_b16 v[242:243], v1 offset:4608
    ds_read_b64_tr_b16 v[248:249], v1 offset:6144
    ds_read_b64_tr_b16 v[250:251], v1 offset:6656
    v_cvt_pk_bf16_f32 v128, v128, v129
    v_cvt_pk_bf16_f32 v129, v130, v131
    v_cvt_pk_bf16_f32 v130, v132, v133
    v_cvt_pk_bf16_f32 v131, v134, v135
    v_cvt_pk_bf16_f32 v132, v136, v137
    v_cvt_pk_bf16_f32 v133, v138, v139
    v_cvt_pk_bf16_f32 v134, v140, v141
    v_cvt_pk_bf16_f32 v135, v142, v143
    buffer_store_dwordx4 v[128:131], v0, s[52:55], s67 offen offset:0 sc1
    buffer_store_dwordx4 v[132:135], v0, s[52:55], s67 offen offset:1024 sc1
    v_cvt_pk_bf16_f32 v176, v176, v177
    v_cvt_pk_bf16_f32 v177, v178, v179
    v_cvt_pk_bf16_f32 v178, v180, v181
    v_cvt_pk_bf16_f32 v179, v182, v183
    v_cvt_pk_bf16_f32 v180, v184, v185
    v_cvt_pk_bf16_f32 v181, v186, v187
    v_cvt_pk_bf16_f32 v182, v188, v189
    v_mfma_f32_32x32x16_bf16 v[208:223], v[228:231], v[16:19], 0
    ds_read_b64_tr_b16 v[244:245], v2 offset:4096
    ds_read_b64_tr_b16 v[246:247], v2 offset:4608
    ds_read_b64_tr_b16 v[252:253], v2 offset:6144
    ds_read_b64_tr_b16 v[254:255], v2 offset:6656
    v_cvt_pk_bf16_f32 v183, v190, v191
    v_cndmask_b32 v182, v182, v6, vcc
    v_cndmask_b32 v183, v183, 0, vcc
    ds_write_b64 v8, v[176:177] offset:0
    ds_write_b64 v8, v[178:179] offset:16
    ds_write_b64 v8, v[180:181] offset:32
    ds_write_b64 v8, v[182:183] offset:48
    ds_read_b64_tr_b16 v[184:185], v10 offset:0
    ds_read_b64_tr_b16 v[186:187], v10 offset:512
    ds_read_b64_tr_b16 v[188:189], v10 offset:1024
    ds_read_b64_tr_b16 v[190:191], v10 offset:1536
    v_mul_f32 v160, s76, v160
    v_mul_f32 v161, s76, v161
    v_mul_f32 v162, s76, v162
    v_mul_f32 v163, s76, v163
    v_mul_f32 v164, s76, v164
    v_mul_f32 v165, s76, v165
    s_waitcnt lgkmcnt(15)
    v_mfma_f32_32x32x16_bf16 v[192:207], v[232:235], v[20:23], v[192:207]
    ds_read_b64_tr_b16 v[224:225], v1 offset:16384
    ds_read_b64_tr_b16 v[226:227], v1 offset:16896
    v_mul_f32 v166, s76, v166
    v_mul_f32 v167, s76, v167
    v_mul_f32 v168, s76, v168
    v_mul_f32 v169, s76, v169
    v_mul_f32 v170, s76, v170
    v_mul_f32 v171, s76, v171
    v_mul_f32 v172, s76, v172
    v_mul_f32 v173, s76, v173
    v_mul_f32 v174, s76, v174
    v_mul_f32 v175, s76, v175
    v_cvt_pk_bf16_f32 v160, v160, v161
    v_cvt_pk_bf16_f32 v161, v162, v163
    v_cvt_pk_bf16_f32 v162, v164, v165
    v_cvt_pk_bf16_f32 v163, v166, v167
    v_cvt_pk_bf16_f32 v164, v168, v169
    v_cvt_pk_bf16_f32 v165, v170, v171
    v_cvt_pk_bf16_f32 v166, v172, v173
    v_mfma_f32_32x32x16_bf16 v[208:223], v[236:239], v[20:23], v[208:223]
    ds_read_b64_tr_b16 v[228:229], v2 offset:16384
    ds_read_b64_tr_b16 v[230:231], v2 offset:16896
    v_cvt_pk_bf16_f32 v167, v174, v175
    v_cndmask_b32 v166, v166, v5, vcc
    v_cndmask_b32 v167, v167, v6, vcc
    buffer_store_dwordx4 v[160:163], v0, s[52:55], s71 offen sc1
    buffer_store_dwordx4 v[164:167], v0, s[52:55], s71 offen offset:1024 sc1
    s_waitcnt lgkmcnt(6)
    buffer_store_dwordx4 v[184:187], v0, s[52:55], s71 offen offset:2048 sc1
    s_waitcnt lgkmcnt(4)
    buffer_store_dwordx4 v[188:191], v0, s[52:55], s71 offen offset:3072 sc1
    v_cvt_pk_bf16_f32 v144, v144, v145
    v_cvt_pk_bf16_f32 v145, v146, v147
    v_cvt_pk_bf16_f32 v146, v148, v149
    v_cvt_pk_bf16_f32 v147, v150, v151
    v_cvt_pk_bf16_f32 v148, v152, v153
    v_cvt_pk_bf16_f32 v149, v154, v155
    v_cvt_pk_bf16_f32 v150, v156, v157
    v_cvt_pk_bf16_f32 v151, v158, v159
    buffer_store_dwordx4 v[144:147], v0, s[52:55], s67 offen offset:2048 sc1
    buffer_store_dwordx4 v[148:151], v0, s[52:55], s67 offen offset:3072 sc1
    v_mfma_f32_32x32x16_bf16 v[192:207], v[240:243], v[24:27], v[192:207]
    ds_read_b64_tr_b16 v[232:233], v1 offset:18432
    ds_read_b64_tr_b16 v[234:235], v1 offset:18944
    s_lshl_b32 s5, s60, 11
    v_mfma_f32_32x32x16_bf16 v[208:223], v[244:247], v[24:27], v[208:223]
    ds_read_b64_tr_b16 v[236:237], v2 offset:18432
    ds_read_b64_tr_b16 v[238:239], v2 offset:18944
    s_lshl_b32 s6, s61, 9
    v_mfma_f32_32x32x16_bf16 v[192:207], v[248:251], v[28:31], v[192:207]
    ds_read_b64_tr_b16 v[240:241], v1 offset:20480
    ds_read_b64_tr_b16 v[242:243], v1 offset:20992
    s_add_u32 s5, s5, s6
    v_mfma_f32_32x32x16_bf16 v[208:223], v[252:255], v[28:31], v[208:223]
    ds_read_b64_tr_b16 v[244:245], v2 offset:20480
    ds_read_b64_tr_b16 v[246:247], v2 offset:20992
    s_lshl_b32 s6, s62, 7
    s_waitcnt lgkmcnt(8)
    v_mfma_f32_32x32x16_bf16 v[192:207], v[224:227], v[32:35], v[192:207]
    ds_read_b64_tr_b16 v[248:249], v1 offset:22528
    ds_read_b64_tr_b16 v[250:251], v1 offset:23040
    s_add_u32 s5, s5, s6
    v_mfma_f32_32x32x16_bf16 v[208:223], v[228:231], v[32:35], v[208:223]
    ds_read_b64_tr_b16 v[252:253], v2 offset:22528
    ds_read_b64_tr_b16 v[254:255], v2 offset:23040
    s_add_u32 s79, s5, 20971520
    s_waitcnt lgkmcnt(8)
    v_mfma_f32_32x32x16_bf16 v[192:207], v[232:235], v[36:39], v[192:207]
    ds_read_b64_tr_b16 v[224:225], v1 offset:32768
    ds_read_b64_tr_b16 v[226:227], v1 offset:33280
    v_mfma_f32_32x32x16_bf16 v[208:223], v[236:239], v[36:39], v[208:223]
    ds_read_b64_tr_b16 v[228:229], v2 offset:32768
    ds_read_b64_tr_b16 v[230:231], v2 offset:33280
    s_waitcnt lgkmcnt(8)
    v_mfma_f32_32x32x16_bf16 v[192:207], v[240:243], v[40:43], v[192:207]
    ds_read_b64_tr_b16 v[232:233], v1 offset:34816
    ds_read_b64_tr_b16 v[234:235], v1 offset:35328
    v_mfma_f32_32x32x16_bf16 v[208:223], v[244:247], v[40:43], v[208:223]
    ds_read_b64_tr_b16 v[236:237], v2 offset:34816
    ds_read_b64_tr_b16 v[238:239], v2 offset:35328
    s_waitcnt lgkmcnt(8)
    v_mfma_f32_32x32x16_bf16 v[192:207], v[248:251], v[44:47], v[192:207]
    ds_read_b64_tr_b16 v[240:241], v1 offset:36864
    ds_read_b64_tr_b16 v[242:243], v1 offset:37376
    v_mfma_f32_32x32x16_bf16 v[208:223], v[252:255], v[44:47], v[208:223]
    ds_read_b64_tr_b16 v[244:245], v2 offset:36864
    ds_read_b64_tr_b16 v[246:247], v2 offset:37376
    s_waitcnt lgkmcnt(8)
    v_mfma_f32_32x32x16_bf16 v[192:207], v[224:227], v[48:51], v[192:207]
    ds_read_b64_tr_b16 v[248:249], v1 offset:38912
    ds_read_b64_tr_b16 v[250:251], v1 offset:39424
    v_mfma_f32_32x32x16_bf16 v[208:223], v[228:231], v[48:51], v[208:223]
    ds_read_b64_tr_b16 v[252:253], v2 offset:38912
    ds_read_b64_tr_b16 v[254:255], v2 offset:39424
    s_waitcnt lgkmcnt(8)
    v_mfma_f32_32x32x16_bf16 v[192:207], v[232:235], v[52:55], v[192:207]
    ds_read_b64_tr_b16 v[224:225], v1 offset:49152
    ds_read_b64_tr_b16 v[226:227], v1 offset:49664
    v_mfma_f32_32x32x16_bf16 v[208:223], v[236:239], v[52:55], v[208:223]
    ds_read_b64_tr_b16 v[228:229], v2 offset:49152
    ds_read_b64_tr_b16 v[230:231], v2 offset:49664
    s_waitcnt lgkmcnt(8)
    v_mfma_f32_32x32x16_bf16 v[192:207], v[240:243], v[56:59], v[192:207]
    ds_read_b64_tr_b16 v[232:233], v1 offset:51200
    ds_read_b64_tr_b16 v[234:235], v1 offset:51712
    v_mfma_f32_32x32x16_bf16 v[208:223], v[244:247], v[56:59], v[208:223]
    ds_read_b64_tr_b16 v[236:237], v2 offset:51200
    ds_read_b64_tr_b16 v[238:239], v2 offset:51712
    s_waitcnt lgkmcnt(8)
    v_mfma_f32_32x32x16_bf16 v[192:207], v[248:251], v[60:63], v[192:207]
    ds_read_b64_tr_b16 v[240:241], v1 offset:53248
    ds_read_b64_tr_b16 v[242:243], v1 offset:53760
    v_mfma_f32_32x32x16_bf16 v[208:223], v[252:255], v[60:63], v[208:223]
    ds_read_b64_tr_b16 v[244:245], v2 offset:53248
    ds_read_b64_tr_b16 v[246:247], v2 offset:53760
    s_waitcnt lgkmcnt(8)
    v_mfma_f32_32x32x16_bf16 v[192:207], v[224:227], v[64:67], v[192:207]
    ds_read_b64_tr_b16 v[248:249], v1 offset:55296
    ds_read_b64_tr_b16 v[250:251], v1 offset:55808
    v_mfma_f32_32x32x16_bf16 v[208:223], v[228:231], v[64:67], v[208:223]
    ds_read_b64_tr_b16 v[252:253], v2 offset:55296
    ds_read_b64_tr_b16 v[254:255], v2 offset:55808
    s_waitcnt vmcnt(0)
    v_readfirstlane_b32 s4, v14
    s_nop 0
    s_cmp_lg_u32 s4, 0
    s_cbranch_scc1 NC6E
    s_mov_b32 s5, 400000
NC6:
    buffer_load_dword v14, off, s[80:83], 0 sc1
    s_waitcnt vmcnt(0)
    v_readfirstlane_b32 s4, v14
    s_nop 0
    s_cmp_lg_u32 s4, 0
    s_cbranch_scc1 NC6E
    s_sub_u32 s5, s5, 1
    s_cmp_lg_u32 s5, 0
    s_cbranch_scc1 NC6
NC6E:
    s_mov_b64 exec, 1
    buffer_store_dword v14, off, s[52:55], s79 sc1
    s_mov_b64 exec, -1
    s_waitcnt lgkmcnt(8)
    v_mfma_f32_32x32x16_bf16 v[192:207], v[232:235], v[68:71], v[192:207]
    v_add_u32 v1, 32768, v1
    v_add_u32 v2, 32768, v2
    v_add_u32 v3, 32768, v3
    v_add_u32 v4, 32768, v4
    ds_read_b64_tr_b16 v[224:225], v1 offset:32768
    ds_read_b64_tr_b16 v[226:227], v1 offset:33280
    v_mfma_f32_32x32x16_bf16 v[208:223], v[236:239], v[68:71], v[208:223]
    ds_read_b64_tr_b16 v[228:229], v2 offset:32768
    ds_read_b64_tr_b16 v[230:231], v2 offset:33280
    s_waitcnt lgkmcnt(8)
    v_mfma_f32_32x32x16_bf16 v[192:207], v[240:243], v[72:75], v[192:207]
    ds_read_b64_tr_b16 v[232:233], v1 offset:34816
    ds_read_b64_tr_b16 v[234:235], v1 offset:35328
    v_mfma_f32_32x32x16_bf16 v[208:223], v[244:247], v[72:75], v[208:223]
    ds_read_b64_tr_b16 v[236:237], v2 offset:34816
    ds_read_b64_tr_b16 v[238:239], v2 offset:35328
    s_waitcnt lgkmcnt(8)
    v_mfma_f32_32x32x16_bf16 v[192:207], v[248:251], v[76:79], v[192:207]
    ds_read_b64_tr_b16 v[240:241], v1 offset:36864
    ds_read_b64_tr_b16 v[242:243], v1 offset:37376
    s_mov_b32 s40, s24
    s_mov_b32 s41, s25
    s_mov_b32 s42, 1605632
    v_mfma_f32_32x32x16_bf16 v[208:223], v[252:255], v[76:79], v[208:223]
    ds_read_b64_tr_b16 v[244:245], v2 offset:36864
    ds_read_b64_tr_b16 v[246:247], v2 offset:37376
    s_mov_b32 s43, 0x20000
    s_and_b32 s4, s61, 7
    s_cmp_lt_u32 s61, 8
    s_waitcnt lgkmcnt(8)
    v_mfma_f32_32x32x16_bf16 v[192:207], v[224:227], v[80:83], v[192:207]
    ds_read_b64_tr_b16 v[248:249], v1 offset:38912
    ds_read_b64_tr_b16 v[250:251], v1 offset:39424
    s_cselect_b32 s5, 3, 7
    s_cmp_gt_u32 s4, s5
    s_subb_u32 s70, s4, 0
    v_mfma_f32_32x32x16_bf16 v[208:223], v[228:231], v[80:83], v[208:223]
    ds_read_b64_tr_b16 v[252:253], v2 offset:38912
    ds_read_b64_tr_b16 v[254:255], v2 offset:39424
    s_cmp_eq_u32 s4, s5
    s_and_b32 s5, s60, 3
    s_mul_i32 s5, s5, 7
    s_lshl_b32 s6, s70, 2
    s_waitcnt lgkmcnt(8)
    v_mfma_f32_32x32x16_bf16 v[192:207], v[232:235], v[84:87], v[192:207]
    ds_read_b64_tr_b16 v[224:225], v1 offset:49152
    ds_read_b64_tr_b16 v[226:227], v1 offset:49664
    s_barrier
    s_add_u32 s5, s5, s6
    s_cmp_ge_u32 s5, 28
    s_cselect_b32 s6, 28, 0
    v_mfma_f32_32x32x16_bf16 v[208:223], v[236:239], v[84:87], v[208:223]
    ds_read_b64_tr_b16 v[228:229], v2 offset:49152
    ds_read_b64_tr_b16 v[230:231], v2 offset:49664
    s_sub_u32 s63, s5, s6
    s_add_u32 s5, s63, 6
    s_cmp_ge_u32 s5, 28
    s_waitcnt lgkmcnt(8)
    v_mfma_f32_32x32x16_bf16 v[192:207], v[240:243], v[88:91], v[192:207]
    ds_read_b64_tr_b16 v[232:233], v1 offset:51200
    ds_read_b64_tr_b16 v[234:235], v1 offset:51712
    s_cselect_b32 s6, 28, 0
    s_sub_u32 s5, s5, s6
    s_mul_i32 s73, s5, 14336
    s_mul_i32 s74, s62, 12288
    v_mfma_f32_32x32x16_bf16 v[208:223], v[244:247], v[88:91], v[208:223]
    ds_read_b64_tr_b16 v[236:237], v2 offset:51200
    ds_read_b64_tr_b16 v[238:239], v2 offset:51712
    s_add_u32 s74, s74, 16384
    s_lshl_b32 s5, s70, 7
    s_mul_i32 s6, s62, 401408
    s_waitcnt lgkmcnt(8)
    v_mfma_f32_32x32x16_bf16 v[192:207], v[248:251], v[92:95], v[192:207]
    ds_read_b64_tr_b16 v[240:241], v1 offset:53248
    ds_read_b64_tr_b16 v[242:243], v1 offset:53760
    s_add_u32 s5, s5, s6
    v_lshrrev_b32 v7, 7, v0
    v_mul_u32_u24 v7, 896, v7
    v_mfma_f32_32x32x16_bf16 v[208:223], v[252:255], v[92:95], v[208:223]
    ds_read_b64_tr_b16 v[244:245], v2 offset:53248
    ds_read_b64_tr_b16 v[246:247], v2 offset:53760
    v_and_b32 v13, 0x70, v0
    v_add_u32 v7, v7, v13
    v_add_u32 v12, s5, v7
    v_add_u32 v13, 7168, v12
    s_waitcnt lgkmcnt(8)
    v_mfma_f32_32x32x16_bf16 v[192:207], v[224:227], v[96:99], v[192:207]
    ds_read_b64_tr_b16 v[248:249], v1 offset:55296
    ds_read_b64_tr_b16 v[250:251], v1 offset:55808
    v_mfma_f32_32x32x16_bf16 v[208:223], v[228:231], v[96:99], v[208:223]
    ds_read_b64_tr_b16 v[252:253], v2 offset:55296
    ds_read_b64_tr_b16 v[254:255], v2 offset:55808
    s_waitcnt lgkmcnt(8)
    v_mfma_f32_32x32x16_bf16 v[192:207], v[232:235], v[100:103], v[192:207]
    v_add_u32 v1, 4294868992, v1
    v_add_u32 v2, 4294868992, v2
    v_add_u32 v3, 4294868992, v3
    v_add_u32 v4, 4294868992, v4
    ds_read_b64_tr_b16 v[224:225], v1 offset:0
    ds_read_b64_tr_b16 v[226:227], v1 offset:512
    v_mfma_f32_32x32x16_bf16 v[208:223], v[236:239], v[100:103], v[208:223]
    ds_read_b64_tr_b16 v[228:229], v2 offset:0
    ds_read_b64_tr_b16 v[230:231], v2 offset:512
    s_waitcnt lgkmcnt(8)
    v_mfma_f32_32x32x16_bf16 v[192:207], v[240:243], v[104:107], v[192:207]
    ds_read_b64_tr_b16 v[232:233], v1 offset:2048
    ds_read_b64_tr_b16 v[234:235], v1 offset:2560
    v_mfma_f32_32x32x16_bf16 v[208:223], v[244:247], v[104:107], v[208:223]
    ds_read_b64_tr_b16 v[236:237], v2 offset:2048
    ds_read_b64_tr_b16 v[238:239], v2 offset:2560
    s_waitcnt lgkmcnt(8)
    v_mfma_f32_32x32x16_bf16 v[192:207], v[248:251], v[108:111], v[192:207]
    ds_read_b64_tr_b16 v[240:241], v1 offset:4096
    ds_read_b64_tr_b16 v[242:243], v1 offset:4608
    v_mfma_f32_32x32x16_bf16 v[208:223], v[252:255], v[108:111], v[208:223]
    ds_read_b64_tr_b16 v[244:245], v2 offset:4096
    ds_read_b64_tr_b16 v[246:247], v2 offset:4608
    s_waitcnt lgkmcnt(8)
    v_mfma_f32_32x32x16_bf16 v[192:207], v[224:227], v[112:115], v[192:207]
    ds_read_b64_tr_b16 v[248:249], v1 offset:6144
    ds_read_b64_tr_b16 v[250:251], v1 offset:6656
    v_mfma_f32_32x32x16_bf16 v[208:223], v[228:231], v[112:115], v[208:223]
    ds_read_b64_tr_b16 v[252:253], v2 offset:6144
    ds_read_b64_tr_b16 v[254:255], v2 offset:6656
    s_waitcnt lgkmcnt(8)
    v_mfma_f32_32x32x16_bf16 v[192:207], v[232:235], v[116:119], v[192:207]
    v_add_u32 v1, 65536, v1
    v_add_u32 v2, 65536, v2
    v_add_u32 v3, 65536, v3
    v_add_u32 v4, 65536, v4
    ds_read_b64_tr_b16 v[224:225], v3 offset:0
    ds_read_b64_tr_b16 v[226:227], v3 offset:512
    v_mfma_f32_32x32x16_bf16 v[208:223], v[236:239], v[116:119], v[208:223]
    ds_read_b64_tr_b16 v[228:229], v4 offset:0
    ds_read_b64_tr_b16 v[230:231], v4 offset:512
    s_waitcnt lgkmcnt(8)
    v_mfma_f32_32x32x16_bf16 v[192:207], v[240:243], v[120:123], v[192:207]
    ds_read_b64_tr_b16 v[232:233], v3 offset:2048
    ds_read_b64_tr_b16 v[234:235], v3 offset:2560
    v_mfma_f32_32x32x16_bf16 v[208:223], v[244:247], v[120:123], v[208:223]
    ds_read_b64_tr_b16 v[236:237], v4 offset:2048
    ds_read_b64_tr_b16 v[238:239], v4 offset:2560
    s_waitcnt lgkmcnt(8)
    v_mfma_f32_32x32x16_bf16 v[192:207], v[248:251], v[124:127], v[192:207]
    ds_read_b64_tr_b16 v[240:241], v3 offset:4096
    ds_read_b64_tr_b16 v[242:243], v3 offset:4608
    v_mfma_f32_32x32x16_bf16 v[208:223], v[252:255], v[124:127], v[208:223]
    ds_read_b64_tr_b16 v[244:245], v4 offset:4096
    ds_read_b64_tr_b16 v[246:247], v4 offset:4608
    s_waitcnt lgkmcnt(8)
    v_mfma_f32_32x32x16_bf16 v[128:143], v[224:227], v[16:19], 0
    ds_read_b64_tr_b16 v[248:249], v3 offset:6144
    ds_read_b64_tr_b16 v[250:251], v3 offset:6656
    v_mfma_f32_32x32x16_bf16 v[144:159], v[228:231], v[16:19], 0
    ds_read_b64_tr_b16 v[252:253], v4 offset:6144
    ds_read_b64_tr_b16 v[254:255], v4 offset:6656
    s_waitcnt lgkmcnt(8)
    v_mfma_f32_32x32x16_bf16 v[128:143], v[232:235], v[20:23], v[128:143]
    ds_read_b64_tr_b16 v[224:225], v3 offset:16384
    ds_read_b64_tr_b16 v[226:227], v3 offset:16896
    v_mfma_f32_32x32x16_bf16 v[144:159], v[236:239], v[20:23], v[144:159]
    ds_read_b64_tr_b16 v[228:229], v4 offset:16384
    ds_read_b64_tr_b16 v[230:231], v4 offset:16896
    s_waitcnt lgkmcnt(8)
    v_mfma_f32_32x32x16_bf16 v[128:143], v[240:243], v[24:27], v[128:143]
    ds_read_b64_tr_b16 v[232:233], v3 offset:18432
    ds_read_b64_tr_b16 v[234:235], v3 offset:18944
    v_mul_f32 v192, s75, v192
    v_mfma_f32_32x32x16_bf16 v[144:159], v[244:247], v[24:27], v[144:159]
    ds_read_b64_tr_b16 v[236:237], v4 offset:18432
    ds_read_b64_tr_b16 v[238:239], v4 offset:18944
    v_mul_f32 v193, s75, v193
    v_mul_f32 v194, s75, v194
    s_waitcnt lgkmcnt(8)
    v_mfma_f32_32x32x16_bf16 v[128:143], v[248:251], v[28:31], v[128:143]
    ds_read_b64_tr_b16 v[240:241], v3 offset:20480
    ds_read_b64_tr_b16 v[242:243], v3 offset:20992
    v_mul_f32 v195, s75, v195
    v_mul_f32 v196, s75, v196
    v_mfma_f32_32x32x16_bf16 v[144:159], v[252:255], v[28:31], v[144:159]
    ds_read_b64_tr_b16 v[244:245], v4 offset:20480
    ds_read_b64_tr_b16 v[246:247], v4 offset:20992
    v_mul_f32 v197, s75, v197
    s_waitcnt lgkmcnt(8)
    v_mfma_f32_32x32x16_bf16 v[128:143], v[224:227], v[32:35], v[128:143]
    ds_read_b64_tr_b16 v[248:249], v3 offset:22528
    ds_read_b64_tr_b16 v[250:251], v3 offset:23040
    v_mul_f32 v198, s75, v198
    v_mul_f32 v199, s75, v199
    v_mfma_f32_32x32x16_bf16 v[144:159], v[228:231], v[32:35], v[144:159]
    ds_read_b64_tr_b16 v[252:253], v4 offset:22528
    ds_read_b64_tr_b16 v[254:255], v4 offset:23040
    v_exp_f32 v192, v192
    v_exp_f32 v193, v193
    s_waitcnt lgkmcnt(8)
    v_mfma_f32_32x32x16_bf16 v[128:143], v[232:235], v[36:39], v[128:143]
    ds_read_b64_tr_b16 v[224:225], v3 offset:32768
    ds_read_b64_tr_b16 v[226:227], v3 offset:33280
    v_exp_f32 v194, v194
    v_exp_f32 v195, v195
    v_mfma_f32_32x32x16_bf16 v[144:159], v[236:239], v[36:39], v[144:159]
    ds_read_b64_tr_b16 v[228:229], v4 offset:32768
    ds_read_b64_tr_b16 v[230:231], v4 offset:33280
    v_exp_f32 v196, v196
    s_waitcnt lgkmcnt(8)
    v_mfma_f32_32x32x16_bf16 v[128:143], v[240:243], v[40:43], v[128:143]
    ds_read_b64_tr_b16 v[232:233], v3 offset:34816
    ds_read_b64_tr_b16 v[234:235], v3 offset:35328
    v_exp_f32 v197, v197
    v_exp_f32 v198, v198
    v_mfma_f32_32x32x16_bf16 v[144:159], v[244:247], v[40:43], v[144:159]
    ds_read_b64_tr_b16 v[236:237], v4 offset:34816
    ds_read_b64_tr_b16 v[238:239], v4 offset:35328
    v_exp_f32 v199, v199
    v_add_f32 v192, 1.0, v192
    s_waitcnt lgkmcnt(8)
    v_mfma_f32_32x32x16_bf16 v[128:143], v[248:251], v[44:47], v[128:143]
    ds_read_b64_tr_b16 v[240:241], v3 offset:36864
    ds_read_b64_tr_b16 v[242:243], v3 offset:37376
    v_add_f32 v193, 1.0, v193
    v_add_f32 v194, 1.0, v194
    v_mfma_f32_32x32x16_bf16 v[144:159], v[252:255], v[44:47], v[144:159]
    ds_read_b64_tr_b16 v[244:245], v4 offset:36864
    ds_read_b64_tr_b16 v[246:247], v4 offset:37376
    v_add_f32 v195, 1.0, v195
    s_waitcnt lgkmcnt(8)
    v_mfma_f32_32x32x16_bf16 v[128:143], v[224:227], v[48:51], v[128:143]
    ds_read_b64_tr_b16 v[248:249], v3 offset:38912
    ds_read_b64_tr_b16 v[250:251], v3 offset:39424
    v_add_f32 v196, 1.0, v196
    v_add_f32 v197, 1.0, v197
    v_mfma_f32_32x32x16_bf16 v[144:159], v[228:231], v[48:51], v[144:159]
    ds_read_b64_tr_b16 v[252:253], v4 offset:38912
    ds_read_b64_tr_b16 v[254:255], v4 offset:39424
    v_add_f32 v198, 1.0, v198
    v_add_f32 v199, 1.0, v199
    s_waitcnt lgkmcnt(8)
    v_mfma_f32_32x32x16_bf16 v[128:143], v[232:235], v[52:55], v[128:143]
    ds_read_b64_tr_b16 v[224:225], v3 offset:49152
    ds_read_b64_tr_b16 v[226:227], v3 offset:49664
    v_rcp_f32 v192, v192
    v_mfma_f32_32x32x16_bf16 v[144:159], v[236:239], v[52:55], v[144:159]
    ds_read_b64_tr_b16 v[228:229], v4 offset:49152
    ds_read_b64_tr_b16 v[230:231], v4 offset:49664
    v_rcp_f32 v193, v193
    v_rcp_f32 v194, v194
    s_waitcnt lgkmcnt(8)
    v_mfma_f32_32x32x16_bf16 v[128:143], v[240:243], v[56:59], v[128:143]
    ds_read_b64_tr_b16 v[232:233], v3 offset:51200
    ds_read_b64_tr_b16 v[234:235], v3 offset:51712
    v_rcp_f32 v195, v195
    v_rcp_f32 v196, v196
    v_mfma_f32_32x32x16_bf16 v[144:159], v[244:247], v[56:59], v[144:159]
    ds_read_b64_tr_b16 v[236:237], v4 offset:51200
    ds_read_b64_tr_b16 v[238:239], v4 offset:51712
    v_rcp_f32 v197, v197
    v_rcp_f32 v198, v198
    s_waitcnt lgkmcnt(8)
    v_mfma_f32_32x32x16_bf16 v[128:143], v[248:251], v[60:63], v[128:143]
    ds_read_b64_tr_b16 v[240:241], v3 offset:53248
    ds_read_b64_tr_b16 v[242:243], v3 offset:53760
    v_rcp_f32 v199, v199
    v_mfma_f32_32x32x16_bf16 v[144:159], v[252:255], v[60:63], v[144:159]
    ds_read_b64_tr_b16 v[244:245], v4 offset:53248
    ds_read_b64_tr_b16 v[246:247], v4 offset:53760
    v_mul_f32 v192, v192, v200
    v_mul_f32 v193, v193, v201
    s_waitcnt lgkmcnt(8)
    v_mfma_f32_32x32x16_bf16 v[128:143], v[224:227], v[64:67], v[128:143]
    ds_read_b64_tr_b16 v[248:249], v3 offset:55296
    ds_read_b64_tr_b16 v[250:251], v3 offset:55808
    v_mul_f32 v194, v194, v202
    v_mul_f32 v195, v195, v203
    v_mfma_f32_32x32x16_bf16 v[144:159], v[228:231], v[64:67], v[144:159]
    ds_read_b64_tr_b16 v[252:253], v4 offset:55296
    ds_read_b64_tr_b16 v[254:255], v4 offset:55808
    v_mul_f32 v196, v196, v204
    v_mul_f32 v197, v197, v205
    s_waitcnt lgkmcnt(8)
    v_mfma_f32_32x32x16_bf16 v[128:143], v[232:235], v[68:71], v[128:143]
    v_add_u32 v1, 32768, v1
    v_add_u32 v2, 32768, v2
    v_add_u32 v3, 32768, v3
    v_add_u32 v4, 32768, v4
    ds_read_b64_tr_b16 v[224:225], v3 offset:32768
    ds_read_b64_tr_b16 v[226:227], v3 offset:33280
    v_mul_f32 v198, v198, v206
    v_mfma_f32_32x32x16_bf16 v[144:159], v[236:239], v[68:71], v[144:159]
    ds_read_b64_tr_b16 v[228:229], v4 offset:32768
    ds_read_b64_tr_b16 v[230:231], v4 offset:33280
    v_mul_f32 v199, v199, v207
    v_cvt_pk_bf16_f32 v200, v192, v193
    s_waitcnt lgkmcnt(8)
    v_mfma_f32_32x32x16_bf16 v[128:143], v[240:243], v[72:75], v[128:143]
    ds_read_b64_tr_b16 v[232:233], v3 offset:34816
    ds_read_b64_tr_b16 v[234:235], v3 offset:35328
    v_cvt_pk_bf16_f32 v201, v194, v195
    v_cvt_pk_bf16_f32 v202, v196, v197
    v_mfma_f32_32x32x16_bf16 v[144:159], v[244:247], v[72:75], v[144:159]
    ds_read_b64_tr_b16 v[236:237], v4 offset:34816
    ds_read_b64_tr_b16 v[238:239], v4 offset:35328
    v_cvt_pk_bf16_f32 v203, v198, v199
    buffer_store_dwordx4 v[200:203], v0, s[52:55], s66 offen offset:0 sc1
    s_waitcnt lgkmcnt(8)
    v_mfma_f32_32x32x16_bf16 v[128:143], v[248:251], v[76:79], v[128:143]
    ds_read_b64_tr_b16 v[240:241], v3 offset:36864
    ds_read_b64_tr_b16 v[242:243], v3 offset:37376
    v_mul_f32 v208, s75, v208
    v_mfma_f32_32x32x16_bf16 v[144:159], v[252:255], v[76:79], v[144:159]
    ds_read_b64_tr_b16 v[244:245], v4 offset:36864
    ds_read_b64_tr_b16 v[246:247], v4 offset:37376
    v_mul_f32 v209, s75, v209
    v_mul_f32 v210, s75, v210
    s_waitcnt lgkmcnt(8)
    v_mfma_f32_32x32x16_bf16 v[128:143], v[224:227], v[80:83], v[128:143]
    ds_read_b64_tr_b16 v[248:249], v3 offset:38912
    ds_read_b64_tr_b16 v[250:251], v3 offset:39424
    v_mul_f32 v211, s75, v211
    v_mul_f32 v212, s75, v212
    v_mfma_f32_32x32x16_bf16 v[144:159], v[228:231], v[80:83], v[144:159]
    ds_read_b64_tr_b16 v[252:253], v4 offset:38912
    ds_read_b64_tr_b16 v[254:255], v4 offset:39424
    v_mul_f32 v213, s75, v213
    s_waitcnt lgkmcnt(8)
    v_mfma_f32_32x32x16_bf16 v[128:143], v[232:235], v[84:87], v[128:143]
    ds_read_b64_tr_b16 v[224:225], v3 offset:49152
    ds_read_b64_tr_b16 v[226:227], v3 offset:49664
    v_mul_f32 v214, s75, v214
    v_mul_f32 v215, s75, v215
    v_mfma_f32_32x32x16_bf16 v[144:159], v[236:239], v[84:87], v[144:159]
    ds_read_b64_tr_b16 v[228:229], v4 offset:49152
    ds_read_b64_tr_b16 v[230:231], v4 offset:49664
    v_exp_f32 v208, v208
    v_exp_f32 v209, v209
    s_waitcnt lgkmcnt(8)
    v_mfma_f32_32x32x16_bf16 v[128:143], v[240:243], v[88:91], v[128:143]
    ds_read_b64_tr_b16 v[232:233], v3 offset:51200
    ds_read_b64_tr_b16 v[234:235], v3 offset:51712
    v_exp_f32 v210, v210
    v_exp_f32 v211, v211
    v_mfma_f32_32x32x16_bf16 v[144:159], v[244:247], v[88:91], v[144:159]
    ds_read_b64_tr_b16 v[236:237], v4 offset:51200
    ds_read_b64_tr_b16 v[238:239], v4 offset:51712
    v_exp_f32 v212, v212
    s_waitcnt lgkmcnt(8)
    v_mfma_f32_32x32x16_bf16 v[128:143], v[248:251], v[92:95], v[128:143]
    ds_read_b64_tr_b16 v[240:241], v3 offset:53248
    ds_read_b64_tr_b16 v[242:243], v3 offset:53760
    v_exp_f32 v213, v213
    v_exp_f32 v214, v214
    v_mfma_f32_32x32x16_bf16 v[144:159], v[252:255], v[92:95], v[144:159]
    ds_read_b64_tr_b16 v[244:245], v4 offset:53248
    ds_read_b64_tr_b16 v[246:247], v4 offset:53760
    v_exp_f32 v215, v215
    v_add_f32 v208, 1.0, v208
    s_waitcnt lgkmcnt(8)
    v_mfma_f32_32x32x16_bf16 v[128:143], v[224:227], v[96:99], v[128:143]
    ds_read_b64_tr_b16 v[248:249], v3 offset:55296
    ds_read_b64_tr_b16 v[250:251], v3 offset:55808
    v_add_f32 v209, 1.0, v209
    v_add_f32 v210, 1.0, v210
    v_mfma_f32_32x32x16_bf16 v[144:159], v[228:231], v[96:99], v[144:159]
    ds_read_b64_tr_b16 v[252:253], v4 offset:55296
    ds_read_b64_tr_b16 v[254:255], v4 offset:55808
    v_add_f32 v211, 1.0, v211
    s_waitcnt lgkmcnt(8)
    v_mfma_f32_32x32x16_bf16 v[128:143], v[232:235], v[100:103], v[128:143]
    v_add_u32 v1, 4294868992, v1
    v_add_u32 v2, 4294868992, v2
    v_add_u32 v3, 4294868992, v3
    v_add_u32 v4, 4294868992, v4
    ds_read_b64_tr_b16 v[224:225], v3 offset:0
    ds_read_b64_tr_b16 v[226:227], v3 offset:512
    v_add_f32 v212, 1.0, v212
    v_add_f32 v213, 1.0, v213
    v_mfma_f32_32x32x16_bf16 v[144:159], v[236:239], v[100:103], v[144:159]
    ds_read_b64_tr_b16 v[228:229], v4 offset:0
    ds_read_b64_tr_b16 v[230:231], v4 offset:512
    v_add_f32 v214, 1.0, v214
    v_add_f32 v215, 1.0, v215
    s_waitcnt lgkmcnt(8)
    v_mfma_f32_32x32x16_bf16 v[128:143], v[240:243], v[104:107], v[128:143]
    ds_read_b64_tr_b16 v[232:233], v3 offset:2048
    ds_read_b64_tr_b16 v[234:235], v3 offset:2560
    v_rcp_f32 v208, v208
    v_mfma_f32_32x32x16_bf16 v[144:159], v[244:247], v[104:107], v[144:159]
    ds_read_b64_tr_b16 v[236:237], v4 offset:2048
    ds_read_b64_tr_b16 v[238:239], v4 offset:2560
    v_rcp_f32 v209, v209
    v_rcp_f32 v210, v210
    s_waitcnt lgkmcnt(8)
    v_mfma_f32_32x32x16_bf16 v[128:143], v[248:251], v[108:111], v[128:143]
    ds_read_b64_tr_b16 v[240:241], v3 offset:4096
    ds_read_b64_tr_b16 v[242:243], v3 offset:4608
    v_rcp_f32 v211, v211
    v_rcp_f32 v212, v212
    v_mfma_f32_32x32x16_bf16 v[144:159], v[252:255], v[108:111], v[144:159]
    ds_read_b64_tr_b16 v[244:245], v4 offset:4096
    ds_read_b64_tr_b16 v[246:247], v4 offset:4608
    v_rcp_f32 v213, v213
    v_rcp_f32 v214, v214
    s_waitcnt lgkmcnt(8)
    v_mfma_f32_32x32x16_bf16 v[128:143], v[224:227], v[112:115], v[128:143]
    ds_read_b64_tr_b16 v[248:249], v3 offset:6144
    ds_read_b64_tr_b16 v[250:251], v3 offset:6656
    v_rcp_f32 v215, v215
    v_mfma_f32_32x32x16_bf16 v[144:159], v[228:231], v[112:115], v[144:159]
    ds_read_b64_tr_b16 v[252:253], v4 offset:6144
    ds_read_b64_tr_b16 v[254:255], v4 offset:6656
    v_mul_f32 v208, v208, v216
    v_mul_f32 v209, v209, v217
    s_waitcnt lgkmcnt(8)
    v_mfma_f32_32x32x16_bf16 v[128:143], v[232:235], v[116:119], v[128:143]
    v_mul_f32 v210, v210, v218
    v_mul_f32 v211, v211, v219
    v_mfma_f32_32x32x16_bf16 v[144:159], v[236:239], v[116:119], v[144:159]
    v_mul_f32 v212, v212, v220
    v_mul_f32 v213, v213, v221
    s_waitcnt lgkmcnt(4)
    v_mfma_f32_32x32x16_bf16 v[128:143], v[240:243], v[120:123], v[128:143]
    v_mul_f32 v214, v214, v222
    v_mfma_f32_32x32x16_bf16 v[144:159], v[244:247], v[120:123], v[144:159]
    v_mul_f32 v215, v215, v223
    v_cvt_pk_bf16_f32 v216, v208, v209
    s_waitcnt lgkmcnt(0)
    v_mfma_f32_32x32x16_bf16 v[128:143], v[248:251], v[124:127], v[128:143]
    v_cvt_pk_bf16_f32 v217, v210, v211
    v_cvt_pk_bf16_f32 v218, v212, v213
    v_mfma_f32_32x32x16_bf16 v[144:159], v[252:255], v[124:127], v[144:159]
    v_cvt_pk_bf16_f32 v219, v214, v215
    buffer_store_dwordx4 v[216:219], v0, s[52:55], s66 offen offset:1024 sc1
    s_nop 6
    v_mul_f32 v128, s75, v128
    v_mul_f32 v129, s75, v129
    v_mul_f32 v130, s75, v130
    v_mul_f32 v131, s75, v131
    v_mul_f32 v132, s75, v132
    v_mul_f32 v133, s75, v133
    v_mul_f32 v134, s75, v134
    v_mul_f32 v135, s75, v135
    v_exp_f32 v128, v128
    v_exp_f32 v129, v129
    v_exp_f32 v130, v130
    v_exp_f32 v131, v131
    v_exp_f32 v132, v132
    v_exp_f32 v133, v133
    v_exp_f32 v134, v134
    v_exp_f32 v135, v135
    v_add_f32 v128, 1.0, v128
    v_add_f32 v129, 1.0, v129
    v_add_f32 v130, 1.0, v130
    v_add_f32 v131, 1.0, v131
    v_add_f32 v132, 1.0, v132
    v_add_f32 v133, 1.0, v133
    v_add_f32 v134, 1.0, v134
    v_add_f32 v135, 1.0, v135
    v_rcp_f32 v128, v128
    v_rcp_f32 v129, v129
    v_rcp_f32 v130, v130
    v_rcp_f32 v131, v131
    v_rcp_f32 v132, v132
    v_rcp_f32 v133, v133
    v_rcp_f32 v134, v134
    v_rcp_f32 v135, v135
    v_mul_f32 v128, v128, v136
    v_mul_f32 v129, v129, v137
    v_mul_f32 v130, v130, v138
    v_mul_f32 v131, v131, v139
    v_mul_f32 v132, v132, v140
    v_mul_f32 v133, v133, v141
    v_mul_f32 v134, v134, v142
    v_mul_f32 v135, v135, v143
    v_cvt_pk_bf16_f32 v136, v128, v129
    v_cvt_pk_bf16_f32 v137, v130, v131
    v_cvt_pk_bf16_f32 v138, v132, v133
    v_cvt_pk_bf16_f32 v139, v134, v135
    buffer_store_dwordx4 v[136:139], v0, s[52:55], s66 offen offset:2048 sc1
    v_mul_f32 v144, s75, v144
    v_mul_f32 v145, s75, v145
    v_mul_f32 v146, s75, v146
    v_mul_f32 v147, s75, v147
    v_mul_f32 v148, s75, v148
    v_mul_f32 v149, s75, v149
    v_mul_f32 v150, s75, v150
    v_mul_f32 v151, s75, v151
    v_exp_f32 v144, v144
    v_exp_f32 v145, v145
    v_exp_f32 v146, v146
    v_exp_f32 v147, v147
    v_exp_f32 v148, v148
    v_exp_f32 v149, v149
    v_exp_f32 v150, v150
    v_exp_f32 v151, v151
    v_add_f32 v144, 1.0, v144
    v_add_f32 v145, 1.0, v145
    v_add_f32 v146, 1.0, v146
    v_add_f32 v147, 1.0, v147
    v_add_f32 v148, 1.0, v148
    v_add_f32 v149, 1.0, v149
    v_add_f32 v150, 1.0, v150
    v_add_f32 v151, 1.0, v151
    v_rcp_f32 v144, v144
    v_rcp_f32 v145, v145
    v_rcp_f32 v146, v146
    v_rcp_f32 v147, v147
    v_rcp_f32 v148, v148
    v_rcp_f32 v149, v149
    v_rcp_f32 v150, v150
    v_rcp_f32 v151, v151
    v_mul_f32 v144, v144, v152
    v_mul_f32 v145, v145, v153
    v_mul_f32 v146, v146, v154
    v_mul_f32 v147, v147, v155
    v_mul_f32 v148, v148, v156
    v_mul_f32 v149, v149, v157
    v_mul_f32 v150, v150, v158
    v_mul_f32 v151, v151, v159
    v_cvt_pk_bf16_f32 v152, v144, v145
    v_cvt_pk_bf16_f32 v153, v146, v147
    v_cvt_pk_bf16_f32 v154, v148, v149
    v_cvt_pk_bf16_f32 v155, v150, v151
    buffer_store_dwordx4 v[152:155], v0, s[52:55], s66 offen offset:3072 sc1
    s_branch K1_CDONE
K1_CDONE:
    s_nop 2
    s_mov_b32 s44, s16
    s_mov_b32 s45, s17
    s_mov_b32 s46, 401408
    s_mov_b32 s47, 0x20000
    s_mov_b32 s36, s26
    s_mov_b32 s37, s27
    s_mov_b32 s38, 1835008
    s_mov_b32 s39, 0x20000
    s_and_b32 s4, s61, 7
    s_cmp_lt_u32 s61, 8
    s_cselect_b32 s5, 3, 7
    s_cmp_gt_u32 s4, s5
    s_subb_u32 s65, s4, 0
    s_cmp_eq_u32 s4, s5
    s_cselect_b32 s64, 1, 0
    s_lshl_b32 s69, s60, 13
    s_add_u32 s69, s69, 21037056
    s_lshl_b32 s5, s61, 9
    s_add_u32 s7, s69, s5
    s_lshl_b32 s5, s62, 7
    s_add_u32 s7, s7, s5
    s_lshr_b32 s3, s61, 3
    s_lshl_b32 s71, s63, 10
    s_lshl_b32 s63, s60, 1
    s_add_u32 s63, s63, s3
    s_lshl_b32 s3, s3, 8
    s_add_u32 s69, s69, s3
    v_mov_b32 v1, v0
    v_lshrrev_b32 v0, 4, v0
    s_lshl_b32 s5, s62, 6
    v_add_u32 v15, s5, v0
    s_mul_i32 s20, s63, 294912
    s_add_u32 s20, s20, 4194304
    s_lshl_b32 s5, s62, 13
    s_add_u32 s66, s20, s5
    s_add_u32 s66, s66, 114688
    s_add_u32 s67, s66, 147456
    s_mul_i32 s5, s62, 28672
    s_add_u32 s20, s20, s5
    s_add_u32 s21, s20, 147456
    s_lshl_b32 s5, s65, 7
    s_mul_i32 s68, s62, 100352
    s_add_u32 s68, s68, s5
    s_mul_i32 s5, s62, 7
    v_lshrrev_b32 v3, 1, v0
    v_min_u32 v3, 6, v3
    v_add_u32 v3, s5, v3
    v_lshrrev_b32 v4, 1, v3
    v_add_u32 v4, 4, v4
    v_subrev_u32 v5, 24, v3
    v_cmp_gt_u32 vcc, 24, v3
    s_nop 1
    v_cndmask_b32 v3, v5, v4, vcc
    v_and_b32 v4, 1, v0
    v_lshlrev_b32 v4, 7, v4
    v_lshl_add_u32 v3, v3, 9, v4
    s_lshl_b32 s5, s61, 9
    s_sub_u32 s5, s5, s3
    v_and_b32 v4, 3, v0
    v_lshl_add_u32 v4, v4, 7, s5
    v_cmp_lt_u32 vcc, 15, v0
    s_nop 1
    v_cndmask_b32 v3, v3, v4, vcc
    v_add_u32 v3, s69, v3
    s_mov_b32 s69, 0
    v_lshrrev_b32 v4, 3, v0
    v_and_b32 v5, 7, v0
    v_mul_u32_u24 v7, 896, v4
    v_lshl_add_u32 v7, v5, 4, v7
    v_add_u32 v8, 7168, v7
    s_mov_b32 s5, 67310093
    v_lshlrev_b32 v5, 3, v4
    v_lshrrev_b32 v5, v5, s5
    v_and_b32 v5, 31, v5
    v_cmp_lt_u32 vcc, 3, v4
    s_nop 1
    v_cndmask_b32 v5, 0, v5, vcc
    v_sub_u32 v5, 24, v5
    v_mul_u32_u24 v5, 896, v5
    v_add_u32 v9, v7, v5
    v_lshrrev_b32 v4, 5, v0
    v_bfe_u32 v10, v0, 2, 2
    v_lshl_add_u32 v10, v4, 2, v10
    v_lshlrev_b32 v10, 7, v10
    v_bfe_u32 v4, v0, 4, 1
    v_lshl_add_u32 v10, v4, 5, v10
    v_and_b32 v4, 3, v0
    v_lshl_add_u32 v10, v4, 3, v10
    v_add_u32 v10, s74, v10
    v_add_u32 v241, 98304, v10
    v_add_u32 v242, s20, v1
    v_add_u32 v243, s21, v1
    s_mov_b32 s20, s71
    s_waitcnt vmcnt(0)
    v_readfirstlane_b32 s4, v14
    s_nop 0
    s_cmp_lg_u32 s4, 0
    s_cbranch_scc1 NC7E
    s_mov_b32 s5, 400000
NC7:
    buffer_load_dword v14, off, s[80:83], 0 sc1
    s_waitcnt vmcnt(0)
    v_readfirstlane_b32 s4, v14
    s_nop 0
    s_cmp_lg_u32 s4, 0
    s_cbranch_scc1 NC7E
    s_sub_u32 s5, s5, 1
    s_cmp_lg_u32 s5, 0
    s_cbranch_scc1 NC7
NC7E:
    s_mov_b64 exec, 1
    buffer_store_dword v14, off, s[52:55], s7 sc1
    s_mov_b64 exec, -1
    s_setprio 0
    s_cmp_eq_u32 s64, 1
    s_cbranch_scc1 F_CEND
    v_lshrrev_b32 v2, 3, v15
    v_and_b32 v245, 7, v15
    v_mul_u32_u24 v244, 896, v2
    v_lshl_add_u32 v244, v245, 4, v244
    s_mul_i32 s23, s63, 57344
    s_lshl_b32 s5, s65, 7
    s_add_u32 s23, s23, s5
    s_add_u32 s24, s23, 28672
    buffer_load_dwordx4 v[248:251], v244, s[32:35], s23 offen
    buffer_load_dwordx4 v[252:255], v244, s[32:35], s24 offen
    s_mov_b32 s4, 400000
    s_branch PL8F
PL8:
    s_sleep 4
PL8F:
    s_bfm_b64 exec, 20, 0
    buffer_load_dword v6, v3, s[52:55], s69 offen sc1
    s_waitcnt vmcnt(0)
PL8C:
    v_xor_b32 v6, v6, v14
    v_cmp_ne_u32 vcc, 0, v6
    s_sub_u32 s4, s4, 1
    s_cmp_eq_u64 vcc, 0
    s_cbranch_scc1 PL8E
    s_cmp_lg_u32 s4, 0
    s_cbranch_scc1 PL8
PL8E:
    s_mov_b64 exec, -1
    buffer_load_dwordx4 v[160:163], v242, s[52:55], s20 offen sc1
    s_add_u32 s5, s20, 1024
    buffer_load_dwordx4 v[164:167], v243, s[52:55], s20 offen sc1
    s_cmp_eq_u32 s5, 28672
    s_cselect_b32 s20, 0, s5
    buffer_load_dwordx4 v[168:171], v242, s[52:55], s20 offen sc1
    s_add_u32 s5, s20, 1024
    buffer_load_dwordx4 v[172:175], v243, s[52:55], s20 offen sc1
    s_cmp_eq_u32 s5, 28672
    s_cselect_b32 s20, 0, s5
    buffer_load_dwordx4 v[176:179], v242, s[52:55], s20 offen sc1
    s_add_u32 s5, s20, 1024
    buffer_load_dwordx4 v[180:183], v243, s[52:55], s20 offen sc1
    s_cmp_eq_u32 s5, 28672
    s_cselect_b32 s20, 0, s5
    ds_read_b64_tr_b16 v[144:145], v10 offset:0
    ds_read_b64_tr_b16 v[146:147], v10 offset:1024
    ds_read_b64_tr_b16 v[148:149], v10 offset:64
    ds_read_b64_tr_b16 v[150:151], v10 offset:1088
    s_waitcnt vmcnt(4)
    s_waitcnt lgkmcnt(0)
    v_mfma_f32_32x32x16_bf16 v[16:31], v[144:147], v[160:163], 0
    v_mfma_f32_32x32x16_bf16 v[48:63], v[144:147], v[164:167], 0
    v_mfma_f32_32x32x16_bf16 v[32:47], v[148:151], v[160:163], 0
    v_mfma_f32_32x32x16_bf16 v[64:79], v[148:151], v[164:167], 0
    ds_read_b64_tr_b16 v[152:153], v10 offset:2048
    ds_read_b64_tr_b16 v[154:155], v10 offset:3072
    ds_read_b64_tr_b16 v[156:157], v10 offset:2112
    ds_read_b64_tr_b16 v[158:159], v10 offset:3136
    buffer_load_dwordx4 v[160:163], v242, s[52:55], s20 offen sc1
    s_add_u32 s5, s20, 1024
    buffer_load_dwordx4 v[164:167], v243, s[52:55], s20 offen sc1
    s_cmp_eq_u32 s5, 28672
    s_cselect_b32 s20, 0, s5
    s_add_u32 m0, s74, 98304
    s_add_u32 s72, s73, 14336
    buffer_load_dwordx4 v12, s[40:43], s73 offen lds
    s_add_u32 m0, s74, 99328
    s_cmp_eq_u32 s72, 401408
    buffer_load_dwordx4 v13, s[40:43], s73 offen lds
    s_cselect_b32 s73, 0, s72
    s_add_u32 m0, s74, 100352
    s_add_u32 s72, s73, 14336
    buffer_load_dwordx4 v12, s[40:43], s73 offen lds
    s_add_u32 m0, s74, 101376
    s_cmp_eq_u32 s72, 401408
    buffer_load_dwordx4 v13, s[40:43], s73 offen lds
    s_cselect_b32 s73, 0, s72
    s_waitcnt vmcnt(8)
    s_waitcnt lgkmcnt(0)
    v_mfma_f32_32x32x16_bf16 v[16:31], v[152:155], v[168:171], v[16:31]
    v_mfma_f32_32x32x16_bf16 v[48:63], v[152:155], v[172:175], v[48:63]
    v_mfma_f32_32x32x16_bf16 v[32:47], v[156:159], v[168:171], v[32:47]
    v_mfma_f32_32x32x16_bf16 v[64:79], v[156:159], v[172:175], v[64:79]
    ds_read_b64_tr_b16 v[144:145], v10 offset:4096
    ds_read_b64_tr_b16 v[146:147], v10 offset:5120
    ds_read_b64_tr_b16 v[148:149], v10 offset:4160
    ds_read_b64_tr_b16 v[150:151], v10 offset:5184
    buffer_load_dwordx4 v[168:171], v242, s[52:55], s20 offen sc1
    s_add_u32 s5, s20, 1024
    buffer_load_dwordx4 v[172:175], v243, s[52:55], s20 offen sc1
    s_cmp_eq_u32 s5, 28672
    s_cselect_b32 s20, 0, s5
    s_add_u32 m0, s74, 102400
    s_add_u32 s72, s73, 14336
    buffer_load_dwordx4 v12, s[40:43], s73 offen lds
    s_add_u32 m0, s74, 103424
    s_cmp_eq_u32 s72, 401408
    buffer_load_dwordx4 v13, s[40:43], s73 offen lds
    s_cselect_b32 s73, 0, s72
    s_add_u32 m0, s74, 104448
    s_add_u32 s72, s73, 14336
    buffer_load_dwordx4 v12, s[40:43], s73 offen lds
    s_add_u32 m0, s74, 105472
    s_cmp_eq_u32 s72, 401408
    buffer_load_dwordx4 v13, s[40:43], s73 offen lds
    s_cselect_b32 s73, 0, s72
    s_waitcnt vmcnt(12)
    s_waitcnt lgkmcnt(0)
    v_mfma_f32_32x32x16_bf16 v[16:31], v[144:147], v[176:179], v[16:31]
    v_mfma_f32_32x32x16_bf16 v[48:63], v[144:147], v[180:183], v[48:63]
    v_mfma_f32_32x32x16_bf16 v[32:47], v[148:151], v[176:179], v[32:47]
    v_mfma_f32_32x32x16_bf16 v[64:79], v[148:151], v[180:183], v[64:79]
    ds_read_b64_tr_b16 v[152:153], v10 offset:6144
    ds_read_b64_tr_b16 v[154:155], v10 offset:7168
    ds_read_b64_tr_b16 v[156:157], v10 offset:6208
    ds_read_b64_tr_b16 v[158:159], v10 offset:7232
    buffer_load_dwordx4 v[176:179], v242, s[52:55], s20 offen sc1
    s_add_u32 s5, s20, 1024
    buffer_load_dwordx4 v[180:183], v243, s[52:55], s20 offen sc1
    s_cmp_eq_u32 s5, 28672
    s_cselect_b32 s20, 0, s5
    s_add_u32 m0, s74, 106496
    s_add_u32 s72, s73, 14336
    buffer_load_dwordx4 v12, s[40:43], s73 offen lds
    s_add_u32 m0, s74, 107520
    s_cmp_eq_u32 s72, 401408
    buffer_load_dwordx4 v13, s[40:43], s73 offen lds
    s_cselect_b32 s73, 0, s72
    s_add_u32 m0, s74, 0
    s_add_u32 s72, s73, 14336
    buffer_load_dwordx4 v12, s[40:43], s73 offen lds
    s_add_u32 m0, s74, 1024
    s_cmp_eq_u32 s72, 401408
    buffer_load_dwordx4 v13, s[40:43], s73 offen lds
    s_cselect_b32 s73, 0, s72
    s_waitcnt vmcnt(16)
    s_waitcnt lgkmcnt(0)
    v_mfma_f32_32x32x16_bf16 v[16:31], v[152:155], v[160:163], v[16:31]
    v_mfma_f32_32x32x16_bf16 v[48:63], v[152:155], v[164:167], v[48:63]
    v_mfma_f32_32x32x16_bf16 v[32:47], v[156:159], v[160:163], v[32:47]
    v_mfma_f32_32x32x16_bf16 v[64:79], v[156:159], v[164:167], v[64:79]
    ds_read_b64_tr_b16 v[144:145], v10 offset:8192
    ds_read_b64_tr_b16 v[146:147], v10 offset:9216
    ds_read_b64_tr_b16 v[148:149], v10 offset:8256
    ds_read_b64_tr_b16 v[150:151], v10 offset:9280
    buffer_load_dwordx4 v[160:163], v242, s[52:55], s20 offen sc1
    s_add_u32 s5, s20, 1024
    buffer_load_dwordx4 v[164:167], v243, s[52:55], s20 offen sc1
    s_cmp_eq_u32 s5, 28672
    s_cselect_b32 s20, 0, s5
    s_add_u32 m0, s74, 2048
    s_add_u32 s72, s73, 14336
    buffer_load_dwordx4 v12, s[40:43], s73 offen lds
    s_add_u32 m0, s74, 3072
    s_cmp_eq_u32 s72, 401408
    buffer_load_dwordx4 v13, s[40:43], s73 offen lds
    s_cselect_b32 s73, 0, s72
    s_add_u32 m0, s74, 4096
    s_add_u32 s72, s73, 14336
    buffer_load_dwordx4 v12, s[40:43], s73 offen lds
    s_add_u32 m0, s74, 5120
    s_cmp_eq_u32 s72, 401408
    buffer_load_dwordx4 v13, s[40:43], s73 offen lds
    s_cselect_b32 s73, 0, s72
    s_waitcnt vmcnt(16)
    s_waitcnt lgkmcnt(0)
    v_mfma_f32_32x32x16_bf16 v[16:31], v[144:147], v[168:171], v[16:31]
    v_mfma_f32_32x32x16_bf16 v[48:63], v[144:147], v[172:175], v[48:63]
    v_mfma_f32_32x32x16_bf16 v[32:47], v[148:151], v[168:171], v[32:47]
    v_mfma_f32_32x32x16_bf16 v[64:79], v[148:151], v[172:175], v[64:79]
    ds_read_b64_tr_b16 v[152:153], v10 offset:10240
    ds_read_b64_tr_b16 v[154:155], v10 offset:11264
    ds_read_b64_tr_b16 v[156:157], v10 offset:10304
    ds_read_b64_tr_b16 v[158:159], v10 offset:11328
    buffer_load_dwordx4 v[168:171], v242, s[52:55], s20 offen sc1
    s_add_u32 s5, s20, 1024
    buffer_load_dwordx4 v[172:175], v243, s[52:55], s20 offen sc1
    s_cmp_eq_u32 s5, 28672
    s_cselect_b32 s20, 0, s5
    s_add_u32 m0, s74, 6144
    s_add_u32 s72, s73, 14336
    buffer_load_dwordx4 v12, s[40:43], s73 offen lds
    s_add_u32 m0, s74, 7168
    s_cmp_eq_u32 s72, 401408
    buffer_load_dwordx4 v13, s[40:43], s73 offen lds
    s_cselect_b32 s73, 0, s72
    s_add_u32 m0, s74, 8192
    s_add_u32 s72, s73, 14336
    buffer_load_dwordx4 v12, s[40:43], s73 offen lds
    s_add_u32 m0, s74, 9216
    s_cmp_eq_u32 s72, 401408
    buffer_load_dwordx4 v13, s[40:43], s73 offen lds
    s_cselect_b32 s73, 0, s72
    s_waitcnt vmcnt(16)
    s_waitcnt lgkmcnt(0)
    v_mfma_f32_32x32x16_bf16 v[16:31], v[152:155], v[176:179], v[16:31]
    v_mfma_f32_32x32x16_bf16 v[48:63], v[152:155], v[180:183], v[48:63]
    v_mfma_f32_32x32x16_bf16 v[32:47], v[156:159], v[176:179], v[32:47]
    v_mfma_f32_32x32x16_bf16 v[64:79], v[156:159], v[180:183], v[64:79]
    ds_read_b64_tr_b16 v[144:145], v241 offset:0
    ds_read_b64_tr_b16 v[146:147], v241 offset:1024
    ds_read_b64_tr_b16 v[148:149], v241 offset:64
    ds_read_b64_tr_b16 v[150:151], v241 offset:1088
    buffer_load_dwordx4 v[176:179], v242, s[52:55], s20 offen sc1
    s_add_u32 s5, s20, 1024
    buffer_load_dwordx4 v[180:183], v243, s[52:55], s20 offen sc1
    s_cmp_eq_u32 s5, 28672
    s_cselect_b32 s20, 0, s5
    s_add_u32 m0, s74, 10240
    s_add_u32 s72, s73, 14336
    buffer_load_dwordx4 v12, s[40:43], s73 offen lds
    s_add_u32 m0, s74, 11264
    s_cmp_eq_u32 s72, 401408
    buffer_load_dwordx4 v13, s[40:43], s73 offen lds
    s_cselect_b32 s73, 0, s72
    s_waitcnt vmcnt(14)
    s_waitcnt lgkmcnt(0)
    v_mfma_f32_32x32x16_bf16 v[16:31], v[144:147], v[160:163], v[16:31]
    v_mfma_f32_32x32x16_bf16 v[48:63], v[144:147], v[164:167], v[48:63]
    v_mfma_f32_32x32x16_bf16 v[32:47], v[148:151], v[160:163], v[32:47]
    v_mfma_f32_32x32x16_bf16 v[64:79], v[148:151], v[164:167], v[64:79]
    ds_read_b64_tr_b16 v[152:153], v241 offset:2048
    ds_read_b64_tr_b16 v[154:155], v241 offset:3072
    ds_read_b64_tr_b16 v[156:157], v241 offset:2112
    ds_read_b64_tr_b16 v[158:159], v241 offset:3136
    buffer_load_dwordx4 v[160:163], v242, s[52:55], s20 offen sc1
    s_add_u32 s5, s20, 1024
    buffer_load_dwordx4 v[164:167], v243, s[52:55], s20 offen sc1
    s_cmp_eq_u32 s5, 28672
    s_cselect_b32 s20, 0, s5
    s_add_u32 m0, s74, 98304
    s_add_u32 s72, s73, 14336
    buffer_load_dwordx4 v12, s[40:43], s73 offen lds
    s_add_u32 m0, s74, 99328
    s_cmp_eq_u32 s72, 401408
    buffer_load_dwordx4 v13, s[40:43], s73 offen lds
    s_cselect_b32 s73, 0, s72
    s_waitcnt vmcnt(12)
    s_waitcnt lgkmcnt(0)
    v_mfma_f32_32x32x16_bf16 v[16:31], v[152:155], v[168:171], v[16:31]
    v_mfma_f32_32x32x16_bf16 v[48:63], v[152:155], v[172:175], v[48:63]
    v_mfma_f32_32x32x16_bf16 v[32:47], v[156:159], v[168:171], v[32:47]
    v_mfma_f32_32x32x16_bf16 v[64:79], v[156:159], v[172:175], v[64:79]
    ds_read_b64_tr_b16 v[144:145], v241 offset:4096
    ds_read_b64_tr_b16 v[146:147], v241 offset:5120
    ds_read_b64_tr_b16 v[148:149], v241 offset:4160
    ds_read_b64_tr_b16 v[150:151], v241 offset:5184
    buffer_load_dwordx4 v[168:171], v242, s[52:55], s20 offen sc1
    s_add_u32 s5, s20, 1024
    buffer_load_dwordx4 v[172:175], v243, s[52:55], s20 offen sc1
    s_cmp_eq_u32 s5, 28672
    s_cselect_b32 s20, 0, s5
    s_add_u32 m0, s74, 100352
    s_add_u32 s72, s73, 14336
    buffer_load_dwordx4 v12, s[40:43], s73 offen lds
    s_add_u32 m0, s74, 101376
    s_cmp_eq_u32 s72, 401408
    buffer_load_dwordx4 v13, s[40:43], s73 offen lds
    s_cselect_b32 s73, 0, s72
    s_waitcnt vmcnt(10)
    s_waitcnt lgkmcnt(0)
    v_mfma_f32_32x32x16_bf16 v[16:31], v[144:147], v[176:179], v[16:31]
    v_mfma_f32_32x32x16_bf16 v[48:63], v[144:147], v[180:183], v[48:63]
    v_mfma_f32_32x32x16_bf16 v[32:47], v[148:151], v[176:179], v[32:47]
    v_mfma_f32_32x32x16_bf16 v[64:79], v[148:151], v[180:183], v[64:79]
    ds_read_b64_tr_b16 v[152:153], v241 offset:6144
    ds_read_b64_tr_b16 v[154:155], v241 offset:7168
    ds_read_b64_tr_b16 v[156:157], v241 offset:6208
    ds_read_b64_tr_b16 v[158:159], v241 offset:7232
    buffer_load_dwordx4 v[176:179], v242, s[52:55], s20 offen sc1
    s_add_u32 s5, s20, 1024
    buffer_load_dwordx4 v[180:183], v243, s[52:55], s20 offen sc1
    s_cmp_eq_u32 s5, 28672
    s_cselect_b32 s20, 0, s5
    s_add_u32 m0, s74, 102400
    s_add_u32 s72, s73, 14336
    buffer_load_dwordx4 v12, s[40:43], s73 offen lds
    s_add_u32 m0, s74, 103424
    s_cmp_eq_u32 s72, 401408
    buffer_load_dwordx4 v13, s[40:43], s73 offen lds
    s_cselect_b32 s73, 0, s72
    s_waitcnt vmcnt(10)
    s_waitcnt lgkmcnt(0)
    v_mfma_f32_32x32x16_bf16 v[16:31], v[152:155], v[160:163], v[16:31]
    v_mfma_f32_32x32x16_bf16 v[48:63], v[152:155], v[164:167], v[48:63]
    v_mfma_f32_32x32x16_bf16 v[32:47], v[156:159], v[160:163], v[32:47]
    v_mfma_f32_32x32x16_bf16 v[64:79], v[156:159], v[164:167], v[64:79]
    ds_read_b64_tr_b16 v[144:145], v241 offset:8192
    ds_read_b64_tr_b16 v[146:147], v241 offset:9216
    ds_read_b64_tr_b16 v[148:149], v241 offset:8256
    ds_read_b64_tr_b16 v[150:151], v241 offset:9280
    buffer_load_dwordx4 v[160:163], v242, s[52:55], s20 offen sc1
    s_add_u32 s5, s20, 1024
    buffer_load_dwordx4 v[164:167], v243, s[52:55], s20 offen sc1
    s_cmp_eq_u32 s5, 28672
    s_cselect_b32 s20, 0, s5
    s_add_u32 m0, s74, 104448
    s_add_u32 s72, s73, 14336
    buffer_load_dwordx4 v12, s[40:43], s73 offen lds
    s_add_u32 m0, s74, 105472
    s_cmp_eq_u32 s72, 401408
    buffer_load_dwordx4 v13, s[40:43], s73 offen lds
    s_cselect_b32 s73, 0, s72
    s_waitcnt vmcnt(10)
    s_waitcnt lgkmcnt(0)
    v_mfma_f32_32x32x16_bf16 v[16:31], v[144:147], v[168:171], v[16:31]
    v_mfma_f32_32x32x16_bf16 v[48:63], v[144:147], v[172:175], v[48:63]
    v_mfma_f32_32x32x16_bf16 v[32:47], v[148:151], v[168:171], v[32:47]
    v_mfma_f32_32x32x16_bf16 v[64:79], v[148:151], v[172:175], v[64:79]
    ds_read_b64_tr_b16 v[152:153], v10 offset:0
    ds_read_b64_tr_b16 v[154:155], v10 offset:1024
    ds_read_b64_tr_b16 v[156:157], v10 offset:64
    ds_read_b64_tr_b16 v[158:159], v10 offset:1088
    buffer_load_dwordx4 v[168:171], v242, s[52:55], s20 offen sc1
    s_add_u32 s5, s20, 1024
    buffer_load_dwordx4 v[172:175], v243, s[52:55], s20 offen sc1
    s_cmp_eq_u32 s5, 28672
    s_cselect_b32 s20, 0, s5
    s_add_u32 m0, s74, 106496
    s_add_u32 s72, s73, 14336
    buffer_load_dwordx4 v12, s[40:43], s73 offen lds
    s_add_u32 m0, s74, 107520
    s_cmp_eq_u32 s72, 401408
    buffer_load_dwordx4 v13, s[40:43], s73 offen lds
    s_cselect_b32 s73, 0, s72
    s_waitcnt vmcnt(10)
    s_waitcnt lgkmcnt(0)
    v_mfma_f32_32x32x16_bf16 v[16:31], v[152:155], v[176:179], v[16:31]
    v_mfma_f32_32x32x16_bf16 v[48:63], v[152:155], v[180:183], v[48:63]
    v_mfma_f32_32x32x16_bf16 v[32:47], v[156:159], v[176:179], v[32:47]
    v_mfma_f32_32x32x16_bf16 v[64:79], v[156:159], v[180:183], v[64:79]
    ds_read_b64_tr_b16 v[144:145], v10 offset:2048
    ds_read_b64_tr_b16 v[146:147], v10 offset:3072
    ds_read_b64_tr_b16 v[148:149], v10 offset:2112
    ds_read_b64_tr_b16 v[150:151], v10 offset:3136
    buffer_load_dwordx4 v[176:179], v242, s[52:55], s20 offen sc1
    s_add_u32 s5, s20, 1024
    buffer_load_dwordx4 v[180:183], v243, s[52:55], s20 offen sc1
    s_cmp_eq_u32 s5, 28672
    s_cselect_b32 s20, 0, s5
    s_add_u32 m0, s74, 0
    s_add_u32 s72, s73, 14336
    buffer_load_dwordx4 v12, s[40:43], s73 offen lds
    s_add_u32 m0, s74, 1024
    s_cmp_eq_u32 s72, 401408
    buffer_load_dwordx4 v13, s[40:43], s73 offen lds
    s_cselect_b32 s73, 0, s72
    s_waitcnt vmcnt(10)
    s_waitcnt lgkmcnt(0)
    v_mfma_f32_32x32x16_bf16 v[16:31], v[144:147], v[160:163], v[16:31]
    v_mfma_f32_32x32x16_bf16 v[48:63], v[144:147], v[164:167], v[48:63]
    v_mfma_f32_32x32x16_bf16 v[32:47], v[148:151], v[160:163], v[32:47]
    v_mfma_f32_32x32x16_bf16 v[64:79], v[148:151], v[164:167], v[64:79]
    ds_read_b64_tr_b16 v[152:153], v10 offset:4096
    ds_read_b64_tr_b16 v[154:155], v10 offset:5120
    ds_read_b64_tr_b16 v[156:157], v10 offset:4160
    ds_read_b64_tr_b16 v[158:159], v10 offset:5184
    buffer_load_dwordx4 v[160:163], v242, s[52:55], s20 offen sc1
    s_add_u32 s5, s20, 1024
    buffer_load_dwordx4 v[164:167], v243, s[52:55], s20 offen sc1
    s_cmp_eq_u32 s5, 28672
    s_cselect_b32 s20, 0, s5
    s_add_u32 m0, s74, 2048
    s_add_u32 s72, s73, 14336
    buffer_load_dwordx4 v12, s[40:43], s73 offen lds
    s_add_u32 m0, s74, 3072
    s_cmp_eq_u32 s72, 401408
    buffer_load_dwordx4 v13, s[40:43], s73 offen lds
    s_cselect_b32 s73, 0, s72
    s_waitcnt vmcnt(10)
    s_waitcnt lgkmcnt(0)
    v_mfma_f32_32x32x16_bf16 v[16:31], v[152:155], v[168:171], v[16:31]
    v_mfma_f32_32x32x16_bf16 v[48:63], v[152:155], v[172:175], v[48:63]
    v_mfma_f32_32x32x16_bf16 v[32:47], v[156:159], v[168:171], v[32:47]
    v_mfma_f32_32x32x16_bf16 v[64:79], v[156:159], v[172:175], v[64:79]
    ds_read_b64_tr_b16 v[144:145], v10 offset:6144
    ds_read_b64_tr_b16 v[146:147], v10 offset:7168
    ds_read_b64_tr_b16 v[148:149], v10 offset:6208
    ds_read_b64_tr_b16 v[150:151], v10 offset:7232
    buffer_load_dwordx4 v[168:171], v242, s[52:55], s20 offen sc1
    s_add_u32 s5, s20, 1024
    buffer_load_dwordx4 v[172:175], v243, s[52:55], s20 offen sc1
    s_cmp_eq_u32 s5, 28672
    s_cselect_b32 s20, 0, s5
    s_add_u32 m0, s74, 4096
    s_add_u32 s72, s73, 14336
    buffer_load_dwordx4 v12, s[40:43], s73 offen lds
    s_add_u32 m0, s74, 5120
    s_cmp_eq_u32 s72, 401408
    buffer_load_dwordx4 v13, s[40:43], s73 offen lds
    s_cselect_b32 s73, 0, s72
    s_waitcnt vmcnt(10)
    s_waitcnt lgkmcnt(0)
    v_mfma_f32_32x32x16_bf16 v[16:31], v[144:147], v[176:179], v[16:31]
    v_mfma_f32_32x32x16_bf16 v[48:63], v[144:147], v[180:183], v[48:63]
    v_mfma_f32_32x32x16_bf16 v[32:47], v[148:151], v[176:179], v[32:47]
    v_mfma_f32_32x32x16_bf16 v[64:79], v[148:151], v[180:183], v[64:79]
    ds_read_b64_tr_b16 v[152:153], v10 offset:8192
    ds_read_b64_tr_b16 v[154:155], v10 offset:9216
    ds_read_b64_tr_b16 v[156:157], v10 offset:8256
    ds_read_b64_tr_b16 v[158:159], v10 offset:9280
    buffer_load_dwordx4 v[176:179], v242, s[52:55], s20 offen sc1
    s_add_u32 s5, s20, 1024
    buffer_load_dwordx4 v[180:183], v243, s[52:55], s20 offen sc1
    s_cmp_eq_u32 s5, 28672
    s_cselect_b32 s20, 0, s5
    s_add_u32 m0, s74, 6144
    s_add_u32 s72, s73, 14336
    buffer_load_dwordx4 v12, s[40:43], s73 offen lds
    s_add_u32 m0, s74, 7168
    s_cmp_eq_u32 s72, 401408
    buffer_load_dwordx4 v13, s[40:43], s73 offen lds
    s_cselect_b32 s73, 0, s72
    s_waitcnt vmcnt(10)
    s_waitcnt lgkmcnt(0)
    v_mfma_f32_32x32x16_bf16 v[16:31], v[152:155], v[160:163], v[16:31]
    v_mfma_f32_32x32x16_bf16 v[48:63], v[152:155], v[164:167], v[48:63]
    v_mfma_f32_32x32x16_bf16 v[32:47], v[156:159], v[160:163], v[32:47]
    v_mfma_f32_32x32x16_bf16 v[64:79], v[156:159], v[164:167], v[64:79]
    ds_read_b64_tr_b16 v[144:145], v10 offset:10240
    ds_read_b64_tr_b16 v[146:147], v10 offset:11264
    ds_read_b64_tr_b16 v[148:149], v10 offset:10304
    ds_read_b64_tr_b16 v[150:151], v10 offset:11328
    buffer_load_dwordx4 v[160:163], v242, s[52:55], s20 offen sc1
    s_add_u32 s5, s20, 1024
    buffer_load_dwordx4 v[164:167], v243, s[52:55], s20 offen sc1
    s_cmp_eq_u32 s5, 28672
    s_cselect_b32 s20, 0, s5
    s_add_u32 m0, s74, 8192
    s_add_u32 s72, s73, 14336
    buffer_load_dwordx4 v12, s[40:43], s73 offen lds
    s_add_u32 m0, s74, 9216
    s_cmp_eq_u32 s72, 401408
    buffer_load_dwordx4 v13, s[40:43], s73 offen lds
    s_cselect_b32 s73, 0, s72
    s_waitcnt vmcnt(10)
    s_waitcnt lgkmcnt(0)
    v_mfma_f32_32x32x16_bf16 v[16:31], v[144:147], v[168:171], v[16:31]
    v_mfma_f32_32x32x16_bf16 v[48:63], v[144:147], v[172:175], v[48:63]
    v_mfma_f32_32x32x16_bf16 v[32:47], v[148:151], v[168:171], v[32:47]
    v_mfma_f32_32x32x16_bf16 v[64:79], v[148:151], v[172:175], v[64:79]
    ds_read_b64_tr_b16 v[152:153], v241 offset:0
    ds_read_b64_tr_b16 v[154:155], v241 offset:1024
    ds_read_b64_tr_b16 v[156:157], v241 offset:64
    ds_read_b64_tr_b16 v[158:159], v241 offset:1088
    buffer_load_dwordx4 v[168:171], v242, s[52:55], s20 offen sc1
    s_add_u32 s5, s20, 1024
    buffer_load_dwordx4 v[172:175], v243, s[52:55], s20 offen sc1
    s_cmp_eq_u32 s5, 28672
    s_cselect_b32 s20, 0, s5
    s_add_u32 m0, s74, 10240
    s_add_u32 s72, s73, 14336
    buffer_load_dwordx4 v12, s[40:43], s73 offen lds
    s_add_u32 m0, s74, 11264
    s_cmp_eq_u32 s72, 401408
    buffer_load_dwordx4 v13, s[40:43], s73 offen lds
    s_cselect_b32 s73, 0, s72
    s_waitcnt vmcnt(10)
    s_waitcnt lgkmcnt(0)
    v_mfma_f32_32x32x16_bf16 v[16:31], v[152:155], v[176:179], v[16:31]
    v_mfma_f32_32x32x16_bf16 v[48:63], v[152:155], v[180:183], v[48:63]
    v_mfma_f32_32x32x16_bf16 v[32:47], v[156:159], v[176:179], v[32:47]
    v_mfma_f32_32x32x16_bf16 v[64:79], v[156:159], v[180:183], v[64:79]
    ds_read_b64_tr_b16 v[144:145], v241 offset:2048
    ds_read_b64_tr_b16 v[146:147], v241 offset:3072
    ds_read_b64_tr_b16 v[148:149], v241 offset:2112
    ds_read_b64_tr_b16 v[150:151], v241 offset:3136
    buffer_load_dwordx4 v[176:179], v242, s[52:55], s20 offen sc1
    s_add_u32 s5, s20, 1024
    buffer_load_dwordx4 v[180:183], v243, s[52:55], s20 offen sc1
    s_cmp_eq_u32 s5, 28672
    s_cselect_b32 s20, 0, s5
    s_add_u32 m0, s74, 98304
    s_add_u32 s22, s68, 14336
    buffer_load_dwordx4 v7, s[44:47], s68 offen lds
    s_add_u32 m0, s74, 99328
    s_nop 0
    buffer_load_dwordx4 v8, s[44:47], s68 offen lds
    s_waitcnt vmcnt(10)
    s_waitcnt lgkmcnt(0)
    v_mfma_f32_32x32x16_bf16 v[16:31], v[144:147], v[160:163], v[16:31]
    v_mfma_f32_32x32x16_bf16 v[48:63], v[144:147], v[164:167], v[48:63]
    v_mfma_f32_32x32x16_bf16 v[32:47], v[148:151], v[160:163], v[32:47]
    v_mfma_f32_32x32x16_bf16 v[64:79], v[148:151], v[164:167], v[64:79]
    ds_read_b64_tr_b16 v[152:153], v241 offset:4096
    ds_read_b64_tr_b16 v[154:155], v241 offset:5120
    ds_read_b64_tr_b16 v[156:157], v241 offset:4160
    ds_read_b64_tr_b16 v[158:159], v241 offset:5184
    buffer_load_dwordx4 v[160:163], v242, s[52:55], s20 offen sc1
    s_add_u32 s5, s20, 1024
    buffer_load_dwordx4 v[164:167], v243, s[52:55], s20 offen sc1
    s_cmp_eq_u32 s5, 28672
    s_cselect_b32 s20, 0, s5
    s_add_u32 m0, s74, 100352
    s_nop 0
    buffer_load_dwordx4 v7, s[44:47], s22 offen lds
    s_add_u32 m0, s74, 101376
    s_nop 0
    buffer_load_dwordx4 v9, s[44:47], s68 offen lds
    s_add_u32 s68, s68, 25088
    s_waitcnt vmcnt(10)
    s_waitcnt lgkmcnt(0)
    v_mfma_f32_32x32x16_bf16 v[16:31], v[152:155], v[168:171], v[16:31]
    v_mfma_f32_32x32x16_bf16 v[48:63], v[152:155], v[172:175], v[48:63]
    v_mfma_f32_32x32x16_bf16 v[32:47], v[156:159], v[168:171], v[32:47]
    v_mfma_f32_32x32x16_bf16 v[64:79], v[156:159], v[172:175], v[64:79]
    ds_read_b64_tr_b16 v[144:145], v241 offset:6144
    ds_read_b64_tr_b16 v[146:147], v241 offset:7168
    ds_read_b64_tr_b16 v[148:149], v241 offset:6208
    ds_read_b64_tr_b16 v[150:151], v241 offset:7232
    buffer_load_dwordx4 v[168:171], v242, s[52:55], s20 offen sc1
    s_add_u32 s5, s20, 1024
    buffer_load_dwordx4 v[172:175], v243, s[52:55], s20 offen sc1
    s_cmp_eq_u32 s5, 28672
    s_cselect_b32 s20, 0, s5
    s_add_u32 m0, s74, 102400
    s_add_u32 s22, s68, 14336
    buffer_load_dwordx4 v7, s[44:47], s68 offen lds
    s_add_u32 m0, s74, 103424
    s_nop 0
    buffer_load_dwordx4 v8, s[44:47], s68 offen lds
    s_waitcnt vmcnt(10)
    s_waitcnt lgkmcnt(0)
    v_mfma_f32_32x32x16_bf16 v[16:31], v[144:147], v[176:179], v[16:31]
    v_mfma_f32_32x32x16_bf16 v[48:63], v[144:147], v[180:183], v[48:63]
    v_mfma_f32_32x32x16_bf16 v[32:47], v[148:151], v[176:179], v[32:47]
    v_mfma_f32_32x32x16_bf16 v[64:79], v[148:151], v[180:183], v[64:79]
    ds_read_b64_tr_b16 v[152:153], v241 offset:8192
    ds_read_b64_tr_b16 v[154:155], v241 offset:9216
    ds_read_b64_tr_b16 v[156:157], v241 offset:8256
    ds_read_b64_tr_b16 v[158:159], v241 offset:9280
    buffer_load_dwordx4 v[176:179], v242, s[52:55], s20 offen sc1
    s_add_u32 s5, s20, 1024
    buffer_load_dwordx4 v[180:183], v243, s[52:55], s20 offen sc1
    s_cmp_eq_u32 s5, 28672
    s_cselect_b32 s20, 0, s5
    s_add_u32 m0, s74, 104448
    s_nop 0
    buffer_load_dwordx4 v7, s[44:47], s22 offen lds
    s_add_u32 m0, s74, 105472
    s_nop 0
    buffer_load_dwordx4 v9, s[44:47], s68 offen lds
    s_add_u32 s68, s68, 25088
    s_waitcnt vmcnt(10)
    s_waitcnt lgkmcnt(0)
    v_mfma_f32_32x32x16_bf16 v[16:31], v[152:155], v[160:163], v[16:31]
    v_mfma_f32_32x32x16_bf16 v[48:63], v[152:155], v[164:167], v[48:63]
    v_mfma_f32_32x32x16_bf16 v[32:47], v[156:159], v[160:163], v[32:47]
    v_mfma_f32_32x32x16_bf16 v[64:79], v[156:159], v[164:167], v[64:79]
    ds_read_b64_tr_b16 v[144:145], v10 offset:0
    ds_read_b64_tr_b16 v[146:147], v10 offset:1024
    ds_read_b64_tr_b16 v[148:149], v10 offset:64
    ds_read_b64_tr_b16 v[150:151], v10 offset:1088
    buffer_load_dwordx4 v[160:163], v242, s[52:55], s20 offen sc1
    s_add_u32 s5, s20, 1024
    buffer_load_dwordx4 v[164:167], v243, s[52:55], s20 offen sc1
    s_cmp_eq_u32 s5, 28672
    s_cselect_b32 s20, 0, s5
    s_add_u32 m0, s74, 106496
    s_add_u32 s22, s68, 14336
    buffer_load_dwordx4 v7, s[44:47], s68 offen lds
    s_add_u32 m0, s74, 107520
    s_nop 0
    buffer_load_dwordx4 v8, s[44:47], s68 offen lds
    s_waitcnt vmcnt(10)
    s_waitcnt lgkmcnt(0)
    v_mfma_f32_32x32x16_bf16 v[16:31], v[144:147], v[168:171], v[16:31]
    v_mfma_f32_32x32x16_bf16 v[48:63], v[144:147], v[172:175], v[48:63]
    v_mfma_f32_32x32x16_bf16 v[32:47], v[148:151], v[168:171], v[32:47]
    v_mfma_f32_32x32x16_bf16 v[64:79], v[148:151], v[172:175], v[64:79]
    ds_read_b64_tr_b16 v[152:153], v10 offset:2048
    ds_read_b64_tr_b16 v[154:155], v10 offset:3072
    ds_read_b64_tr_b16 v[156:157], v10 offset:2112
    ds_read_b64_tr_b16 v[158:159], v10 offset:3136
    buffer_load_dwordx4 v[168:171], v242, s[52:55], s20 offen sc1
    s_add_u32 s5, s20, 1024
    buffer_load_dwordx4 v[172:175], v243, s[52:55], s20 offen sc1
    s_cmp_eq_u32 s5, 28672
    s_cselect_b32 s20, 0, s5
    s_add_u32 m0, s74, 0
    s_nop 0
    buffer_load_dwordx4 v7, s[44:47], s22 offen lds
    s_add_u32 m0, s74, 1024
    s_nop 0
    buffer_load_dwordx4 v9, s[44:47], s68 offen lds
    s_add_u32 s68, s68, 25088
    s_waitcnt vmcnt(10)
    s_waitcnt lgkmcnt(0)
    v_mfma_f32_32x32x16_bf16 v[16:31], v[152:155], v[176:179], v[16:31]
    v_mfma_f32_32x32x16_bf16 v[48:63], v[152:155], v[180:183], v[48:63]
    v_mfma_f32_32x32x16_bf16 v[32:47], v[156:159], v[176:179], v[32:47]
    v_mfma_f32_32x32x16_bf16 v[64:79], v[156:159], v[180:183], v[64:79]
    ds_read_b64_tr_b16 v[144:145], v10 offset:4096
    ds_read_b64_tr_b16 v[146:147], v10 offset:5120
    ds_read_b64_tr_b16 v[148:149], v10 offset:4160
    ds_read_b64_tr_b16 v[150:151], v10 offset:5184
    buffer_load_dwordx4 v[176:179], v242, s[52:55], s20 offen sc1
    s_add_u32 s5, s20, 1024
    buffer_load_dwordx4 v[180:183], v243, s[52:55], s20 offen sc1
    s_cmp_eq_u32 s5, 28672
    s_cselect_b32 s20, 0, s5
    s_add_u32 m0, s74, 2048
    s_add_u32 s22, s68, 14336
    buffer_load_dwordx4 v7, s[44:47], s68 offen lds
    s_add_u32 m0, s74, 3072
    s_nop 0
    buffer_load_dwordx4 v8, s[44:47], s68 offen lds
    s_waitcnt vmcnt(10)
    s_waitcnt lgkmcnt(0)
    v_mfma_f32_32x32x16_bf16 v[16:31], v[144:147], v[160:163], v[16:31]
    v_mfma_f32_32x32x16_bf16 v[48:63], v[144:147], v[164:167], v[48:63]
    v_mfma_f32_32x32x16_bf16 v[32:47], v[148:151], v[160:163], v[32:47]
    v_mfma_f32_32x32x16_bf16 v[64:79], v[148:151], v[164:167], v[64:79]
    ds_read_b64_tr_b16 v[152:153], v10 offset:6144
    ds_read_b64_tr_b16 v[154:155], v10 offset:7168
    ds_read_b64_tr_b16 v[156:157], v10 offset:6208
    ds_read_b64_tr_b16 v[158:159], v10 offset:7232
    buffer_load_dwordx4 v[160:163], v242, s[52:55], s20 offen sc1
    s_add_u32 s5, s20, 1024
    buffer_load_dwordx4 v[164:167], v243, s[52:55], s20 offen sc1
    s_cmp_eq_u32 s5, 28672
    s_cselect_b32 s20, 0, s5
    s_add_u32 m0, s74, 4096
    s_nop 0
    buffer_load_dwordx4 v7, s[44:47], s22 offen lds
    s_add_u32 m0, s74, 5120
    s_nop 0
    buffer_load_dwordx4 v9, s[44:47], s68 offen lds
    s_add_u32 s68, s68, 25088
    s_waitcnt vmcnt(10)
    s_waitcnt lgkmcnt(0)
    v_mfma_f32_32x32x16_bf16 v[16:31], v[152:155], v[168:171], v[16:31]
    v_mfma_f32_32x32x16_bf16 v[48:63], v[152:155], v[172:175], v[48:63]
    v_mfma_f32_32x32x16_bf16 v[32:47], v[156:159], v[168:171], v[32:47]
    v_mfma_f32_32x32x16_bf16 v[64:79], v[156:159], v[172:175], v[64:79]
    ds_read_b64_tr_b16 v[144:145], v10 offset:8192
    ds_read_b64_tr_b16 v[146:147], v10 offset:9216
    ds_read_b64_tr_b16 v[148:149], v10 offset:8256
    ds_read_b64_tr_b16 v[150:151], v10 offset:9280
    s_waitcnt vmcnt(6)
    s_waitcnt lgkmcnt(0)
    v_mfma_f32_32x32x16_bf16 v[16:31], v[144:147], v[176:179], v[16:31]
    v_mfma_f32_32x32x16_bf16 v[48:63], v[144:147], v[180:183], v[48:63]
    v_mfma_f32_32x32x16_bf16 v[32:47], v[148:151], v[176:179], v[32:47]
    v_mfma_f32_32x32x16_bf16 v[64:79], v[148:151], v[180:183], v[64:79]
    ds_read_b64_tr_b16 v[152:153], v10 offset:10240
    ds_read_b64_tr_b16 v[154:155], v10 offset:11264
    ds_read_b64_tr_b16 v[156:157], v10 offset:10304
    ds_read_b64_tr_b16 v[158:159], v10 offset:11328
    s_waitcnt vmcnt(2)
    s_waitcnt lgkmcnt(0)
    v_mfma_f32_32x32x16_bf16 v[16:31], v[152:155], v[160:163], v[16:31]
    v_mfma_f32_32x32x16_bf16 v[48:63], v[152:155], v[164:167], v[48:63]
    v_mfma_f32_32x32x16_bf16 v[32:47], v[156:159], v[160:163], v[32:47]
    v_mfma_f32_32x32x16_bf16 v[64:79], v[156:159], v[164:167], v[64:79]
    ds_read_b64_tr_b16 v[80:81], v241 offset:0
    ds_read_b64_tr_b16 v[82:83], v241 offset:1024
    ds_read_b64_tr_b16 v[84:85], v241 offset:64
    ds_read_b64_tr_b16 v[86:87], v241 offset:1088
    s_waitcnt lgkmcnt(0)
    ds_read_b64_tr_b16 v[88:89], v241 offset:2048
    ds_read_b64_tr_b16 v[90:91], v241 offset:3072
    ds_read_b64_tr_b16 v[92:93], v241 offset:2112
    ds_read_b64_tr_b16 v[94:95], v241 offset:3136
    s_waitcnt lgkmcnt(0)
    ds_read_b64_tr_b16 v[96:97], v241 offset:4096
    ds_read_b64_tr_b16 v[98:99], v241 offset:5120
    ds_read_b64_tr_b16 v[100:101], v241 offset:4160
    ds_read_b64_tr_b16 v[102:103], v241 offset:5184
    s_waitcnt lgkmcnt(0)
    ds_read_b64_tr_b16 v[104:105], v241 offset:6144
    ds_read_b64_tr_b16 v[106:107], v241 offset:7168
    ds_read_b64_tr_b16 v[108:109], v241 offset:6208
    ds_read_b64_tr_b16 v[110:111], v241 offset:7232
    s_waitcnt lgkmcnt(0)
    ds_read_b64_tr_b16 v[112:113], v241 offset:8192
    ds_read_b64_tr_b16 v[114:115], v241 offset:9216
    ds_read_b64_tr_b16 v[116:117], v241 offset:8256
    ds_read_b64_tr_b16 v[118:119], v241 offset:9280
    s_waitcnt lgkmcnt(0)
    ds_read_b64_tr_b16 v[120:121], v10 offset:0
    ds_read_b64_tr_b16 v[122:123], v10 offset:1024
    ds_read_b64_tr_b16 v[124:125], v10 offset:64
    ds_read_b64_tr_b16 v[126:127], v10 offset:1088
    s_waitcnt lgkmcnt(0)
    ds_read_b64_tr_b16 v[128:129], v10 offset:2048
    ds_read_b64_tr_b16 v[130:131], v10 offset:3072
    ds_read_b64_tr_b16 v[132:133], v10 offset:2112
    ds_read_b64_tr_b16 v[134:135], v10 offset:3136
    s_waitcnt vmcnt(0)
    s_waitcnt lgkmcnt(0)
    ds_read_b64_tr_b16 v[136:137], v10 offset:4096
    ds_read_b64_tr_b16 v[138:139], v10 offset:5120
    ds_read_b64_tr_b16 v[140:141], v10 offset:4160
    ds_read_b64_tr_b16 v[142:143], v10 offset:5184
    s_waitcnt lgkmcnt(0)
    v_and_b32 v83, 0xffff, v83
    v_and_b32 v87, 0xffff, v87
    v_and_b32 v91, 0xffff, v91
    v_and_b32 v95, 0xffff, v95
    v_and_b32 v99, 0xffff, v99
    v_and_b32 v103, 0xffff, v103
    v_and_b32 v107, 0xffff, v107
    v_and_b32 v111, 0xffff, v111
    v_and_b32 v115, 0xffff, v115
    v_and_b32 v119, 0xffff, v119
    v_and_b32 v123, 0xffff, v123
    v_and_b32 v127, 0xffff, v127
    v_and_b32 v131, 0xffff, v131
    v_and_b32 v135, 0xffff, v135
    v_and_b32 v139, 0xffff, v139
    v_and_b32 v143, 0xffff, v143
    v_and_b32 v10, 31, v0
    v_mul_u32_u24 v10, 272, v10
    v_lshrrev_b32 v11, 5, v0
    v_lshl_add_u32 v10, v11, 4, v10
    v_add_u32 v10, s74, v10
    v_add_u32 v13, 98304, v10
    v_mul_u32_u24 v11, 272, v2
    v_lshl_add_u32 v11, v245, 5, v11
    v_add_u32 v11, 16384, v11
    v_add_u32 v12, 98304, v11
    v_and_b32 v8, 0x1fff, v14
    v_or_b32 v8, 0x2000, v8
    v_lshlrev_b32 v8, 16, v8
    s_add_u32 s69, s66, 4096
    s_add_u32 s70, s67, 4096
    v_and_b32 v9, 3, v0
    v_lshlrev_b32 v9, 11, v9
    v_bfe_u32 v4, v0, 2, 1
    v_mul_u32_u24 v4, 147456, v4
    v_add_u32 v9, v9, v4
    ds_write_b128 v10, v[16:19] offset:0
    ds_write_b128 v10, v[20:23] offset:32
    ds_write_b128 v10, v[24:27] offset:64
    ds_write_b128 v10, v[28:31] offset:96
    ds_write_b128 v10, v[32:35] offset:128
    ds_write_b128 v10, v[36:39] offset:160
    ds_write_b128 v10, v[40:43] offset:192
    ds_write_b128 v10, v[44:47] offset:224
    ds_write_b128 v13, v[48:51] offset:0
    ds_write_b128 v13, v[52:55] offset:32
    ds_write_b128 v13, v[56:59] offset:64
    ds_write_b128 v13, v[60:63] offset:96
    ds_write_b128 v13, v[64:67] offset:128
    ds_write_b128 v13, v[68:71] offset:160
    ds_write_b128 v13, v[72:75] offset:192
    ds_write_b128 v13, v[76:79] offset:224
    s_waitcnt lgkmcnt(0)
    s_barrier
    s_setprio 3
    v_and_b32 v3, 3, v0
    v_mul_u32_u24 v3, 12288, v3
    v_add_u32 v3, 65536, v3
    ds_read_b32 v4, v3
    s_waitcnt lgkmcnt(0)
    v_cmp_ne_u32 vcc, 0, v4
    s_nop 0
    s_cmp_eq_u64 vcc, 0
    s_cbranch_scc1 K3_NOFB
    s_barrier
    s_barrier
K3_NOFB:
    ds_read_b128 v[16:19], v11 offset:0
    ds_read_b128 v[20:23], v11 offset:16
    ds_read_b128 v[24:27], v11 offset:12288
    ds_read_b128 v[28:31], v11 offset:12304
    ds_read_b128 v[32:35], v11 offset:24576
    ds_read_b128 v[36:39], v11 offset:24592
    ds_read_b128 v[40:43], v11 offset:36864
    ds_read_b128 v[44:47], v11 offset:36880
    ds_read_b128 v[48:51], v12 offset:0
    ds_read_b128 v[52:55], v12 offset:16
    ds_read_b128 v[56:59], v12 offset:12288
    ds_read_b128 v[60:63], v12 offset:12304
    ds_read_b128 v[64:67], v12 offset:24576
    ds_read_b128 v[68:71], v12 offset:24592
    ds_read_b128 v[72:75], v12 offset:36864
    ds_read_b128 v[76:79], v12 offset:36880
    v_lshlrev_b32 v224, 16, v248
    v_and_b32 v225, 0xffff0000, v248
    v_lshlrev_b32 v226, 16, v249
    v_and_b32 v227, 0xffff0000, v249
    v_lshlrev_b32 v228, 16, v250
    v_and_b32 v229, 0xffff0000, v250
    v_lshlrev_b32 v230, 16, v251
    v_and_b32 v231, 0xffff0000, v251
    v_lshlrev_b32 v232, 16, v252
    v_and_b32 v233, 0xffff0000, v252
    v_lshlrev_b32 v234, 16, v253
    v_and_b32 v235, 0xffff0000, v253
    v_lshlrev_b32 v236, 16, v254
    v_and_b32 v237, 0xffff0000, v254
    v_lshlrev_b32 v238, 16, v255
    v_and_b32 v239, 0xffff0000, v255
    s_waitcnt lgkmcnt(8)
    v_add_f32 v224, v224, v16
    v_add_f32 v225, v225, v17
    v_add_f32 v226, v226, v18
    v_add_f32 v227, v227, v19
    v_add_f32 v228, v228, v20
    v_add_f32 v229, v229, v21
    v_add_f32 v230, v230, v22
    v_add_f32 v231, v231, v23
    v_add_f32 v224, v224, v24
    v_add_f32 v225, v225, v25
    v_add_f32 v226, v226, v26
    v_add_f32 v227, v227, v27
    v_add_f32 v228, v228, v28
    v_add_f32 v229, v229, v29
    v_add_f32 v230, v230, v30
    v_add_f32 v231, v231, v31
    v_add_f32 v224, v224, v32
    v_add_f32 v225, v225, v33
    v_add_f32 v226, v226, v34
    v_add_f32 v227, v227, v35
    v_add_f32 v228, v228, v36
    v_add_f32 v229, v229, v37
    v_add_f32 v230, v230, v38
    v_add_f32 v231, v231, v39
    v_add_f32 v224, v224, v40
    v_add_f32 v225, v225, v41
    v_add_f32 v226, v226, v42
    v_add_f32 v227, v227, v43
    v_add_f32 v228, v228, v44
    v_add_f32 v229, v229, v45
    v_add_f32 v230, v230, v46
    v_add_f32 v231, v231, v47
    s_waitcnt lgkmcnt(0)
    v_add_f32 v232, v232, v48
    v_add_f32 v233, v233, v49
    v_add_f32 v234, v234, v50
    v_add_f32 v235, v235, v51
    v_add_f32 v236, v236, v52
    v_add_f32 v237, v237, v53
    v_add_f32 v238, v238, v54
    v_add_f32 v239, v239, v55
    v_add_f32 v232, v232, v56
    v_add_f32 v233, v233, v57
    v_add_f32 v234, v234, v58
    v_add_f32 v235, v235, v59
    v_add_f32 v236, v236, v60
    v_add_f32 v237, v237, v61
    v_add_f32 v238, v238, v62
    v_add_f32 v239, v239, v63
    v_add_f32 v232, v232, v64
    v_add_f32 v233, v233, v65
    v_add_f32 v234, v234, v66
    v_add_f32 v235, v235, v67
    v_add_f32 v236, v236, v68
    v_add_f32 v237, v237, v69
    v_add_f32 v238, v238, v70
    v_add_f32 v239, v239, v71
    v_add_f32 v232, v232, v72
    v_add_f32 v233, v233, v73
    v_add_f32 v234, v234, v74
    v_add_f32 v235, v235, v75
    v_add_f32 v236, v236, v76
    v_add_f32 v237, v237, v77
    v_add_f32 v238, v238, v78
    v_add_f32 v239, v239, v79
    s_barrier
    s_mov_b32 s4, 400000
    s_brev_b32 s5, 0xffff
    s_branch K3_OQ
K3_OP:
    s_sleep 1
K3_OQ:
    s_mov_b64 exec, 0xff
    buffer_load_dword v6, v9, s[52:55], s66 offen offset:2044 sc1
    s_sub_u32 s4, s4, 1
    s_waitcnt vmcnt(0)
    v_xor_b32 v6, v6, v8
    v_and_b32 v6, s5, v6
    v_cmp_ne_u32 vcc, 0, v6
    s_mov_b64 exec, -1
    s_cmp_eq_u32 s4, 0
    s_cbranch_scc1 K3_OE
    s_cmp_lg_u64 vcc, 0
    s_cbranch_scc1 K3_OP
K3_OS:
    buffer_load_dwordx4 v[144:147], v1, s[52:55], s66 offen offset:0 sc1
    buffer_load_dwordx4 v[148:151], v1, s[52:55], s67 offen offset:0 sc1
    buffer_load_dwordx4 v[152:155], v1, s[52:55], s66 offen offset:1024 sc1
    buffer_load_dwordx4 v[156:159], v1, s[52:55], s67 offen offset:1024 sc1
    buffer_load_dwordx4 v[160:163], v1, s[52:55], s66 offen offset:2048 sc1
    buffer_load_dwordx4 v[164:167], v1, s[52:55], s67 offen offset:2048 sc1
    buffer_load_dwordx4 v[168:171], v1, s[52:55], s66 offen offset:3072 sc1
    buffer_load_dwordx4 v[172:175], v1, s[52:55], s67 offen offset:3072 sc1
    buffer_load_dwordx4 v[176:179], v1, s[52:55], s69 offen offset:0 sc1
    buffer_load_dwordx4 v[180:183], v1, s[52:55], s70 offen offset:0 sc1
    buffer_load_dwordx4 v[184:187], v1, s[52:55], s69 offen offset:1024 sc1
    buffer_load_dwordx4 v[188:191], v1, s[52:55], s70 offen offset:1024 sc1
    buffer_load_dwordx4 v[192:195], v1, s[52:55], s69 offen offset:2048 sc1
    buffer_load_dwordx4 v[196:199], v1, s[52:55], s70 offen offset:2048 sc1
    buffer_load_dwordx4 v[200:203], v1, s[52:55], s69 offen offset:3072 sc1
    buffer_load_dwordx4 v[204:207], v1, s[52:55], s70 offen offset:3072 sc1
    s_waitcnt vmcnt(14)
    v_mfma_f32_32x32x16_bf16 v[16:31], v[80:83], v[144:147], 0
    v_mfma_f32_32x32x16_bf16 v[48:63], v[80:83], v[148:151], 0
    v_mfma_f32_32x32x16_bf16 v[32:47], v[84:87], v[144:147], 0
    v_mfma_f32_32x32x16_bf16 v[64:79], v[84:87], v[148:151], 0
    v_xor_b32 v4, v147, v8
    v_xor_b32 v5, v151, v8
    v_or_b32 v6, v4, v5
    s_waitcnt vmcnt(12)
    v_mfma_f32_32x32x16_bf16 v[16:31], v[88:91], v[152:155], v[16:31]
    v_mfma_f32_32x32x16_bf16 v[48:63], v[88:91], v[156:159], v[48:63]
    v_mfma_f32_32x32x16_bf16 v[32:47], v[92:95], v[152:155], v[32:47]
    v_mfma_f32_32x32x16_bf16 v[64:79], v[92:95], v[156:159], v[64:79]
    v_xor_b32 v4, v155, v8
    v_xor_b32 v5, v159, v8
    v_or3_b32 v6, v4, v5, v6
    s_waitcnt vmcnt(10)
    v_mfma_f32_32x32x16_bf16 v[16:31], v[96:99], v[160:163], v[16:31]
    v_mfma_f32_32x32x16_bf16 v[48:63], v[96:99], v[164:167], v[48:63]
    v_mfma_f32_32x32x16_bf16 v[32:47], v[100:103], v[160:163], v[32:47]
    v_mfma_f32_32x32x16_bf16 v[64:79], v[100:103], v[164:167], v[64:79]
    v_xor_b32 v4, v163, v8
    v_xor_b32 v5, v167, v8
    v_or3_b32 v6, v4, v5, v6
    s_waitcnt vmcnt(8)
    v_mfma_f32_32x32x16_bf16 v[16:31], v[104:107], v[168:171], v[16:31]
    v_mfma_f32_32x32x16_bf16 v[48:63], v[104:107], v[172:175], v[48:63]
    v_mfma_f32_32x32x16_bf16 v[32:47], v[108:111], v[168:171], v[32:47]
    v_mfma_f32_32x32x16_bf16 v[64:79], v[108:111], v[172:175], v[64:79]
    v_xor_b32 v4, v171, v8
    v_xor_b32 v5, v175, v8
    v_or3_b32 v6, v4, v5, v6
    s_waitcnt vmcnt(6)
    v_mfma_f32_32x32x16_bf16 v[16:31], v[112:115], v[176:179], v[16:31]
    v_mfma_f32_32x32x16_bf16 v[48:63], v[112:115], v[180:183], v[48:63]
    v_mfma_f32_32x32x16_bf16 v[32:47], v[116:119], v[176:179], v[32:47]
    v_mfma_f32_32x32x16_bf16 v[64:79], v[116:119], v[180:183], v[64:79]
    v_xor_b32 v4, v179, v8
    v_xor_b32 v5, v183, v8
    v_or3_b32 v6, v4, v5, v6
    s_waitcnt vmcnt(4)
    v_mfma_f32_32x32x16_bf16 v[16:31], v[120:123], v[184:187], v[16:31]
    v_mfma_f32_32x32x16_bf16 v[48:63], v[120:123], v[188:191], v[48:63]
    v_mfma_f32_32x32x16_bf16 v[32:47], v[124:127], v[184:187], v[32:47]
    v_mfma_f32_32x32x16_bf16 v[64:79], v[124:127], v[188:191], v[64:79]
    v_xor_b32 v4, v187, v8
    v_xor_b32 v5, v191, v8
    v_or3_b32 v6, v4, v5, v6
    s_waitcnt vmcnt(2)
    v_mfma_f32_32x32x16_bf16 v[16:31], v[128:131], v[192:195], v[16:31]
    v_mfma_f32_32x32x16_bf16 v[48:63], v[128:131], v[196:199], v[48:63]
    v_mfma_f32_32x32x16_bf16 v[32:47], v[132:135], v[192:195], v[32:47]
    v_mfma_f32_32x32x16_bf16 v[64:79], v[132:135], v[196:199], v[64:79]
    v_xor_b32 v4, v195, v8
    v_xor_b32 v5, v199, v8
    v_or3_b32 v6, v4, v5, v6
    s_waitcnt vmcnt(0)
    v_mfma_f32_32x32x16_bf16 v[16:31], v[136:139], v[200:203], v[16:31]
    v_mfma_f32_32x32x16_bf16 v[48:63], v[136:139], v[204:207], v[48:63]
    v_mfma_f32_32x32x16_bf16 v[32:47], v[140:143], v[200:203], v[32:47]
    v_mfma_f32_32x32x16_bf16 v[64:79], v[140:143], v[204:207], v[64:79]
    v_xor_b32 v4, v203, v8
    v_xor_b32 v5, v207, v8
    v_or3_b32 v6, v4, v5, v6
    v_and_b32 v6, s5, v6
    v_cmp_ne_u32 vcc, 0, v6
    s_nop 0
    s_cmp_lg_u64 vcc, 0
    s_cbranch_scc1 K3_OP
K3_OE:
    s_nop 3
    ds_write_b128 v10, v[16:19] offset:0
    ds_write_b128 v10, v[20:23] offset:32
    ds_write_b128 v10, v[24:27] offset:64
    ds_write_b128 v10, v[28:31] offset:96
    ds_write_b128 v10, v[32:35] offset:128
    ds_write_b128 v10, v[36:39] offset:160
    ds_write_b128 v10, v[40:43] offset:192
    ds_write_b128 v10, v[44:47] offset:224
    ds_write_b128 v13, v[48:51] offset:0
    ds_write_b128 v13, v[52:55] offset:32
    ds_write_b128 v13, v[56:59] offset:64
    ds_write_b128 v13, v[60:63] offset:96
    ds_write_b128 v13, v[64:67] offset:128
    ds_write_b128 v13, v[68:71] offset:160
    ds_write_b128 v13, v[72:75] offset:192
    ds_write_b128 v13, v[76:79] offset:224
    s_waitcnt lgkmcnt(0)
    s_barrier
    ds_read_b128 v[16:19], v11 offset:0
    ds_read_b128 v[20:23], v11 offset:16
    ds_read_b128 v[24:27], v11 offset:12288
    ds_read_b128 v[28:31], v11 offset:12304
    ds_read_b128 v[32:35], v11 offset:24576
    ds_read_b128 v[36:39], v11 offset:24592
    ds_read_b128 v[40:43], v11 offset:36864
    ds_read_b128 v[44:47], v11 offset:36880
    ds_read_b128 v[48:51], v12 offset:0
    ds_read_b128 v[52:55], v12 offset:16
    ds_read_b128 v[56:59], v12 offset:12288
    ds_read_b128 v[60:63], v12 offset:12304
    ds_read_b128 v[64:67], v12 offset:24576
    ds_read_b128 v[68:71], v12 offset:24592
    ds_read_b128 v[72:75], v12 offset:36864
    ds_read_b128 v[76:79], v12 offset:36880
    s_waitcnt lgkmcnt(8)
    v_add_f32 v224, v224, v16
    v_add_f32 v225, v225, v17
    v_add_f32 v226, v226, v18
    v_add_f32 v227, v227, v19
    v_add_f32 v228, v228, v20
    v_add_f32 v229, v229, v21
    v_add_f32 v230, v230, v22
    v_add_f32 v231, v231, v23
    v_add_f32 v224, v224, v24
    v_add_f32 v225, v225, v25
    v_add_f32 v226, v226, v26
    v_add_f32 v227, v227, v27
    v_add_f32 v228, v228, v28
    v_add_f32 v229, v229, v29
    v_add_f32 v230, v230, v30
    v_add_f32 v231, v231, v31
    v_add_f32 v224, v224, v32
    v_add_f32 v225, v225, v33
    v_add_f32 v226, v226, v34
    v_add_f32 v227, v227, v35
    v_add_f32 v228, v228, v36
    v_add_f32 v229, v229, v37
    v_add_f32 v230, v230, v38
    v_add_f32 v231, v231, v39
    v_add_f32 v224, v224, v40
    v_add_f32 v225, v225, v41
    v_add_f32 v226, v226, v42
    v_add_f32 v227, v227, v43
    v_add_f32 v228, v228, v44
    v_add_f32 v229, v229, v45
    v_add_f32 v230, v230, v46
    v_add_f32 v231, v231, v47
    v_cvt_pk_bf16_f32 v248, v224, v225
    v_cvt_pk_bf16_f32 v249, v226, v227
    v_cvt_pk_bf16_f32 v250, v228, v229
    v_cvt_pk_bf16_f32 v251, v230, v231
    buffer_store_dwordx4 v[248:251], v244, s[36:39], s23 offen
    s_waitcnt lgkmcnt(0)
    v_add_f32 v232, v232, v48
    v_add_f32 v233, v233, v49
    v_add_f32 v234, v234, v50
    v_add_f32 v235, v235, v51
    v_add_f32 v236, v236, v52
    v_add_f32 v237, v237, v53
    v_add_f32 v238, v238, v54
    v_add_f32 v239, v239, v55
    v_add_f32 v232, v232, v56
    v_add_f32 v233, v233, v57
    v_add_f32 v234, v234, v58
    v_add_f32 v235, v235, v59
    v_add_f32 v236, v236, v60
    v_add_f32 v237, v237, v61
    v_add_f32 v238, v238, v62
    v_add_f32 v239, v239, v63
    v_add_f32 v232, v232, v64
    v_add_f32 v233, v233, v65
    v_add_f32 v234, v234, v66
    v_add_f32 v235, v235, v67
    v_add_f32 v236, v236, v68
    v_add_f32 v237, v237, v69
    v_add_f32 v238, v238, v70
    v_add_f32 v239, v239, v71
    v_add_f32 v232, v232, v72
    v_add_f32 v233, v233, v73
    v_add_f32 v234, v234, v74
    v_add_f32 v235, v235, v75
    v_add_f32 v236, v236, v76
    v_add_f32 v237, v237, v77
    v_add_f32 v238, v238, v78
    v_add_f32 v239, v239, v79
    v_cvt_pk_bf16_f32 v252, v232, v233
    v_cvt_pk_bf16_f32 v253, v234, v235
    v_cvt_pk_bf16_f32 v254, v236, v237
    v_cvt_pk_bf16_f32 v255, v238, v239
    buffer_store_dwordx4 v[252:255], v244, s[36:39], s24 offen
F_CEND:
F_END:
    s_endpgm
F_CODE_END:
.section .rodata,"a"
.p2align 6
.amdhsa_kernel parallel_sum__grouped_kv_mqa__glu_gated_glu__prompt_kernel
  .amdhsa_next_free_vgpr 256
  .amdhsa_next_free_sgpr 102
  .amdhsa_accum_offset 256
  .amdhsa_group_segment_fixed_size 0
  .amdhsa_kernarg_size 96
  .amdhsa_user_sgpr_count 2
  .amdhsa_user_sgpr_kernarg_segment_ptr 1
  .amdhsa_system_sgpr_workgroup_id_x 1
  .amdhsa_float_denorm_mode_32 3
  .amdhsa_float_denorm_mode_16_64 3
.end_amdhsa_kernel
```
